```python
import torch

def _softmax(x, axis=-1):
    return torch.softmax(x, dim=axis)
def _gelu(x):
    return torch.nn.functional.gelu(x, approximate="tanh")
def _silu(x):
    return torch.nn.functional.silu(x)
def _sigmoid(x):
    return torch.sigmoid(x)
def _layernorm(x, axis=-1, eps=1e-5):
    m = x.mean(dim=axis, keepdim=True)
    v = x.var(dim=axis, keepdim=True, unbiased=False)
    return (x - m) / torch.sqrt(v + eps)
def _scatter_add(tgt, idx, src, axis=0):
    return tgt.clone().index_add_(axis, idx, src)
def _segment_sum(src, seg, n):
    out = torch.zeros((n,) + src.shape[1:], dtype=src.dtype)
    return out.index_add_(0, seg, src)
def _pad(x, pw):
    flat = tuple(v for pair in reversed(pw) for v in pair)
    return torch.nn.functional.pad(x, flat)

kernel_name = 'standalone__cross_network_dcn__recsys'

def setup_inputs():

    _w = (lambda a: (lambda t: t.to(torch.bfloat16) if t.is_floating_point() else t)(torch.as_tensor(a)))
    B, F, D, L = 4096, 100, 64, 3
    Din = min(F * D, 1024)
    return {
        "x0": _w((lambda *s: torch.randn(*s, dtype=torch.bfloat16) * 0.05)(B, Din)),
        "ws": _w((lambda *s: torch.randn(*s, dtype=torch.bfloat16) * 0.8)(L, Din, Din) * (Din ** -0.5)),
        "bs": _w((lambda *s: torch.randn(*s, dtype=torch.bfloat16) * 3.2)(L, Din) * 0.01),
    }

def reference(x0, ws, bs):
    x = x0
    L = ws.shape[0]
    for l in range(L):
        proj = torch.einsum('bd,de->be', x, ws[l]) + bs[l]
        x = x0 * proj + x
    return x
```

```asm
; @launch grid=(256,1,1) block=(512,1,1) lds=133120
.amdgcn_target "amdgcn-amd-amdhsa--gfx950"
.text
.globl standalone__cross_network_dcn__recsys_kernel
.p2align 8
.type standalone__cross_network_dcn__recsys_kernel,@function
standalone__cross_network_dcn__recsys_kernel:
    s_cmp_ge_u32 s2, 256
    s_cbranch_scc1 L_end
    s_load_dwordx4 s[4:7], s[0:1], 0
    s_load_dwordx2 s[44:45], s[0:1], 16
    s_load_dwordx2 s[42:43], s[0:1], 24
    s_load_dwordx2 s[40:41], s[0:1], 40
    v_lshrrev_b32 v1, 6, v0
    s_lshr_b32 s29, s2, 3
    s_and_b32 s29, s29, 7
    s_lshr_b32 s28, s2, 6
    s_lshl_b32 s28, s28, 3
    s_and_b32 s34, s2, 7
    s_add_u32 s28, s28, s34
    v_readfirstlane_b32 s3, v1
    s_nop 3
    s_cmp_ge_u32 s3, 4
    s_cbranch_scc1 L_loader
L_compute:
    s_and_b32 s31, s3, 1
    s_lshr_b32 s30, s3, 1
    s_setprio 2
    v_and_b32 v0, 63, v0
    v_and_b32 v11, 15, v0
    v_lshrrev_b32 v12, 4, v0
    v_lshrrev_b32 v13, 1, v11
    v_xor_b32 v14, v13, v12
    v_lshlrev_b32 v14, 4, v14
    v_lshlrev_b32 v15, 7, v11
    v_add_u32 v14, v14, v15
    s_lshl_b32 s34, s30, 13
    v_add_u32 v1, s34, v14
    v_xor_b32 v2, 64, v1
    v_lshrrev_b32 v14, 1, v12
    v_xor_b32 v14, v14, v13
    v_lshlrev_b32 v14, 4, v14
    v_add_u32 v14, v14, v15
    v_and_b32 v15, 1, v12
    v_lshlrev_b32 v15, 3, v15
    v_add_u32 v14, v14, v15
    s_lshl_b32 s35, s31, 14
    s_add_u32 s35, s35, s34
    v_add_u32 v7, s35, v14
    v_lshrrev_b32 v13, 2, v11
    v_lshlrev_b32 v14, 2, v12
    v_add_u32 v13, v13, v14
    v_and_b32 v14, 7, v13
    v_lshlrev_b32 v13, 8, v13
    v_and_b32 v15, 3, v11
    v_lshlrev_b32 v15, 3, v15
    v_add_u32 v13, v13, v15
    v_add_u32 v13, 65536, v13
    s_lshl_b32 s36, s31, 2
    s_add_u32 s37, s36, 0
    v_xor_b32 v15, s37, v14
    v_lshlrev_b32 v15, 5, v15
    v_add_u32 v3, v13, v15
    s_add_u32 s37, s36, 1
    v_xor_b32 v15, s37, v14
    v_lshlrev_b32 v15, 5, v15
    v_add_u32 v4, v13, v15
    s_add_u32 s37, s36, 2
    v_xor_b32 v15, s37, v14
    v_lshlrev_b32 v15, 5, v15
    v_add_u32 v5, v13, v15
    s_add_u32 s37, s36, 3
    v_xor_b32 v15, s37, v14
    v_lshlrev_b32 v15, 5, v15
    v_add_u32 v6, v13, v15
    v_lshlrev_b32 v8, 4, v0
    s_mov_b32 s33, 0xffff0000
    s_lshl_b32 s37, s28, 8
    s_lshl_b32 s38, s29, 4
    s_add_u32 s37, s37, s38
    s_lshl_b32 s38, s3, 2
    s_add_u32 s37, s37, s38
    s_add_u32 s37, s37, 16777216
    v_mov_b32 v9, 0x7ffffff0
    v_mov_b32 v15, s37
    v_cmp_eq_u32 vcc, 0, v0
    s_nop 1
    v_cndmask_b32 v9, v9, v15, vcc
    s_mov_b32 s59, 32768
    s_lshl_b32 s60, s28, 18
    s_lshl_b32 s37, s29, 15
    s_add_u32 s60, s60, s37
    s_add_u32 s60, s60, s35
    s_add_u32 s61, s60, 4096
    s_waitcnt lgkmcnt(0)
    s_mov_b32 s16, s40
    s_mov_b32 s17, s41
    s_mov_b32 s18, 18874368
    s_mov_b32 s19, 0x00020000
    s_mov_b32 s20, s42
    s_mov_b32 s21, s43
    s_mov_b32 s22, 8388608
    s_mov_b32 s23, 0x00020000
    s_mov_b32 s12, s6
    s_mov_b32 s13, s7
    s_mov_b32 s14, 6291456
    s_mov_b32 s15, 0x00020000
    s_lshl_b32 s77, s2, 13
    s_lshl_b32 s34, s3, 11
    s_add_u32 s77, s77, s34
    s_lshl_b32 s34, s28, 7
    s_add_u32 s34, s34, 16842752
    s_load_dword s32, s[40:41], s34
    s_getreg_b32 s75, hwreg(HW_REG_XCC_ID, 0, 4)
    s_waitcnt lgkmcnt(0)
    s_add_u32 s75, s75, s32
    s_add_u32 s75, s75, 1013904242
    s_add_u32 s32, s32, 1779033703
    v_mov_b32 v10, s32
    s_barrier
    v_lshrrev_b32 v11, 4, v0
    v_lshlrev_b32 v11, 3, v11
    s_lshl_b32 s34, s31, 7
    s_add_u32 s34, s34, 131072
    v_add_u32 v11, s34, v11
    ds_read_b64 v[242:243], v11 offset:0
    ds_read_b64 v[246:247], v11 offset:32
    ds_read_b64 v[250:251], v11 offset:64
    ds_read_b64 v[254:255], v11 offset:96
    ds_read_b64_tr_b16 v[208:209], v3 offset:0
    ds_read_b64_tr_b16 v[210:211], v3 offset:4096
    ds_read_b128 v[80:83], v1 offset:0
    ds_read_b64_tr_b16 v[212:213], v3 offset:8192
    ds_read_b64_tr_b16 v[214:215], v3 offset:12288
    ds_read_b128 v[84:87], v2 offset:0
    ds_read_b128 v[92:95], v2 offset:2048
    ds_read_b128 v[88:91], v1 offset:2048
    ds_read_b128 v[96:99], v1 offset:4096
    ds_read_b128 v[100:103], v2 offset:4096
    ds_read_b128 v[108:111], v2 offset:6144
    ds_read_b128 v[104:107], v1 offset:6144
    ds_read_b64_tr_b16 v[216:217], v4 offset:0
    ds_read_b64_tr_b16 v[218:219], v4 offset:4096
    ds_read_b64_tr_b16 v[220:221], v4 offset:8192
    ds_read_b64_tr_b16 v[222:223], v4 offset:12288
    s_waitcnt lgkmcnt(15)
    v_lshlrev_b32 v240, 16, v242
    v_and_b32 v241, s33, v242
    v_lshlrev_b32 v242, 16, v243
    v_and_b32 v243, s33, v243
    v_lshlrev_b32 v244, 16, v246
    v_and_b32 v245, s33, v246
    v_lshlrev_b32 v246, 16, v247
    v_and_b32 v247, s33, v247
    v_lshlrev_b32 v248, 16, v250
    v_and_b32 v249, s33, v250
    v_lshlrev_b32 v250, 16, v251
    v_and_b32 v251, s33, v251
    v_lshlrev_b32 v252, 16, v254
    v_and_b32 v253, s33, v254
    v_lshlrev_b32 v254, 16, v255
    v_and_b32 v255, s33, v255
    v_add_f32 v240, 1.0, v240
    v_add_f32 v241, 1.0, v241
    v_add_f32 v242, 1.0, v242
    v_add_f32 v243, 1.0, v243
    v_add_f32 v244, 1.0, v244
    v_add_f32 v245, 1.0, v245
    v_add_f32 v246, 1.0, v246
    v_add_f32 v247, 1.0, v247
    v_add_f32 v248, 1.0, v248
    v_add_f32 v249, 1.0, v249
    v_add_f32 v250, 1.0, v250
    v_add_f32 v251, 1.0, v251
    v_add_f32 v252, 1.0, v252
    v_add_f32 v253, 1.0, v253
    v_add_f32 v254, 1.0, v254
    v_add_f32 v255, 1.0, v255
    s_nop 1
    s_waitcnt lgkmcnt(13)
    v_mfma_f32_16x16x32_bf16 v[16:19], v[208:211], v[80:83], v[240:243]
    ds_read_b64_tr_b16 v[224:225], v5 offset:0
    s_waitcnt lgkmcnt(11)
    v_mfma_f32_16x16x32_bf16 v[16:19], v[212:215], v[84:87], v[16:19]
    ds_read_b64_tr_b16 v[226:227], v5 offset:4096
    s_waitcnt lgkmcnt(11)
    v_mfma_f32_16x16x32_bf16 v[32:35], v[212:215], v[92:95], v[240:243]
    ds_read_b64_tr_b16 v[228:229], v5 offset:8192
    s_waitcnt lgkmcnt(11)
    v_mfma_f32_16x16x32_bf16 v[32:35], v[208:211], v[88:91], v[32:35]
    ds_read_b64_tr_b16 v[230:231], v5 offset:12288
    s_waitcnt lgkmcnt(11)
    v_mfma_f32_16x16x32_bf16 v[48:51], v[208:211], v[96:99], v[240:243]
    ds_read_b64_tr_b16 v[232:233], v6 offset:0
    s_waitcnt lgkmcnt(11)
    v_mfma_f32_16x16x32_bf16 v[48:51], v[212:215], v[100:103], v[48:51]
    ds_read_b64_tr_b16 v[234:235], v6 offset:4096
    s_waitcnt lgkmcnt(11)
    v_mfma_f32_16x16x32_bf16 v[64:67], v[212:215], v[108:111], v[240:243]
    ds_read_b64_tr_b16 v[236:237], v6 offset:8192
    s_waitcnt lgkmcnt(11)
    v_mfma_f32_16x16x32_bf16 v[64:67], v[208:211], v[104:107], v[64:67]
    ds_read_b64_tr_b16 v[238:239], v6 offset:12288
    s_waitcnt lgkmcnt(10)
    v_mfma_f32_16x16x32_bf16 v[68:71], v[216:219], v[104:107], v[244:247]
    s_waitcnt lgkmcnt(8)
    v_mfma_f32_16x16x32_bf16 v[68:71], v[220:223], v[108:111], v[68:71]
    s_lshl_b32 s34, s28, 7
    s_lshl_b32 s35, s29, 2
    s_add_u32 s34, s34, s35
    s_add_u32 s34, s34, 16875520
    v_mov_b32 v13, 0x7ffffff0
    v_mov_b32 v14, s34
    v_cmp_eq_u32 vcc, 0, v0
    s_nop 1
    v_cndmask_b32 v13, v13, v14, vcc
    v_mov_b32 v14, s75
    buffer_store_dword v14, v13, s[16:19], 0 offen sc1
    v_mfma_f32_16x16x32_bf16 v[52:55], v[220:223], v[100:103], v[244:247]
    v_mfma_f32_16x16x32_bf16 v[52:55], v[216:219], v[96:99], v[52:55]
    v_mfma_f32_16x16x32_bf16 v[36:39], v[216:219], v[88:91], v[244:247]
    v_mfma_f32_16x16x32_bf16 v[36:39], v[220:223], v[92:95], v[36:39]
    s_lshl_b32 s34, s28, 8
    s_add_u32 s34, s34, 16777216
    v_lshlrev_b32 v13, 2, v0
    s_mov_b32 m0, 132096
    s_nop 0
    buffer_load_dword v13, s[16:19], s34 offen sc1 lds
    v_mfma_f32_16x16x32_bf16 v[20:23], v[220:223], v[84:87], v[244:247]
    v_mfma_f32_16x16x32_bf16 v[20:23], v[216:219], v[80:83], v[20:23]
    s_waitcnt lgkmcnt(6)
    v_mfma_f32_16x16x32_bf16 v[24:27], v[224:227], v[80:83], v[248:251]
    s_waitcnt lgkmcnt(0)
    s_barrier
    v_mfma_f32_16x16x32_bf16 v[24:27], v[228:231], v[84:87], v[24:27]
    ds_read_b64_tr_b16 v[208:209], v3 offset:16384
    ds_read_b64_tr_b16 v[210:211], v3 offset:20480
    v_mfma_f32_16x16x32_bf16 v[40:43], v[228:231], v[92:95], v[248:251]
    ds_read_b128 v[112:115], v1 offset:16384
    v_mfma_f32_16x16x32_bf16 v[40:43], v[224:227], v[88:91], v[40:43]
    ds_read_b64_tr_b16 v[212:213], v3 offset:24576
    v_mfma_f32_16x16x32_bf16 v[56:59], v[224:227], v[96:99], v[248:251]
    ds_read_b64_tr_b16 v[214:215], v3 offset:28672
    v_mfma_f32_16x16x32_bf16 v[56:59], v[228:231], v[100:103], v[56:59]
    ds_read_b128 v[116:119], v2 offset:16384
    v_mfma_f32_16x16x32_bf16 v[72:75], v[228:231], v[108:111], v[248:251]
    ds_read_b128 v[124:127], v2 offset:18432
    v_mfma_f32_16x16x32_bf16 v[72:75], v[224:227], v[104:107], v[72:75]
    ds_read_b128 v[120:123], v1 offset:18432
    v_mfma_f32_16x16x32_bf16 v[76:79], v[232:235], v[104:107], v[252:255]
    ds_read_b128 v[128:131], v1 offset:20480
    v_mfma_f32_16x16x32_bf16 v[76:79], v[236:239], v[108:111], v[76:79]
    ds_read_b128 v[132:135], v2 offset:20480
    v_mfma_f32_16x16x32_bf16 v[60:63], v[236:239], v[100:103], v[252:255]
    ds_read_b128 v[140:143], v2 offset:22528
    v_mfma_f32_16x16x32_bf16 v[60:63], v[232:235], v[96:99], v[60:63]
    ds_read_b128 v[136:139], v1 offset:22528
    v_mfma_f32_16x16x32_bf16 v[44:47], v[232:235], v[88:91], v[252:255]
    ds_read_b64_tr_b16 v[216:217], v4 offset:16384
    v_mfma_f32_16x16x32_bf16 v[44:47], v[236:239], v[92:95], v[44:47]
    ds_read_b64_tr_b16 v[218:219], v4 offset:20480
    v_mfma_f32_16x16x32_bf16 v[28:31], v[236:239], v[84:87], v[252:255]
    ds_read_b64_tr_b16 v[220:221], v4 offset:24576
    v_mfma_f32_16x16x32_bf16 v[28:31], v[232:235], v[80:83], v[28:31]
    ds_read_b64_tr_b16 v[222:223], v4 offset:28672
    s_waitcnt lgkmcnt(13)
    v_mfma_f32_16x16x32_bf16 v[16:19], v[208:211], v[112:115], v[16:19]
    ds_read_b64_tr_b16 v[224:225], v5 offset:16384
    v_xor_b32 v11, 0, v7
    v_xor_b32 v12, 32, v7
    s_waitcnt lgkmcnt(11)
    v_mfma_f32_16x16x32_bf16 v[16:19], v[212:215], v[116:119], v[16:19]
    ds_read_b64_tr_b16 v[226:227], v5 offset:20480
    v_xor_b32 v13, 64, v7
    v_xor_b32 v14, 96, v7
    s_waitcnt lgkmcnt(11)
    v_mfma_f32_16x16x32_bf16 v[32:35], v[212:215], v[124:127], v[32:35]
    ds_read_b64_tr_b16 v[228:229], v5 offset:24576
    s_waitcnt lgkmcnt(11)
    v_mfma_f32_16x16x32_bf16 v[32:35], v[208:211], v[120:123], v[32:35]
    ds_read_b64_tr_b16 v[230:231], v5 offset:28672
    s_waitcnt lgkmcnt(11)
    v_mfma_f32_16x16x32_bf16 v[48:51], v[208:211], v[128:131], v[48:51]
    ds_read_b64_tr_b16 v[232:233], v6 offset:16384
    ds_read_b64 v[146:147], v11 offset:0
    s_waitcnt lgkmcnt(12)
    v_mfma_f32_16x16x32_bf16 v[48:51], v[212:215], v[132:135], v[48:51]
    ds_read_b64_tr_b16 v[234:235], v6 offset:20480
    ds_read_b64 v[150:151], v12 offset:0
    s_waitcnt lgkmcnt(13)
    v_mfma_f32_16x16x32_bf16 v[64:67], v[212:215], v[140:143], v[64:67]
    ds_read_b64_tr_b16 v[236:237], v6 offset:24576
    ds_read_b64 v[154:155], v13 offset:0
    s_waitcnt lgkmcnt(14)
    v_mfma_f32_16x16x32_bf16 v[64:67], v[208:211], v[136:139], v[64:67]
    ds_read_b64_tr_b16 v[238:239], v6 offset:28672
    ds_read_b64 v[158:159], v14 offset:0
    s_waitcnt lgkmcnt(14)
    v_mfma_f32_16x16x32_bf16 v[68:71], v[216:219], v[136:139], v[68:71]
    ds_read_b64 v[162:163], v11 offset:2048
    ds_read_b64 v[166:167], v12 offset:2048
    s_waitcnt lgkmcnt(14)
    v_mfma_f32_16x16x32_bf16 v[68:71], v[220:223], v[140:143], v[68:71]
    ds_read_b64 v[170:171], v13 offset:2048
    ds_read_b64 v[174:175], v14 offset:2048
    v_mfma_f32_16x16x32_bf16 v[52:55], v[220:223], v[132:135], v[52:55]
    ds_read_b64 v[178:179], v11 offset:4096
    ds_read_b64 v[182:183], v12 offset:4096
    v_mfma_f32_16x16x32_bf16 v[52:55], v[216:219], v[128:131], v[52:55]
    ds_read_b64 v[186:187], v13 offset:4096
    ds_read_b64 v[190:191], v14 offset:4096
    v_mfma_f32_16x16x32_bf16 v[36:39], v[216:219], v[120:123], v[36:39]
    ds_read_b64 v[194:195], v11 offset:6144
    v_mfma_f32_16x16x32_bf16 v[36:39], v[220:223], v[124:127], v[36:39]
    ds_read_b64 v[198:199], v12 offset:6144
    v_mfma_f32_16x16x32_bf16 v[20:23], v[220:223], v[116:119], v[20:23]
    ds_read_b64 v[202:203], v13 offset:6144
    v_mfma_f32_16x16x32_bf16 v[20:23], v[216:219], v[112:115], v[20:23]
    ds_read_b64 v[206:207], v14 offset:6144
    s_waitcnt lgkmcnt(15)
    v_mfma_f32_16x16x32_bf16 v[24:27], v[224:227], v[112:115], v[24:27]
    s_waitcnt lgkmcnt(0)
    s_barrier
    v_mfma_f32_16x16x32_bf16 v[24:27], v[228:231], v[116:119], v[24:27]
    ds_read_b64_tr_b16 v[208:209], v3 offset:32768
    ds_read_b64_tr_b16 v[210:211], v3 offset:36864
    v_mfma_f32_16x16x32_bf16 v[40:43], v[228:231], v[124:127], v[40:43]
    ds_read_b128 v[80:83], v1 offset:32768
    v_mfma_f32_16x16x32_bf16 v[40:43], v[224:227], v[120:123], v[40:43]
    ds_read_b64_tr_b16 v[212:213], v3 offset:40960
    v_mfma_f32_16x16x32_bf16 v[56:59], v[224:227], v[128:131], v[56:59]
    ds_read_b64_tr_b16 v[214:215], v3 offset:45056
    v_mfma_f32_16x16x32_bf16 v[56:59], v[228:231], v[132:135], v[56:59]
    ds_read_b128 v[84:87], v2 offset:32768
    v_mfma_f32_16x16x32_bf16 v[72:75], v[228:231], v[140:143], v[72:75]
    ds_read_b128 v[92:95], v2 offset:34816
    v_mfma_f32_16x16x32_bf16 v[72:75], v[224:227], v[136:139], v[72:75]
    ds_read_b128 v[88:91], v1 offset:34816
    v_mfma_f32_16x16x32_bf16 v[76:79], v[232:235], v[136:139], v[76:79]
    ds_read_b128 v[96:99], v1 offset:36864
    v_mfma_f32_16x16x32_bf16 v[76:79], v[236:239], v[140:143], v[76:79]
    ds_read_b128 v[100:103], v2 offset:36864
    v_mfma_f32_16x16x32_bf16 v[60:63], v[236:239], v[132:135], v[60:63]
    ds_read_b128 v[108:111], v2 offset:38912
    v_mfma_f32_16x16x32_bf16 v[60:63], v[232:235], v[128:131], v[60:63]
    ds_read_b128 v[104:107], v1 offset:38912
    v_mfma_f32_16x16x32_bf16 v[44:47], v[232:235], v[120:123], v[44:47]
    ds_read_b64_tr_b16 v[216:217], v4 offset:32768
    v_mfma_f32_16x16x32_bf16 v[44:47], v[236:239], v[124:127], v[44:47]
    ds_read_b64_tr_b16 v[218:219], v4 offset:36864
    v_mfma_f32_16x16x32_bf16 v[28:31], v[236:239], v[116:119], v[28:31]
    ds_read_b64_tr_b16 v[220:221], v4 offset:40960
    v_mfma_f32_16x16x32_bf16 v[28:31], v[232:235], v[112:115], v[28:31]
    ds_read_b64_tr_b16 v[222:223], v4 offset:45056
    s_waitcnt lgkmcnt(13)
    v_mfma_f32_16x16x32_bf16 v[16:19], v[208:211], v[80:83], v[16:19]
    ds_read_b64_tr_b16 v[224:225], v5 offset:32768
    s_waitcnt lgkmcnt(11)
    v_mfma_f32_16x16x32_bf16 v[16:19], v[212:215], v[84:87], v[16:19]
    ds_read_b64_tr_b16 v[226:227], v5 offset:36864
    s_waitcnt lgkmcnt(11)
    v_mfma_f32_16x16x32_bf16 v[32:35], v[212:215], v[92:95], v[32:35]
    ds_read_b64_tr_b16 v[228:229], v5 offset:40960
    s_waitcnt lgkmcnt(11)
    v_mfma_f32_16x16x32_bf16 v[32:35], v[208:211], v[88:91], v[32:35]
    ds_read_b64_tr_b16 v[230:231], v5 offset:45056
    s_waitcnt lgkmcnt(11)
    v_mfma_f32_16x16x32_bf16 v[48:51], v[208:211], v[96:99], v[48:51]
    ds_read_b64_tr_b16 v[232:233], v6 offset:32768
    s_waitcnt lgkmcnt(11)
    v_mfma_f32_16x16x32_bf16 v[48:51], v[212:215], v[100:103], v[48:51]
    ds_read_b64_tr_b16 v[234:235], v6 offset:36864
    s_waitcnt lgkmcnt(11)
    v_mfma_f32_16x16x32_bf16 v[64:67], v[212:215], v[108:111], v[64:67]
    ds_read_b64_tr_b16 v[236:237], v6 offset:40960
    s_waitcnt lgkmcnt(11)
    v_mfma_f32_16x16x32_bf16 v[64:67], v[208:211], v[104:107], v[64:67]
    ds_read_b64_tr_b16 v[238:239], v6 offset:45056
    s_waitcnt lgkmcnt(10)
    v_mfma_f32_16x16x32_bf16 v[68:71], v[216:219], v[104:107], v[68:71]
    s_waitcnt lgkmcnt(8)
    v_mfma_f32_16x16x32_bf16 v[68:71], v[220:223], v[108:111], v[68:71]
    v_mfma_f32_16x16x32_bf16 v[52:55], v[220:223], v[100:103], v[52:55]
    v_mfma_f32_16x16x32_bf16 v[52:55], v[216:219], v[96:99], v[52:55]
    v_mfma_f32_16x16x32_bf16 v[36:39], v[216:219], v[88:91], v[36:39]
    v_mfma_f32_16x16x32_bf16 v[36:39], v[220:223], v[92:95], v[36:39]
    v_mfma_f32_16x16x32_bf16 v[20:23], v[220:223], v[84:87], v[20:23]
    v_mfma_f32_16x16x32_bf16 v[20:23], v[216:219], v[80:83], v[20:23]
    s_waitcnt lgkmcnt(6)
    v_mfma_f32_16x16x32_bf16 v[24:27], v[224:227], v[80:83], v[24:27]
    s_waitcnt lgkmcnt(0)
    s_barrier
    v_mfma_f32_16x16x32_bf16 v[24:27], v[228:231], v[84:87], v[24:27]
    ds_read_b64_tr_b16 v[208:209], v3 offset:49152
    ds_read_b64_tr_b16 v[210:211], v3 offset:53248
    v_mfma_f32_16x16x32_bf16 v[40:43], v[228:231], v[92:95], v[40:43]
    ds_read_b128 v[112:115], v1 offset:49152
    v_mfma_f32_16x16x32_bf16 v[40:43], v[224:227], v[88:91], v[40:43]
    ds_read_b64_tr_b16 v[212:213], v3 offset:57344
    v_mfma_f32_16x16x32_bf16 v[56:59], v[224:227], v[96:99], v[56:59]
    ds_read_b64_tr_b16 v[214:215], v3 offset:61440
    v_mfma_f32_16x16x32_bf16 v[56:59], v[228:231], v[100:103], v[56:59]
    ds_read_b128 v[116:119], v2 offset:49152
    v_mfma_f32_16x16x32_bf16 v[72:75], v[228:231], v[108:111], v[72:75]
    ds_read_b128 v[124:127], v2 offset:51200
    v_mfma_f32_16x16x32_bf16 v[72:75], v[224:227], v[104:107], v[72:75]
    ds_read_b128 v[120:123], v1 offset:51200
    v_mfma_f32_16x16x32_bf16 v[76:79], v[232:235], v[104:107], v[76:79]
    ds_read_b128 v[128:131], v1 offset:53248
    v_mfma_f32_16x16x32_bf16 v[76:79], v[236:239], v[108:111], v[76:79]
    ds_read_b128 v[132:135], v2 offset:53248
    v_mfma_f32_16x16x32_bf16 v[60:63], v[236:239], v[100:103], v[60:63]
    ds_read_b128 v[140:143], v2 offset:55296
    v_mfma_f32_16x16x32_bf16 v[60:63], v[232:235], v[96:99], v[60:63]
    ds_read_b128 v[136:139], v1 offset:55296
    v_mfma_f32_16x16x32_bf16 v[44:47], v[232:235], v[88:91], v[44:47]
    ds_read_b64_tr_b16 v[216:217], v4 offset:49152
    v_mfma_f32_16x16x32_bf16 v[44:47], v[236:239], v[92:95], v[44:47]
    ds_read_b64_tr_b16 v[218:219], v4 offset:53248
    v_mfma_f32_16x16x32_bf16 v[28:31], v[236:239], v[84:87], v[28:31]
    ds_read_b64_tr_b16 v[220:221], v4 offset:57344
    v_mfma_f32_16x16x32_bf16 v[28:31], v[232:235], v[80:83], v[28:31]
    ds_read_b64_tr_b16 v[222:223], v4 offset:61440
    s_waitcnt lgkmcnt(13)
    v_mfma_f32_16x16x32_bf16 v[16:19], v[208:211], v[112:115], v[16:19]
    ds_read_b64_tr_b16 v[224:225], v5 offset:49152
    s_waitcnt lgkmcnt(11)
    v_mfma_f32_16x16x32_bf16 v[16:19], v[212:215], v[116:119], v[16:19]
    ds_read_b64_tr_b16 v[226:227], v5 offset:53248
    s_waitcnt lgkmcnt(11)
    v_mfma_f32_16x16x32_bf16 v[32:35], v[212:215], v[124:127], v[32:35]
    ds_read_b64_tr_b16 v[228:229], v5 offset:57344
    s_waitcnt lgkmcnt(11)
    v_mfma_f32_16x16x32_bf16 v[32:35], v[208:211], v[120:123], v[32:35]
    ds_read_b64_tr_b16 v[230:231], v5 offset:61440
    s_waitcnt lgkmcnt(11)
    v_mfma_f32_16x16x32_bf16 v[48:51], v[208:211], v[128:131], v[48:51]
    ds_read_b64_tr_b16 v[232:233], v6 offset:49152
    s_waitcnt lgkmcnt(11)
    v_mfma_f32_16x16x32_bf16 v[48:51], v[212:215], v[132:135], v[48:51]
    ds_read_b64_tr_b16 v[234:235], v6 offset:53248
    s_waitcnt lgkmcnt(11)
    v_mfma_f32_16x16x32_bf16 v[64:67], v[212:215], v[140:143], v[64:67]
    ds_read_b64_tr_b16 v[236:237], v6 offset:57344
    s_waitcnt lgkmcnt(11)
    v_mfma_f32_16x16x32_bf16 v[64:67], v[208:211], v[136:139], v[64:67]
    ds_read_b64_tr_b16 v[238:239], v6 offset:61440
    s_waitcnt lgkmcnt(10)
    v_mfma_f32_16x16x32_bf16 v[68:71], v[216:219], v[136:139], v[68:71]
    s_waitcnt lgkmcnt(8)
    v_mfma_f32_16x16x32_bf16 v[68:71], v[220:223], v[140:143], v[68:71]
    v_lshlrev_b32 v144, 16, v146
    v_and_b32 v145, s33, v146
    v_lshlrev_b32 v146, 16, v147
    v_and_b32 v147, s33, v147
    v_mfma_f32_16x16x32_bf16 v[52:55], v[220:223], v[132:135], v[52:55]
    v_mfma_f32_16x16x32_bf16 v[52:55], v[216:219], v[128:131], v[52:55]
    v_lshlrev_b32 v148, 16, v150
    v_and_b32 v149, s33, v150
    v_lshlrev_b32 v150, 16, v151
    v_and_b32 v151, s33, v151
    v_mfma_f32_16x16x32_bf16 v[36:39], v[216:219], v[120:123], v[36:39]
    v_mfma_f32_16x16x32_bf16 v[36:39], v[220:223], v[124:127], v[36:39]
    v_lshlrev_b32 v152, 16, v154
    v_and_b32 v153, s33, v154
    v_lshlrev_b32 v154, 16, v155
    v_and_b32 v155, s33, v155
    v_mfma_f32_16x16x32_bf16 v[20:23], v[220:223], v[116:119], v[20:23]
    v_mfma_f32_16x16x32_bf16 v[20:23], v[216:219], v[112:115], v[20:23]
    v_lshlrev_b32 v156, 16, v158
    v_and_b32 v157, s33, v158
    v_lshlrev_b32 v158, 16, v159
    v_and_b32 v159, s33, v159
    s_waitcnt lgkmcnt(6)
    v_mfma_f32_16x16x32_bf16 v[24:27], v[224:227], v[112:115], v[24:27]
    s_waitcnt lgkmcnt(0)
    s_barrier
    v_mfma_f32_16x16x32_bf16 v[24:27], v[228:231], v[116:119], v[24:27]
    ds_read_b64_tr_b16 v[208:209], v3 offset:0
    ds_read_b64_tr_b16 v[210:211], v3 offset:4096
    v_mfma_f32_16x16x32_bf16 v[40:43], v[228:231], v[124:127], v[40:43]
    ds_read_b128 v[80:83], v1 offset:0
    v_mfma_f32_16x16x32_bf16 v[40:43], v[224:227], v[120:123], v[40:43]
    ds_read_b64_tr_b16 v[212:213], v3 offset:8192
    v_mfma_f32_16x16x32_bf16 v[56:59], v[224:227], v[128:131], v[56:59]
    ds_read_b64_tr_b16 v[214:215], v3 offset:12288
    v_mfma_f32_16x16x32_bf16 v[56:59], v[228:231], v[132:135], v[56:59]
    ds_read_b128 v[84:87], v2 offset:0
    v_mfma_f32_16x16x32_bf16 v[72:75], v[228:231], v[140:143], v[72:75]
    ds_read_b128 v[92:95], v2 offset:2048
    v_mfma_f32_16x16x32_bf16 v[72:75], v[224:227], v[136:139], v[72:75]
    ds_read_b128 v[88:91], v1 offset:2048
    v_mfma_f32_16x16x32_bf16 v[76:79], v[232:235], v[136:139], v[76:79]
    ds_read_b128 v[96:99], v1 offset:4096
    v_mfma_f32_16x16x32_bf16 v[76:79], v[236:239], v[140:143], v[76:79]
    ds_read_b128 v[100:103], v2 offset:4096
    v_mfma_f32_16x16x32_bf16 v[60:63], v[236:239], v[132:135], v[60:63]
    ds_read_b128 v[108:111], v2 offset:6144
    v_mfma_f32_16x16x32_bf16 v[60:63], v[232:235], v[128:131], v[60:63]
    ds_read_b128 v[104:107], v1 offset:6144
    v_mfma_f32_16x16x32_bf16 v[44:47], v[232:235], v[120:123], v[44:47]
    ds_read_b64_tr_b16 v[216:217], v4 offset:0
    v_mfma_f32_16x16x32_bf16 v[44:47], v[236:239], v[124:127], v[44:47]
    ds_read_b64_tr_b16 v[218:219], v4 offset:4096
    v_mfma_f32_16x16x32_bf16 v[28:31], v[236:239], v[116:119], v[28:31]
    ds_read_b64_tr_b16 v[220:221], v4 offset:8192
    v_mfma_f32_16x16x32_bf16 v[28:31], v[232:235], v[112:115], v[28:31]
    ds_read_b64_tr_b16 v[222:223], v4 offset:12288
    s_waitcnt lgkmcnt(13)
    v_mfma_f32_16x16x32_bf16 v[16:19], v[208:211], v[80:83], v[16:19]
    ds_read_b64_tr_b16 v[224:225], v5 offset:0
    s_waitcnt lgkmcnt(11)
    v_mfma_f32_16x16x32_bf16 v[16:19], v[212:215], v[84:87], v[16:19]
    ds_read_b64_tr_b16 v[226:227], v5 offset:4096
    s_waitcnt lgkmcnt(11)
    v_mfma_f32_16x16x32_bf16 v[32:35], v[212:215], v[92:95], v[32:35]
    ds_read_b64_tr_b16 v[228:229], v5 offset:8192
    s_waitcnt lgkmcnt(11)
    v_mfma_f32_16x16x32_bf16 v[32:35], v[208:211], v[88:91], v[32:35]
    ds_read_b64_tr_b16 v[230:231], v5 offset:12288
    s_waitcnt lgkmcnt(11)
    v_mfma_f32_16x16x32_bf16 v[48:51], v[208:211], v[96:99], v[48:51]
    ds_read_b64_tr_b16 v[232:233], v6 offset:0
    s_waitcnt lgkmcnt(11)
    v_mfma_f32_16x16x32_bf16 v[48:51], v[212:215], v[100:103], v[48:51]
    ds_read_b64_tr_b16 v[234:235], v6 offset:4096
    s_waitcnt lgkmcnt(11)
    v_mfma_f32_16x16x32_bf16 v[64:67], v[212:215], v[108:111], v[64:67]
    ds_read_b64_tr_b16 v[236:237], v6 offset:8192
    s_waitcnt lgkmcnt(11)
    v_mfma_f32_16x16x32_bf16 v[64:67], v[208:211], v[104:107], v[64:67]
    ds_read_b64_tr_b16 v[238:239], v6 offset:12288
    s_waitcnt lgkmcnt(10)
    v_mfma_f32_16x16x32_bf16 v[68:71], v[216:219], v[104:107], v[68:71]
    s_waitcnt lgkmcnt(8)
    v_mfma_f32_16x16x32_bf16 v[68:71], v[220:223], v[108:111], v[68:71]
    v_lshlrev_b32 v160, 16, v162
    v_and_b32 v161, s33, v162
    v_lshlrev_b32 v162, 16, v163
    v_and_b32 v163, s33, v163
    v_mfma_f32_16x16x32_bf16 v[52:55], v[220:223], v[100:103], v[52:55]
    v_mfma_f32_16x16x32_bf16 v[52:55], v[216:219], v[96:99], v[52:55]
    v_lshlrev_b32 v164, 16, v166
    v_and_b32 v165, s33, v166
    v_lshlrev_b32 v166, 16, v167
    v_and_b32 v167, s33, v167
    v_mfma_f32_16x16x32_bf16 v[36:39], v[216:219], v[88:91], v[36:39]
    v_mfma_f32_16x16x32_bf16 v[36:39], v[220:223], v[92:95], v[36:39]
    v_lshlrev_b32 v168, 16, v170
    v_and_b32 v169, s33, v170
    v_lshlrev_b32 v170, 16, v171
    v_and_b32 v171, s33, v171
    s_add_u32 s34, s77, 2097152
    s_mov_b32 m0, 132096
    s_nop 0
    buffer_load_dwordx4 v8, s[12:15], s34 offen lds
    v_mfma_f32_16x16x32_bf16 v[20:23], v[220:223], v[84:87], v[20:23]
    v_mfma_f32_16x16x32_bf16 v[20:23], v[216:219], v[80:83], v[20:23]
    v_lshlrev_b32 v172, 16, v174
    v_and_b32 v173, s33, v174
    v_lshlrev_b32 v174, 16, v175
    v_and_b32 v175, s33, v175
    s_waitcnt lgkmcnt(6)
    v_mfma_f32_16x16x32_bf16 v[24:27], v[224:227], v[80:83], v[24:27]
    s_waitcnt lgkmcnt(0)
    s_barrier
    v_mfma_f32_16x16x32_bf16 v[24:27], v[228:231], v[84:87], v[24:27]
    ds_read_b64_tr_b16 v[208:209], v3 offset:16384
    ds_read_b64_tr_b16 v[210:211], v3 offset:20480
    v_mfma_f32_16x16x32_bf16 v[40:43], v[228:231], v[92:95], v[40:43]
    ds_read_b128 v[112:115], v1 offset:16384
    v_mfma_f32_16x16x32_bf16 v[40:43], v[224:227], v[88:91], v[40:43]
    ds_read_b64_tr_b16 v[212:213], v3 offset:24576
    v_mfma_f32_16x16x32_bf16 v[56:59], v[224:227], v[96:99], v[56:59]
    ds_read_b64_tr_b16 v[214:215], v3 offset:28672
    v_mfma_f32_16x16x32_bf16 v[56:59], v[228:231], v[100:103], v[56:59]
    ds_read_b128 v[116:119], v2 offset:16384
    v_mfma_f32_16x16x32_bf16 v[72:75], v[228:231], v[108:111], v[72:75]
    ds_read_b128 v[124:127], v2 offset:18432
    v_mfma_f32_16x16x32_bf16 v[72:75], v[224:227], v[104:107], v[72:75]
    ds_read_b128 v[120:123], v1 offset:18432
    v_mfma_f32_16x16x32_bf16 v[76:79], v[232:235], v[104:107], v[76:79]
    ds_read_b128 v[128:131], v1 offset:20480
    v_mfma_f32_16x16x32_bf16 v[76:79], v[236:239], v[108:111], v[76:79]
    ds_read_b128 v[132:135], v2 offset:20480
    v_mfma_f32_16x16x32_bf16 v[60:63], v[236:239], v[100:103], v[60:63]
    ds_read_b128 v[140:143], v2 offset:22528
    v_mfma_f32_16x16x32_bf16 v[60:63], v[232:235], v[96:99], v[60:63]
    ds_read_b128 v[136:139], v1 offset:22528
    v_mfma_f32_16x16x32_bf16 v[44:47], v[232:235], v[88:91], v[44:47]
    ds_read_b64_tr_b16 v[216:217], v4 offset:16384
    v_mfma_f32_16x16x32_bf16 v[44:47], v[236:239], v[92:95], v[44:47]
    ds_read_b64_tr_b16 v[218:219], v4 offset:20480
    v_mfma_f32_16x16x32_bf16 v[28:31], v[236:239], v[84:87], v[28:31]
    ds_read_b64_tr_b16 v[220:221], v4 offset:24576
    v_mfma_f32_16x16x32_bf16 v[28:31], v[232:235], v[80:83], v[28:31]
    ds_read_b64_tr_b16 v[222:223], v4 offset:28672
    s_waitcnt lgkmcnt(13)
    v_mfma_f32_16x16x32_bf16 v[16:19], v[208:211], v[112:115], v[16:19]
    ds_read_b64_tr_b16 v[224:225], v5 offset:16384
    s_waitcnt lgkmcnt(11)
    v_mfma_f32_16x16x32_bf16 v[16:19], v[212:215], v[116:119], v[16:19]
    ds_read_b64_tr_b16 v[226:227], v5 offset:20480
    s_waitcnt lgkmcnt(11)
    v_mfma_f32_16x16x32_bf16 v[32:35], v[212:215], v[124:127], v[32:35]
    ds_read_b64_tr_b16 v[228:229], v5 offset:24576
    s_waitcnt lgkmcnt(11)
    v_mfma_f32_16x16x32_bf16 v[32:35], v[208:211], v[120:123], v[32:35]
    ds_read_b64_tr_b16 v[230:231], v5 offset:28672
    s_waitcnt lgkmcnt(11)
    v_mfma_f32_16x16x32_bf16 v[48:51], v[208:211], v[128:131], v[48:51]
    ds_read_b64_tr_b16 v[232:233], v6 offset:16384
    s_waitcnt lgkmcnt(11)
    v_mfma_f32_16x16x32_bf16 v[48:51], v[212:215], v[132:135], v[48:51]
    ds_read_b64_tr_b16 v[234:235], v6 offset:20480
    s_waitcnt lgkmcnt(11)
    v_mfma_f32_16x16x32_bf16 v[64:67], v[212:215], v[140:143], v[64:67]
    ds_read_b64_tr_b16 v[236:237], v6 offset:24576
    s_waitcnt lgkmcnt(11)
    v_mfma_f32_16x16x32_bf16 v[64:67], v[208:211], v[136:139], v[64:67]
    ds_read_b64_tr_b16 v[238:239], v6 offset:28672
    s_waitcnt lgkmcnt(10)
    v_mfma_f32_16x16x32_bf16 v[68:71], v[216:219], v[136:139], v[68:71]
    s_waitcnt lgkmcnt(8)
    v_mfma_f32_16x16x32_bf16 v[68:71], v[220:223], v[140:143], v[68:71]
    v_lshlrev_b32 v176, 16, v178
    v_and_b32 v177, s33, v178
    v_lshlrev_b32 v178, 16, v179
    v_and_b32 v179, s33, v179
    v_mfma_f32_16x16x32_bf16 v[52:55], v[220:223], v[132:135], v[52:55]
    v_mfma_f32_16x16x32_bf16 v[52:55], v[216:219], v[128:131], v[52:55]
    v_lshlrev_b32 v180, 16, v182
    v_and_b32 v181, s33, v182
    v_lshlrev_b32 v182, 16, v183
    v_and_b32 v183, s33, v183
    v_mfma_f32_16x16x32_bf16 v[36:39], v[216:219], v[120:123], v[36:39]
    v_mfma_f32_16x16x32_bf16 v[36:39], v[220:223], v[124:127], v[36:39]
    v_lshlrev_b32 v184, 16, v186
    v_and_b32 v185, s33, v186
    v_lshlrev_b32 v186, 16, v187
    v_and_b32 v187, s33, v187
    s_add_u32 s34, s77, 2098176
    s_mov_b32 m0, 132096
    s_nop 0
    buffer_load_dwordx4 v8, s[12:15], s34 offen lds
    v_mfma_f32_16x16x32_bf16 v[20:23], v[220:223], v[116:119], v[20:23]
    v_mfma_f32_16x16x32_bf16 v[20:23], v[216:219], v[112:115], v[20:23]
    v_lshlrev_b32 v188, 16, v190
    v_and_b32 v189, s33, v190
    v_lshlrev_b32 v190, 16, v191
    v_and_b32 v191, s33, v191
    s_waitcnt lgkmcnt(6)
    v_mfma_f32_16x16x32_bf16 v[24:27], v[224:227], v[112:115], v[24:27]
    s_waitcnt lgkmcnt(0)
    s_barrier
    v_mfma_f32_16x16x32_bf16 v[24:27], v[228:231], v[116:119], v[24:27]
    ds_read_b64_tr_b16 v[208:209], v3 offset:32768
    ds_read_b64_tr_b16 v[210:211], v3 offset:36864
    v_mfma_f32_16x16x32_bf16 v[40:43], v[228:231], v[124:127], v[40:43]
    ds_read_b128 v[80:83], v1 offset:32768
    v_mfma_f32_16x16x32_bf16 v[40:43], v[224:227], v[120:123], v[40:43]
    ds_read_b64_tr_b16 v[212:213], v3 offset:40960
    v_mfma_f32_16x16x32_bf16 v[56:59], v[224:227], v[128:131], v[56:59]
    ds_read_b64_tr_b16 v[214:215], v3 offset:45056
    v_mfma_f32_16x16x32_bf16 v[56:59], v[228:231], v[132:135], v[56:59]
    ds_read_b128 v[84:87], v2 offset:32768
    v_mfma_f32_16x16x32_bf16 v[72:75], v[228:231], v[140:143], v[72:75]
    ds_read_b128 v[92:95], v2 offset:34816
    v_mfma_f32_16x16x32_bf16 v[72:75], v[224:227], v[136:139], v[72:75]
    ds_read_b128 v[88:91], v1 offset:34816
    v_mfma_f32_16x16x32_bf16 v[76:79], v[232:235], v[136:139], v[76:79]
    ds_read_b128 v[96:99], v1 offset:36864
    v_mfma_f32_16x16x32_bf16 v[76:79], v[236:239], v[140:143], v[76:79]
    ds_read_b128 v[100:103], v2 offset:36864
    v_mfma_f32_16x16x32_bf16 v[60:63], v[236:239], v[132:135], v[60:63]
    ds_read_b128 v[108:111], v2 offset:38912
    v_mfma_f32_16x16x32_bf16 v[60:63], v[232:235], v[128:131], v[60:63]
    ds_read_b128 v[104:107], v1 offset:38912
    v_mfma_f32_16x16x32_bf16 v[44:47], v[232:235], v[120:123], v[44:47]
    ds_read_b64_tr_b16 v[216:217], v4 offset:32768
    v_mfma_f32_16x16x32_bf16 v[44:47], v[236:239], v[124:127], v[44:47]
    ds_read_b64_tr_b16 v[218:219], v4 offset:36864
    v_mfma_f32_16x16x32_bf16 v[28:31], v[236:239], v[116:119], v[28:31]
    ds_read_b64_tr_b16 v[220:221], v4 offset:40960
    v_mfma_f32_16x16x32_bf16 v[28:31], v[232:235], v[112:115], v[28:31]
    ds_read_b64_tr_b16 v[222:223], v4 offset:45056
    s_waitcnt lgkmcnt(13)
    v_mfma_f32_16x16x32_bf16 v[16:19], v[208:211], v[80:83], v[16:19]
    ds_read_b64_tr_b16 v[224:225], v5 offset:32768
    s_waitcnt lgkmcnt(11)
    v_mfma_f32_16x16x32_bf16 v[16:19], v[212:215], v[84:87], v[16:19]
    ds_read_b64_tr_b16 v[226:227], v5 offset:36864
    s_waitcnt lgkmcnt(11)
    v_mfma_f32_16x16x32_bf16 v[32:35], v[212:215], v[92:95], v[32:35]
    ds_read_b64_tr_b16 v[228:229], v5 offset:40960
    s_waitcnt lgkmcnt(11)
    v_mfma_f32_16x16x32_bf16 v[32:35], v[208:211], v[88:91], v[32:35]
    ds_read_b64_tr_b16 v[230:231], v5 offset:45056
    s_waitcnt lgkmcnt(11)
    v_mfma_f32_16x16x32_bf16 v[48:51], v[208:211], v[96:99], v[48:51]
    ds_read_b64_tr_b16 v[232:233], v6 offset:32768
    s_waitcnt lgkmcnt(11)
    v_mfma_f32_16x16x32_bf16 v[48:51], v[212:215], v[100:103], v[48:51]
    ds_read_b64_tr_b16 v[234:235], v6 offset:36864
    s_waitcnt lgkmcnt(11)
    v_mfma_f32_16x16x32_bf16 v[64:67], v[212:215], v[108:111], v[64:67]
    ds_read_b64_tr_b16 v[236:237], v6 offset:40960
    s_waitcnt lgkmcnt(11)
    v_mfma_f32_16x16x32_bf16 v[64:67], v[208:211], v[104:107], v[64:67]
    ds_read_b64_tr_b16 v[238:239], v6 offset:45056
    s_waitcnt lgkmcnt(10)
    v_mfma_f32_16x16x32_bf16 v[68:71], v[216:219], v[104:107], v[68:71]
    s_waitcnt lgkmcnt(8)
    v_mfma_f32_16x16x32_bf16 v[68:71], v[220:223], v[108:111], v[68:71]
    v_lshlrev_b32 v192, 16, v194
    v_and_b32 v193, s33, v194
    v_lshlrev_b32 v194, 16, v195
    v_and_b32 v195, s33, v195
    v_mfma_f32_16x16x32_bf16 v[52:55], v[220:223], v[100:103], v[52:55]
    v_mfma_f32_16x16x32_bf16 v[52:55], v[216:219], v[96:99], v[52:55]
    v_lshlrev_b32 v196, 16, v198
    v_and_b32 v197, s33, v198
    v_lshlrev_b32 v198, 16, v199
    v_and_b32 v199, s33, v199
    v_mfma_f32_16x16x32_bf16 v[36:39], v[216:219], v[88:91], v[36:39]
    v_mfma_f32_16x16x32_bf16 v[36:39], v[220:223], v[92:95], v[36:39]
    v_lshlrev_b32 v200, 16, v202
    v_and_b32 v201, s33, v202
    v_lshlrev_b32 v202, 16, v203
    v_and_b32 v203, s33, v203
    v_mfma_f32_16x16x32_bf16 v[20:23], v[220:223], v[84:87], v[20:23]
    v_mfma_f32_16x16x32_bf16 v[20:23], v[216:219], v[80:83], v[20:23]
    v_lshlrev_b32 v204, 16, v206
    v_and_b32 v205, s33, v206
    v_lshlrev_b32 v206, 16, v207
    v_and_b32 v207, s33, v207
    s_waitcnt lgkmcnt(6)
    v_mfma_f32_16x16x32_bf16 v[24:27], v[224:227], v[80:83], v[24:27]
    s_waitcnt lgkmcnt(0)
    s_barrier
    v_mfma_f32_16x16x32_bf16 v[24:27], v[228:231], v[84:87], v[24:27]
    ds_read_b64_tr_b16 v[208:209], v3 offset:49152
    ds_read_b64_tr_b16 v[210:211], v3 offset:53248
    v_mfma_f32_16x16x32_bf16 v[40:43], v[228:231], v[92:95], v[40:43]
    ds_read_b128 v[112:115], v1 offset:49152
    v_mfma_f32_16x16x32_bf16 v[40:43], v[224:227], v[88:91], v[40:43]
    ds_read_b64_tr_b16 v[212:213], v3 offset:57344
    v_mfma_f32_16x16x32_bf16 v[56:59], v[224:227], v[96:99], v[56:59]
    ds_read_b64_tr_b16 v[214:215], v3 offset:61440
    v_mfma_f32_16x16x32_bf16 v[56:59], v[228:231], v[100:103], v[56:59]
    ds_read_b128 v[116:119], v2 offset:49152
    v_mfma_f32_16x16x32_bf16 v[72:75], v[228:231], v[108:111], v[72:75]
    ds_read_b128 v[124:127], v2 offset:51200
    v_mfma_f32_16x16x32_bf16 v[72:75], v[224:227], v[104:107], v[72:75]
    ds_read_b128 v[120:123], v1 offset:51200
    v_mfma_f32_16x16x32_bf16 v[76:79], v[232:235], v[104:107], v[76:79]
    ds_read_b128 v[128:131], v1 offset:53248
    v_mfma_f32_16x16x32_bf16 v[76:79], v[236:239], v[108:111], v[76:79]
    ds_read_b128 v[132:135], v2 offset:53248
    v_mfma_f32_16x16x32_bf16 v[60:63], v[236:239], v[100:103], v[60:63]
    ds_read_b128 v[140:143], v2 offset:55296
    v_mfma_f32_16x16x32_bf16 v[60:63], v[232:235], v[96:99], v[60:63]
    ds_read_b128 v[136:139], v1 offset:55296
    v_mfma_f32_16x16x32_bf16 v[44:47], v[232:235], v[88:91], v[44:47]
    ds_read_b64_tr_b16 v[216:217], v4 offset:49152
    v_mfma_f32_16x16x32_bf16 v[44:47], v[236:239], v[92:95], v[44:47]
    ds_read_b64_tr_b16 v[218:219], v4 offset:53248
    v_mfma_f32_16x16x32_bf16 v[28:31], v[236:239], v[84:87], v[28:31]
    ds_read_b64_tr_b16 v[220:221], v4 offset:57344
    v_mfma_f32_16x16x32_bf16 v[28:31], v[232:235], v[80:83], v[28:31]
    ds_read_b64_tr_b16 v[222:223], v4 offset:61440
    s_waitcnt lgkmcnt(13)
    v_mfma_f32_16x16x32_bf16 v[16:19], v[208:211], v[112:115], v[16:19]
    ds_read_b64_tr_b16 v[224:225], v5 offset:49152
    s_waitcnt lgkmcnt(11)
    v_mfma_f32_16x16x32_bf16 v[16:19], v[212:215], v[116:119], v[16:19]
    ds_read_b64_tr_b16 v[226:227], v5 offset:53248
    s_waitcnt lgkmcnt(11)
    v_mfma_f32_16x16x32_bf16 v[32:35], v[212:215], v[124:127], v[32:35]
    ds_read_b64_tr_b16 v[228:229], v5 offset:57344
    s_waitcnt lgkmcnt(11)
    v_mfma_f32_16x16x32_bf16 v[32:35], v[208:211], v[120:123], v[32:35]
    ds_read_b64_tr_b16 v[230:231], v5 offset:61440
    s_waitcnt lgkmcnt(11)
    v_mfma_f32_16x16x32_bf16 v[48:51], v[208:211], v[128:131], v[48:51]
    ds_read_b64_tr_b16 v[232:233], v6 offset:49152
    s_waitcnt lgkmcnt(11)
    v_mfma_f32_16x16x32_bf16 v[48:51], v[212:215], v[132:135], v[48:51]
    ds_read_b64_tr_b16 v[234:235], v6 offset:53248
    s_waitcnt lgkmcnt(11)
    v_mfma_f32_16x16x32_bf16 v[64:67], v[212:215], v[140:143], v[64:67]
    ds_read_b64_tr_b16 v[236:237], v6 offset:57344
    s_waitcnt lgkmcnt(11)
    v_mfma_f32_16x16x32_bf16 v[64:67], v[208:211], v[136:139], v[64:67]
    ds_read_b64_tr_b16 v[238:239], v6 offset:61440
    s_waitcnt lgkmcnt(10)
    v_mfma_f32_16x16x32_bf16 v[68:71], v[216:219], v[136:139], v[68:71]
    s_waitcnt lgkmcnt(8)
    v_mfma_f32_16x16x32_bf16 v[68:71], v[220:223], v[140:143], v[68:71]
    v_mfma_f32_16x16x32_bf16 v[52:55], v[220:223], v[132:135], v[52:55]
    v_mfma_f32_16x16x32_bf16 v[52:55], v[216:219], v[128:131], v[52:55]
    v_mfma_f32_16x16x32_bf16 v[36:39], v[216:219], v[120:123], v[36:39]
    v_and_b32 v11, 7, v0
    v_lshlrev_b32 v11, 2, v11
    s_lshl_b32 s34, s28, 7
    s_add_u32 s34, s34, 16875520
    buffer_load_dword v12, v11, s[16:19], s34 offen sc1
    v_mfma_f32_16x16x32_bf16 v[36:39], v[220:223], v[124:127], v[36:39]
    v_mfma_f32_16x16x32_bf16 v[20:23], v[220:223], v[116:119], v[20:23]
    v_mfma_f32_16x16x32_bf16 v[20:23], v[216:219], v[112:115], v[20:23]
    s_waitcnt lgkmcnt(6)
    v_mfma_f32_16x16x32_bf16 v[24:27], v[224:227], v[112:115], v[24:27]
    s_waitcnt lgkmcnt(0)
    s_barrier
    v_mfma_f32_16x16x32_bf16 v[24:27], v[228:231], v[116:119], v[24:27]
    ds_read_b64_tr_b16 v[208:209], v3 offset:0
    ds_read_b64_tr_b16 v[210:211], v3 offset:4096
    v_mfma_f32_16x16x32_bf16 v[40:43], v[228:231], v[124:127], v[40:43]
    ds_read_b128 v[80:83], v1 offset:0
    v_mfma_f32_16x16x32_bf16 v[40:43], v[224:227], v[120:123], v[40:43]
    ds_read_b64_tr_b16 v[212:213], v3 offset:8192
    v_mfma_f32_16x16x32_bf16 v[56:59], v[224:227], v[128:131], v[56:59]
    ds_read_b64_tr_b16 v[214:215], v3 offset:12288
    v_mfma_f32_16x16x32_bf16 v[56:59], v[228:231], v[132:135], v[56:59]
    ds_read_b128 v[84:87], v2 offset:0
    v_mfma_f32_16x16x32_bf16 v[72:75], v[228:231], v[140:143], v[72:75]
    ds_read_b128 v[92:95], v2 offset:2048
    v_mfma_f32_16x16x32_bf16 v[72:75], v[224:227], v[136:139], v[72:75]
    ds_read_b128 v[88:91], v1 offset:2048
    v_mfma_f32_16x16x32_bf16 v[76:79], v[232:235], v[136:139], v[76:79]
    ds_read_b128 v[96:99], v1 offset:4096
    v_mfma_f32_16x16x32_bf16 v[76:79], v[236:239], v[140:143], v[76:79]
    ds_read_b128 v[100:103], v2 offset:4096
    v_mfma_f32_16x16x32_bf16 v[60:63], v[236:239], v[132:135], v[60:63]
    ds_read_b128 v[108:111], v2 offset:6144
    v_mfma_f32_16x16x32_bf16 v[60:63], v[232:235], v[128:131], v[60:63]
    ds_read_b128 v[104:107], v1 offset:6144
    v_mfma_f32_16x16x32_bf16 v[44:47], v[232:235], v[120:123], v[44:47]
    ds_read_b64_tr_b16 v[216:217], v4 offset:0
    v_mfma_f32_16x16x32_bf16 v[44:47], v[236:239], v[124:127], v[44:47]
    ds_read_b64_tr_b16 v[218:219], v4 offset:4096
    v_mfma_f32_16x16x32_bf16 v[28:31], v[236:239], v[116:119], v[28:31]
    ds_read_b64_tr_b16 v[220:221], v4 offset:8192
    v_mfma_f32_16x16x32_bf16 v[28:31], v[232:235], v[112:115], v[28:31]
    ds_read_b64_tr_b16 v[222:223], v4 offset:12288
    s_waitcnt lgkmcnt(13)
    v_mfma_f32_16x16x32_bf16 v[16:19], v[208:211], v[80:83], v[16:19]
    ds_read_b64_tr_b16 v[224:225], v5 offset:0
    s_waitcnt lgkmcnt(11)
    v_mfma_f32_16x16x32_bf16 v[16:19], v[212:215], v[84:87], v[16:19]
    ds_read_b64_tr_b16 v[226:227], v5 offset:4096
    s_waitcnt lgkmcnt(11)
    v_mfma_f32_16x16x32_bf16 v[32:35], v[212:215], v[92:95], v[32:35]
    ds_read_b64_tr_b16 v[228:229], v5 offset:8192
    s_waitcnt lgkmcnt(11)
    v_mfma_f32_16x16x32_bf16 v[32:35], v[208:211], v[88:91], v[32:35]
    ds_read_b64_tr_b16 v[230:231], v5 offset:12288
    s_waitcnt lgkmcnt(11)
    v_mfma_f32_16x16x32_bf16 v[48:51], v[208:211], v[96:99], v[48:51]
    ds_read_b64_tr_b16 v[232:233], v6 offset:0
    s_waitcnt lgkmcnt(11)
    v_mfma_f32_16x16x32_bf16 v[48:51], v[212:215], v[100:103], v[48:51]
    ds_read_b64_tr_b16 v[234:235], v6 offset:4096
    s_waitcnt lgkmcnt(11)
    v_mfma_f32_16x16x32_bf16 v[64:67], v[212:215], v[108:111], v[64:67]
    ds_read_b64_tr_b16 v[236:237], v6 offset:8192
    s_waitcnt lgkmcnt(11)
    v_mfma_f32_16x16x32_bf16 v[64:67], v[208:211], v[104:107], v[64:67]
    ds_read_b64_tr_b16 v[238:239], v6 offset:12288
    s_waitcnt lgkmcnt(10)
    v_mfma_f32_16x16x32_bf16 v[68:71], v[216:219], v[104:107], v[68:71]
    s_waitcnt lgkmcnt(8)
    v_mfma_f32_16x16x32_bf16 v[68:71], v[220:223], v[108:111], v[68:71]
    v_mfma_f32_16x16x32_bf16 v[52:55], v[220:223], v[100:103], v[52:55]
    v_mfma_f32_16x16x32_bf16 v[52:55], v[216:219], v[96:99], v[52:55]
    v_mfma_f32_16x16x32_bf16 v[36:39], v[216:219], v[88:91], v[36:39]
    v_mfma_f32_16x16x32_bf16 v[36:39], v[220:223], v[92:95], v[36:39]
    v_mfma_f32_16x16x32_bf16 v[20:23], v[220:223], v[84:87], v[20:23]
    v_mfma_f32_16x16x32_bf16 v[20:23], v[216:219], v[80:83], v[20:23]
    s_waitcnt lgkmcnt(6)
    v_mfma_f32_16x16x32_bf16 v[24:27], v[224:227], v[80:83], v[24:27]
    s_waitcnt lgkmcnt(0)
    s_barrier
    v_mfma_f32_16x16x32_bf16 v[24:27], v[228:231], v[84:87], v[24:27]
    ds_read_b64_tr_b16 v[208:209], v3 offset:16384
    ds_read_b64_tr_b16 v[210:211], v3 offset:20480
    v_mfma_f32_16x16x32_bf16 v[40:43], v[228:231], v[92:95], v[40:43]
    ds_read_b128 v[112:115], v1 offset:16384
    v_mfma_f32_16x16x32_bf16 v[40:43], v[224:227], v[88:91], v[40:43]
    ds_read_b64_tr_b16 v[212:213], v3 offset:24576
    v_mfma_f32_16x16x32_bf16 v[56:59], v[224:227], v[96:99], v[56:59]
    ds_read_b64_tr_b16 v[214:215], v3 offset:28672
    v_mfma_f32_16x16x32_bf16 v[56:59], v[228:231], v[100:103], v[56:59]
    ds_read_b128 v[116:119], v2 offset:16384
    v_mfma_f32_16x16x32_bf16 v[72:75], v[228:231], v[108:111], v[72:75]
    ds_read_b128 v[124:127], v2 offset:18432
    v_mfma_f32_16x16x32_bf16 v[72:75], v[224:227], v[104:107], v[72:75]
    ds_read_b128 v[120:123], v1 offset:18432
    v_mfma_f32_16x16x32_bf16 v[76:79], v[232:235], v[104:107], v[76:79]
    ds_read_b128 v[128:131], v1 offset:20480
    v_mfma_f32_16x16x32_bf16 v[76:79], v[236:239], v[108:111], v[76:79]
    ds_read_b128 v[132:135], v2 offset:20480
    v_mfma_f32_16x16x32_bf16 v[60:63], v[236:239], v[100:103], v[60:63]
    ds_read_b128 v[140:143], v2 offset:22528
    v_mfma_f32_16x16x32_bf16 v[60:63], v[232:235], v[96:99], v[60:63]
    ds_read_b128 v[136:139], v1 offset:22528
    v_mfma_f32_16x16x32_bf16 v[44:47], v[232:235], v[88:91], v[44:47]
    ds_read_b64_tr_b16 v[216:217], v4 offset:16384
    v_mfma_f32_16x16x32_bf16 v[44:47], v[236:239], v[92:95], v[44:47]
    ds_read_b64_tr_b16 v[218:219], v4 offset:20480
    v_mfma_f32_16x16x32_bf16 v[28:31], v[236:239], v[84:87], v[28:31]
    ds_read_b64_tr_b16 v[220:221], v4 offset:24576
    v_mfma_f32_16x16x32_bf16 v[28:31], v[232:235], v[80:83], v[28:31]
    ds_read_b64_tr_b16 v[222:223], v4 offset:28672
    s_waitcnt lgkmcnt(13)
    v_mfma_f32_16x16x32_bf16 v[16:19], v[208:211], v[112:115], v[16:19]
    ds_read_b64_tr_b16 v[224:225], v5 offset:16384
    s_waitcnt lgkmcnt(11)
    v_mfma_f32_16x16x32_bf16 v[16:19], v[212:215], v[116:119], v[16:19]
    ds_read_b64_tr_b16 v[226:227], v5 offset:20480
    s_waitcnt lgkmcnt(11)
    v_mfma_f32_16x16x32_bf16 v[32:35], v[212:215], v[124:127], v[32:35]
    ds_read_b64_tr_b16 v[228:229], v5 offset:24576
    s_waitcnt lgkmcnt(11)
    v_mfma_f32_16x16x32_bf16 v[32:35], v[208:211], v[120:123], v[32:35]
    ds_read_b64_tr_b16 v[230:231], v5 offset:28672
    s_waitcnt lgkmcnt(11)
    v_mfma_f32_16x16x32_bf16 v[48:51], v[208:211], v[128:131], v[48:51]
    ds_read_b64_tr_b16 v[232:233], v6 offset:16384
    s_waitcnt lgkmcnt(11)
    v_mfma_f32_16x16x32_bf16 v[48:51], v[212:215], v[132:135], v[48:51]
    ds_read_b64_tr_b16 v[234:235], v6 offset:20480
    s_waitcnt lgkmcnt(11)
    v_mfma_f32_16x16x32_bf16 v[64:67], v[212:215], v[140:143], v[64:67]
    ds_read_b64_tr_b16 v[236:237], v6 offset:24576
    s_waitcnt lgkmcnt(11)
    v_mfma_f32_16x16x32_bf16 v[64:67], v[208:211], v[136:139], v[64:67]
    ds_read_b64_tr_b16 v[238:239], v6 offset:28672
    s_waitcnt lgkmcnt(10)
    v_mfma_f32_16x16x32_bf16 v[68:71], v[216:219], v[136:139], v[68:71]
    s_waitcnt lgkmcnt(8)
    v_mfma_f32_16x16x32_bf16 v[68:71], v[220:223], v[140:143], v[68:71]
    v_mfma_f32_16x16x32_bf16 v[52:55], v[220:223], v[132:135], v[52:55]
    v_mfma_f32_16x16x32_bf16 v[52:55], v[216:219], v[128:131], v[52:55]
    v_mfma_f32_16x16x32_bf16 v[36:39], v[216:219], v[120:123], v[36:39]
    s_waitcnt vmcnt(0)
    v_cmp_eq_u32 vcc, s75, v12
    s_nop 1
    s_cmp_eq_u64 vcc, -1
    s_cselect_b32 s74, 1, 0
    v_mfma_f32_16x16x32_bf16 v[36:39], v[220:223], v[124:127], v[36:39]
    v_mfma_f32_16x16x32_bf16 v[20:23], v[220:223], v[116:119], v[20:23]
    v_mfma_f32_16x16x32_bf16 v[20:23], v[216:219], v[112:115], v[20:23]
    s_waitcnt lgkmcnt(6)
    v_mfma_f32_16x16x32_bf16 v[24:27], v[224:227], v[112:115], v[24:27]
    s_waitcnt lgkmcnt(0)
    s_barrier
    v_mfma_f32_16x16x32_bf16 v[24:27], v[228:231], v[116:119], v[24:27]
    ds_read_b64_tr_b16 v[208:209], v3 offset:32768
    ds_read_b64_tr_b16 v[210:211], v3 offset:36864
    v_mfma_f32_16x16x32_bf16 v[40:43], v[228:231], v[124:127], v[40:43]
    ds_read_b128 v[80:83], v1 offset:32768
    v_mfma_f32_16x16x32_bf16 v[40:43], v[224:227], v[120:123], v[40:43]
    ds_read_b64_tr_b16 v[212:213], v3 offset:40960
    v_mfma_f32_16x16x32_bf16 v[56:59], v[224:227], v[128:131], v[56:59]
    ds_read_b64_tr_b16 v[214:215], v3 offset:45056
    v_mfma_f32_16x16x32_bf16 v[56:59], v[228:231], v[132:135], v[56:59]
    ds_read_b128 v[84:87], v2 offset:32768
    v_mfma_f32_16x16x32_bf16 v[72:75], v[228:231], v[140:143], v[72:75]
    ds_read_b128 v[92:95], v2 offset:34816
    v_mfma_f32_16x16x32_bf16 v[72:75], v[224:227], v[136:139], v[72:75]
    ds_read_b128 v[88:91], v1 offset:34816
    v_mfma_f32_16x16x32_bf16 v[76:79], v[232:235], v[136:139], v[76:79]
    ds_read_b128 v[96:99], v1 offset:36864
    v_mfma_f32_16x16x32_bf16 v[76:79], v[236:239], v[140:143], v[76:79]
    ds_read_b128 v[100:103], v2 offset:36864
    v_mfma_f32_16x16x32_bf16 v[60:63], v[236:239], v[132:135], v[60:63]
    ds_read_b128 v[108:111], v2 offset:38912
    v_mfma_f32_16x16x32_bf16 v[60:63], v[232:235], v[128:131], v[60:63]
    ds_read_b128 v[104:107], v1 offset:38912
    v_mfma_f32_16x16x32_bf16 v[44:47], v[232:235], v[120:123], v[44:47]
    ds_read_b64_tr_b16 v[216:217], v4 offset:32768
    v_mfma_f32_16x16x32_bf16 v[44:47], v[236:239], v[124:127], v[44:47]
    ds_read_b64_tr_b16 v[218:219], v4 offset:36864
    v_mfma_f32_16x16x32_bf16 v[28:31], v[236:239], v[116:119], v[28:31]
    ds_read_b64_tr_b16 v[220:221], v4 offset:40960
    v_mfma_f32_16x16x32_bf16 v[28:31], v[232:235], v[112:115], v[28:31]
    ds_read_b64_tr_b16 v[222:223], v4 offset:45056
    s_waitcnt lgkmcnt(13)
    v_mfma_f32_16x16x32_bf16 v[16:19], v[208:211], v[80:83], v[16:19]
    ds_read_b64_tr_b16 v[224:225], v5 offset:32768
    s_waitcnt lgkmcnt(11)
    v_mfma_f32_16x16x32_bf16 v[16:19], v[212:215], v[84:87], v[16:19]
    ds_read_b64_tr_b16 v[226:227], v5 offset:36864
    s_waitcnt lgkmcnt(11)
    v_mfma_f32_16x16x32_bf16 v[32:35], v[212:215], v[92:95], v[32:35]
    ds_read_b64_tr_b16 v[228:229], v5 offset:40960
    s_waitcnt lgkmcnt(11)
    v_mfma_f32_16x16x32_bf16 v[32:35], v[208:211], v[88:91], v[32:35]
    ds_read_b64_tr_b16 v[230:231], v5 offset:45056
    s_waitcnt lgkmcnt(11)
    v_mfma_f32_16x16x32_bf16 v[48:51], v[208:211], v[96:99], v[48:51]
    ds_read_b64_tr_b16 v[232:233], v6 offset:32768
    s_waitcnt lgkmcnt(11)
    v_mfma_f32_16x16x32_bf16 v[48:51], v[212:215], v[100:103], v[48:51]
    ds_read_b64_tr_b16 v[234:235], v6 offset:36864
    s_waitcnt lgkmcnt(11)
    v_mfma_f32_16x16x32_bf16 v[64:67], v[212:215], v[108:111], v[64:67]
    ds_read_b64_tr_b16 v[236:237], v6 offset:40960
    s_waitcnt lgkmcnt(11)
    v_mfma_f32_16x16x32_bf16 v[64:67], v[208:211], v[104:107], v[64:67]
    ds_read_b64_tr_b16 v[238:239], v6 offset:45056
    s_waitcnt lgkmcnt(10)
    v_mfma_f32_16x16x32_bf16 v[68:71], v[216:219], v[104:107], v[68:71]
    s_waitcnt lgkmcnt(8)
    v_mfma_f32_16x16x32_bf16 v[68:71], v[220:223], v[108:111], v[68:71]
    v_mfma_f32_16x16x32_bf16 v[52:55], v[220:223], v[100:103], v[52:55]
    v_mfma_f32_16x16x32_bf16 v[52:55], v[216:219], v[96:99], v[52:55]
    v_mfma_f32_16x16x32_bf16 v[36:39], v[216:219], v[88:91], v[36:39]
    v_mfma_f32_16x16x32_bf16 v[36:39], v[220:223], v[92:95], v[36:39]
    v_mfma_f32_16x16x32_bf16 v[20:23], v[220:223], v[84:87], v[20:23]
    v_mfma_f32_16x16x32_bf16 v[20:23], v[216:219], v[80:83], v[20:23]
    s_waitcnt lgkmcnt(6)
    v_mfma_f32_16x16x32_bf16 v[24:27], v[224:227], v[80:83], v[24:27]
    s_waitcnt lgkmcnt(0)
    s_barrier
    v_mfma_f32_16x16x32_bf16 v[24:27], v[228:231], v[84:87], v[24:27]
    ds_read_b64_tr_b16 v[208:209], v3 offset:49152
    ds_read_b64_tr_b16 v[210:211], v3 offset:53248
    v_mfma_f32_16x16x32_bf16 v[40:43], v[228:231], v[92:95], v[40:43]
    ds_read_b128 v[112:115], v1 offset:49152
    v_mfma_f32_16x16x32_bf16 v[40:43], v[224:227], v[88:91], v[40:43]
    ds_read_b64_tr_b16 v[212:213], v3 offset:57344
    v_mfma_f32_16x16x32_bf16 v[56:59], v[224:227], v[96:99], v[56:59]
    ds_read_b64_tr_b16 v[214:215], v3 offset:61440
    v_mfma_f32_16x16x32_bf16 v[56:59], v[228:231], v[100:103], v[56:59]
    ds_read_b128 v[116:119], v2 offset:49152
    v_mfma_f32_16x16x32_bf16 v[72:75], v[228:231], v[108:111], v[72:75]
    ds_read_b128 v[124:127], v2 offset:51200
    v_mfma_f32_16x16x32_bf16 v[72:75], v[224:227], v[104:107], v[72:75]
    ds_read_b128 v[120:123], v1 offset:51200
    v_mfma_f32_16x16x32_bf16 v[76:79], v[232:235], v[104:107], v[76:79]
    ds_read_b128 v[128:131], v1 offset:53248
    v_mfma_f32_16x16x32_bf16 v[76:79], v[236:239], v[108:111], v[76:79]
    ds_read_b128 v[132:135], v2 offset:53248
    v_mfma_f32_16x16x32_bf16 v[60:63], v[236:239], v[100:103], v[60:63]
    ds_read_b128 v[140:143], v2 offset:55296
    v_mfma_f32_16x16x32_bf16 v[60:63], v[232:235], v[96:99], v[60:63]
    ds_read_b128 v[136:139], v1 offset:55296
    v_mfma_f32_16x16x32_bf16 v[44:47], v[232:235], v[88:91], v[44:47]
    ds_read_b64_tr_b16 v[216:217], v4 offset:49152
    v_mfma_f32_16x16x32_bf16 v[44:47], v[236:239], v[92:95], v[44:47]
    ds_read_b64_tr_b16 v[218:219], v4 offset:53248
    v_mfma_f32_16x16x32_bf16 v[28:31], v[236:239], v[84:87], v[28:31]
    ds_read_b64_tr_b16 v[220:221], v4 offset:57344
    v_mfma_f32_16x16x32_bf16 v[28:31], v[232:235], v[80:83], v[28:31]
    ds_read_b64_tr_b16 v[222:223], v4 offset:61440
    s_waitcnt lgkmcnt(13)
    v_mfma_f32_16x16x32_bf16 v[16:19], v[208:211], v[112:115], v[16:19]
    ds_read_b64_tr_b16 v[224:225], v5 offset:49152
    s_waitcnt lgkmcnt(11)
    v_mfma_f32_16x16x32_bf16 v[16:19], v[212:215], v[116:119], v[16:19]
    ds_read_b64_tr_b16 v[226:227], v5 offset:53248
    s_waitcnt lgkmcnt(11)
    v_mfma_f32_16x16x32_bf16 v[32:35], v[212:215], v[124:127], v[32:35]
    ds_read_b64_tr_b16 v[228:229], v5 offset:57344
    s_waitcnt lgkmcnt(11)
    v_mfma_f32_16x16x32_bf16 v[32:35], v[208:211], v[120:123], v[32:35]
    ds_read_b64_tr_b16 v[230:231], v5 offset:61440
    s_waitcnt lgkmcnt(11)
    v_mfma_f32_16x16x32_bf16 v[48:51], v[208:211], v[128:131], v[48:51]
    ds_read_b64_tr_b16 v[232:233], v6 offset:49152
    s_waitcnt lgkmcnt(11)
    v_mfma_f32_16x16x32_bf16 v[48:51], v[212:215], v[132:135], v[48:51]
    ds_read_b64_tr_b16 v[234:235], v6 offset:53248
    s_waitcnt lgkmcnt(11)
    v_mfma_f32_16x16x32_bf16 v[64:67], v[212:215], v[140:143], v[64:67]
    ds_read_b64_tr_b16 v[236:237], v6 offset:57344
    s_waitcnt lgkmcnt(11)
    v_mfma_f32_16x16x32_bf16 v[64:67], v[208:211], v[136:139], v[64:67]
    ds_read_b64_tr_b16 v[238:239], v6 offset:61440
    s_waitcnt lgkmcnt(10)
    v_mfma_f32_16x16x32_bf16 v[68:71], v[216:219], v[136:139], v[68:71]
    s_waitcnt lgkmcnt(8)
    v_mfma_f32_16x16x32_bf16 v[68:71], v[220:223], v[140:143], v[68:71]
    v_mfma_f32_16x16x32_bf16 v[52:55], v[220:223], v[132:135], v[52:55]
    v_mfma_f32_16x16x32_bf16 v[52:55], v[216:219], v[128:131], v[52:55]
    v_mfma_f32_16x16x32_bf16 v[36:39], v[216:219], v[120:123], v[36:39]
    v_mfma_f32_16x16x32_bf16 v[36:39], v[220:223], v[124:127], v[36:39]
    v_mfma_f32_16x16x32_bf16 v[20:23], v[220:223], v[116:119], v[20:23]
    v_mfma_f32_16x16x32_bf16 v[20:23], v[216:219], v[112:115], v[20:23]
    s_waitcnt lgkmcnt(6)
    v_mfma_f32_16x16x32_bf16 v[24:27], v[224:227], v[112:115], v[24:27]
    s_waitcnt lgkmcnt(0)
    s_barrier
    v_mfma_f32_16x16x32_bf16 v[24:27], v[228:231], v[116:119], v[24:27]
    ds_read_b64_tr_b16 v[208:209], v3 offset:0
    ds_read_b64_tr_b16 v[210:211], v3 offset:4096
    v_mfma_f32_16x16x32_bf16 v[40:43], v[228:231], v[124:127], v[40:43]
    ds_read_b128 v[80:83], v1 offset:0
    v_mfma_f32_16x16x32_bf16 v[40:43], v[224:227], v[120:123], v[40:43]
    ds_read_b64_tr_b16 v[212:213], v3 offset:8192
    v_mfma_f32_16x16x32_bf16 v[56:59], v[224:227], v[128:131], v[56:59]
    ds_read_b64_tr_b16 v[214:215], v3 offset:12288
    v_mfma_f32_16x16x32_bf16 v[56:59], v[228:231], v[132:135], v[56:59]
    ds_read_b128 v[84:87], v2 offset:0
    v_mfma_f32_16x16x32_bf16 v[72:75], v[228:231], v[140:143], v[72:75]
    ds_read_b128 v[92:95], v2 offset:2048
    v_mfma_f32_16x16x32_bf16 v[72:75], v[224:227], v[136:139], v[72:75]
    ds_read_b128 v[88:91], v1 offset:2048
    v_mfma_f32_16x16x32_bf16 v[76:79], v[232:235], v[136:139], v[76:79]
    ds_read_b128 v[96:99], v1 offset:4096
    v_mfma_f32_16x16x32_bf16 v[76:79], v[236:239], v[140:143], v[76:79]
    ds_read_b128 v[100:103], v2 offset:4096
    v_mfma_f32_16x16x32_bf16 v[60:63], v[236:239], v[132:135], v[60:63]
    ds_read_b128 v[108:111], v2 offset:6144
    v_mfma_f32_16x16x32_bf16 v[60:63], v[232:235], v[128:131], v[60:63]
    ds_read_b128 v[104:107], v1 offset:6144
    v_mfma_f32_16x16x32_bf16 v[44:47], v[232:235], v[120:123], v[44:47]
    ds_read_b64_tr_b16 v[216:217], v4 offset:0
    v_mfma_f32_16x16x32_bf16 v[44:47], v[236:239], v[124:127], v[44:47]
    ds_read_b64_tr_b16 v[218:219], v4 offset:4096
    v_mfma_f32_16x16x32_bf16 v[28:31], v[236:239], v[116:119], v[28:31]
    ds_read_b64_tr_b16 v[220:221], v4 offset:8192
    v_mfma_f32_16x16x32_bf16 v[28:31], v[232:235], v[112:115], v[28:31]
    ds_read_b64_tr_b16 v[222:223], v4 offset:12288
    s_waitcnt lgkmcnt(13)
    v_mfma_f32_16x16x32_bf16 v[16:19], v[208:211], v[80:83], v[16:19]
    ds_read_b64_tr_b16 v[224:225], v5 offset:0
    s_waitcnt lgkmcnt(11)
    v_mfma_f32_16x16x32_bf16 v[16:19], v[212:215], v[84:87], v[16:19]
    ds_read_b64_tr_b16 v[226:227], v5 offset:4096
    s_waitcnt lgkmcnt(11)
    v_mfma_f32_16x16x32_bf16 v[32:35], v[212:215], v[92:95], v[32:35]
    ds_read_b64_tr_b16 v[228:229], v5 offset:8192
    s_waitcnt lgkmcnt(11)
    v_mfma_f32_16x16x32_bf16 v[32:35], v[208:211], v[88:91], v[32:35]
    ds_read_b64_tr_b16 v[230:231], v5 offset:12288
    s_waitcnt lgkmcnt(11)
    v_mfma_f32_16x16x32_bf16 v[48:51], v[208:211], v[96:99], v[48:51]
    ds_read_b64_tr_b16 v[232:233], v6 offset:0
    s_waitcnt lgkmcnt(11)
    v_mfma_f32_16x16x32_bf16 v[48:51], v[212:215], v[100:103], v[48:51]
    ds_read_b64_tr_b16 v[234:235], v6 offset:4096
    s_waitcnt lgkmcnt(11)
    v_mfma_f32_16x16x32_bf16 v[64:67], v[212:215], v[108:111], v[64:67]
    ds_read_b64_tr_b16 v[236:237], v6 offset:8192
    s_waitcnt lgkmcnt(11)
    v_mfma_f32_16x16x32_bf16 v[64:67], v[208:211], v[104:107], v[64:67]
    ds_read_b64_tr_b16 v[238:239], v6 offset:12288
    s_waitcnt lgkmcnt(10)
    v_mfma_f32_16x16x32_bf16 v[68:71], v[216:219], v[104:107], v[68:71]
    s_waitcnt lgkmcnt(8)
    v_mfma_f32_16x16x32_bf16 v[68:71], v[220:223], v[108:111], v[68:71]
    v_mfma_f32_16x16x32_bf16 v[52:55], v[220:223], v[100:103], v[52:55]
    s_lshl_b32 s34, s30, 13
    s_lshl_b32 s35, s31, 14
    s_add_u32 s35, s35, s34
    v_add_u32 v7, s35, v8
    v_mfma_f32_16x16x32_bf16 v[52:55], v[216:219], v[96:99], v[52:55]
    v_mfma_f32_16x16x32_bf16 v[36:39], v[216:219], v[88:91], v[36:39]
    v_mfma_f32_16x16x32_bf16 v[36:39], v[220:223], v[92:95], v[36:39]
    v_mfma_f32_16x16x32_bf16 v[20:23], v[220:223], v[84:87], v[20:23]
    v_mfma_f32_16x16x32_bf16 v[20:23], v[216:219], v[80:83], v[20:23]
    s_waitcnt lgkmcnt(6)
    v_mfma_f32_16x16x32_bf16 v[24:27], v[224:227], v[80:83], v[24:27]
    s_waitcnt lgkmcnt(0)
    s_barrier
    v_mfma_f32_16x16x32_bf16 v[24:27], v[228:231], v[84:87], v[24:27]
    ds_read_b64_tr_b16 v[208:209], v3 offset:16384
    ds_read_b64_tr_b16 v[210:211], v3 offset:20480
    v_mfma_f32_16x16x32_bf16 v[40:43], v[228:231], v[92:95], v[40:43]
    ds_read_b128 v[112:115], v1 offset:16384
    v_mfma_f32_16x16x32_bf16 v[40:43], v[224:227], v[88:91], v[40:43]
    ds_read_b64_tr_b16 v[212:213], v3 offset:24576
    v_mfma_f32_16x16x32_bf16 v[56:59], v[224:227], v[96:99], v[56:59]
    ds_read_b64_tr_b16 v[214:215], v3 offset:28672
    v_mfma_f32_16x16x32_bf16 v[56:59], v[228:231], v[100:103], v[56:59]
    ds_read_b128 v[116:119], v2 offset:16384
    v_mfma_f32_16x16x32_bf16 v[72:75], v[228:231], v[108:111], v[72:75]
    ds_read_b128 v[124:127], v2 offset:18432
    v_mfma_f32_16x16x32_bf16 v[72:75], v[224:227], v[104:107], v[72:75]
    ds_read_b128 v[120:123], v1 offset:18432
    v_mfma_f32_16x16x32_bf16 v[76:79], v[232:235], v[104:107], v[76:79]
    ds_read_b128 v[128:131], v1 offset:20480
    v_mfma_f32_16x16x32_bf16 v[76:79], v[236:239], v[108:111], v[76:79]
    ds_read_b128 v[132:135], v2 offset:20480
    v_mfma_f32_16x16x32_bf16 v[60:63], v[236:239], v[100:103], v[60:63]
    ds_read_b128 v[140:143], v2 offset:22528
    v_mfma_f32_16x16x32_bf16 v[60:63], v[232:235], v[96:99], v[60:63]
    ds_read_b128 v[136:139], v1 offset:22528
    v_mfma_f32_16x16x32_bf16 v[44:47], v[232:235], v[88:91], v[44:47]
    ds_read_b64_tr_b16 v[216:217], v4 offset:16384
    v_mfma_f32_16x16x32_bf16 v[44:47], v[236:239], v[92:95], v[44:47]
    ds_read_b64_tr_b16 v[218:219], v4 offset:20480
    v_mfma_f32_16x16x32_bf16 v[28:31], v[236:239], v[84:87], v[28:31]
    ds_read_b64_tr_b16 v[220:221], v4 offset:24576
    v_mfma_f32_16x16x32_bf16 v[28:31], v[232:235], v[80:83], v[28:31]
    ds_read_b64_tr_b16 v[222:223], v4 offset:28672
    s_waitcnt lgkmcnt(13)
    v_mfma_f32_16x16x32_bf16 v[16:19], v[208:211], v[112:115], v[16:19]
    ds_read_b64_tr_b16 v[224:225], v5 offset:16384
    s_waitcnt lgkmcnt(11)
    v_mfma_f32_16x16x32_bf16 v[16:19], v[212:215], v[116:119], v[16:19]
    ds_read_b64_tr_b16 v[226:227], v5 offset:20480
    s_waitcnt lgkmcnt(11)
    v_mfma_f32_16x16x32_bf16 v[32:35], v[212:215], v[124:127], v[32:35]
    ds_read_b64_tr_b16 v[228:229], v5 offset:24576
    s_waitcnt lgkmcnt(11)
    v_mfma_f32_16x16x32_bf16 v[32:35], v[208:211], v[120:123], v[32:35]
    ds_read_b64_tr_b16 v[230:231], v5 offset:28672
    s_waitcnt lgkmcnt(11)
    v_mfma_f32_16x16x32_bf16 v[48:51], v[208:211], v[128:131], v[48:51]
    ds_read_b64_tr_b16 v[232:233], v6 offset:16384
    s_waitcnt lgkmcnt(11)
    v_mfma_f32_16x16x32_bf16 v[48:51], v[212:215], v[132:135], v[48:51]
    ds_read_b64_tr_b16 v[234:235], v6 offset:20480
    s_waitcnt lgkmcnt(11)
    v_mfma_f32_16x16x32_bf16 v[64:67], v[212:215], v[140:143], v[64:67]
    ds_read_b64_tr_b16 v[236:237], v6 offset:24576
    s_waitcnt lgkmcnt(11)
    v_mfma_f32_16x16x32_bf16 v[64:67], v[208:211], v[136:139], v[64:67]
    ds_read_b64_tr_b16 v[238:239], v6 offset:28672
    s_waitcnt lgkmcnt(10)
    v_mfma_f32_16x16x32_bf16 v[68:71], v[216:219], v[136:139], v[68:71]
    s_waitcnt lgkmcnt(8)
    v_mfma_f32_16x16x32_bf16 v[68:71], v[220:223], v[140:143], v[68:71]
    v_mfma_f32_16x16x32_bf16 v[52:55], v[220:223], v[132:135], v[52:55]
    v_mfma_f32_16x16x32_bf16 v[52:55], v[216:219], v[128:131], v[52:55]
    v_mfma_f32_16x16x32_bf16 v[36:39], v[216:219], v[120:123], v[36:39]
    v_mfma_f32_16x16x32_bf16 v[36:39], v[220:223], v[124:127], v[36:39]
    v_mfma_f32_16x16x32_bf16 v[20:23], v[220:223], v[116:119], v[20:23]
    v_mfma_f32_16x16x32_bf16 v[20:23], v[216:219], v[112:115], v[20:23]
    s_waitcnt lgkmcnt(6)
    v_mfma_f32_16x16x32_bf16 v[24:27], v[224:227], v[112:115], v[24:27]
    s_waitcnt lgkmcnt(0)
    s_barrier
    v_mfma_f32_16x16x32_bf16 v[24:27], v[228:231], v[116:119], v[24:27]
    ds_read_b64_tr_b16 v[208:209], v3 offset:32768
    ds_read_b64_tr_b16 v[210:211], v3 offset:36864
    v_mfma_f32_16x16x32_bf16 v[40:43], v[228:231], v[124:127], v[40:43]
    ds_read_b128 v[80:83], v1 offset:32768
    v_mfma_f32_16x16x32_bf16 v[40:43], v[224:227], v[120:123], v[40:43]
    ds_read_b64_tr_b16 v[212:213], v3 offset:40960
    v_mfma_f32_16x16x32_bf16 v[56:59], v[224:227], v[128:131], v[56:59]
    ds_read_b64_tr_b16 v[214:215], v3 offset:45056
    v_mfma_f32_16x16x32_bf16 v[56:59], v[228:231], v[132:135], v[56:59]
    ds_read_b128 v[84:87], v2 offset:32768
    v_mfma_f32_16x16x32_bf16 v[72:75], v[228:231], v[140:143], v[72:75]
    ds_read_b128 v[92:95], v2 offset:34816
    v_mfma_f32_16x16x32_bf16 v[72:75], v[224:227], v[136:139], v[72:75]
    ds_read_b128 v[88:91], v1 offset:34816
    v_mfma_f32_16x16x32_bf16 v[76:79], v[232:235], v[136:139], v[76:79]
    ds_read_b128 v[96:99], v1 offset:36864
    v_mfma_f32_16x16x32_bf16 v[76:79], v[236:239], v[140:143], v[76:79]
    ds_read_b128 v[100:103], v2 offset:36864
    v_mfma_f32_16x16x32_bf16 v[60:63], v[236:239], v[132:135], v[60:63]
    ds_read_b128 v[108:111], v2 offset:38912
    v_mfma_f32_16x16x32_bf16 v[60:63], v[232:235], v[128:131], v[60:63]
    ds_read_b128 v[104:107], v1 offset:38912
    v_mfma_f32_16x16x32_bf16 v[44:47], v[232:235], v[120:123], v[44:47]
    ds_read_b64_tr_b16 v[216:217], v4 offset:32768
    v_mfma_f32_16x16x32_bf16 v[44:47], v[236:239], v[124:127], v[44:47]
    ds_read_b64_tr_b16 v[218:219], v4 offset:36864
    v_mfma_f32_16x16x32_bf16 v[28:31], v[236:239], v[116:119], v[28:31]
    ds_read_b64_tr_b16 v[220:221], v4 offset:40960
    v_mfma_f32_16x16x32_bf16 v[28:31], v[232:235], v[112:115], v[28:31]
    ds_read_b64_tr_b16 v[222:223], v4 offset:45056
    s_waitcnt lgkmcnt(13)
    v_mfma_f32_16x16x32_bf16 v[16:19], v[208:211], v[80:83], v[16:19]
    ds_read_b64_tr_b16 v[224:225], v5 offset:32768
    s_waitcnt lgkmcnt(11)
    v_mfma_f32_16x16x32_bf16 v[16:19], v[212:215], v[84:87], v[16:19]
    ds_read_b64_tr_b16 v[226:227], v5 offset:36864
    s_waitcnt lgkmcnt(11)
    v_mfma_f32_16x16x32_bf16 v[32:35], v[212:215], v[92:95], v[32:35]
    ds_read_b64_tr_b16 v[228:229], v5 offset:40960
    s_waitcnt lgkmcnt(11)
    v_mfma_f32_16x16x32_bf16 v[32:35], v[208:211], v[88:91], v[32:35]
    ds_read_b64_tr_b16 v[230:231], v5 offset:45056
    s_waitcnt lgkmcnt(11)
    v_mfma_f32_16x16x32_bf16 v[48:51], v[208:211], v[96:99], v[48:51]
    ds_read_b64_tr_b16 v[232:233], v6 offset:32768
    s_waitcnt lgkmcnt(11)
    v_mfma_f32_16x16x32_bf16 v[48:51], v[212:215], v[100:103], v[48:51]
    ds_read_b64_tr_b16 v[234:235], v6 offset:36864
    s_waitcnt lgkmcnt(11)
    v_mfma_f32_16x16x32_bf16 v[64:67], v[212:215], v[108:111], v[64:67]
    ds_read_b64_tr_b16 v[236:237], v6 offset:40960
    s_waitcnt lgkmcnt(11)
    v_mfma_f32_16x16x32_bf16 v[64:67], v[208:211], v[104:107], v[64:67]
    ds_read_b64_tr_b16 v[238:239], v6 offset:45056
    s_waitcnt lgkmcnt(10)
    v_mfma_f32_16x16x32_bf16 v[68:71], v[216:219], v[104:107], v[68:71]
    s_waitcnt lgkmcnt(8)
    v_mfma_f32_16x16x32_bf16 v[68:71], v[220:223], v[108:111], v[68:71]
    v_mfma_f32_16x16x32_bf16 v[52:55], v[220:223], v[100:103], v[52:55]
    v_mfma_f32_16x16x32_bf16 v[52:55], v[216:219], v[96:99], v[52:55]
    v_mfma_f32_16x16x32_bf16 v[36:39], v[216:219], v[88:91], v[36:39]
    v_mfma_f32_16x16x32_bf16 v[36:39], v[220:223], v[92:95], v[36:39]
    v_mfma_f32_16x16x32_bf16 v[20:23], v[220:223], v[84:87], v[20:23]
    v_mfma_f32_16x16x32_bf16 v[20:23], v[216:219], v[80:83], v[20:23]
    s_waitcnt lgkmcnt(6)
    v_mfma_f32_16x16x32_bf16 v[24:27], v[224:227], v[80:83], v[24:27]
    s_waitcnt lgkmcnt(0)
    s_barrier
    v_mfma_f32_16x16x32_bf16 v[24:27], v[228:231], v[84:87], v[24:27]
    ds_read_b64_tr_b16 v[208:209], v3 offset:49152
    ds_read_b64_tr_b16 v[210:211], v3 offset:53248
    v_mfma_f32_16x16x32_bf16 v[40:43], v[228:231], v[92:95], v[40:43]
    ds_read_b128 v[112:115], v1 offset:49152
    v_mfma_f32_16x16x32_bf16 v[40:43], v[224:227], v[88:91], v[40:43]
    ds_read_b64_tr_b16 v[212:213], v3 offset:57344
    v_mfma_f32_16x16x32_bf16 v[56:59], v[224:227], v[96:99], v[56:59]
    ds_read_b64_tr_b16 v[214:215], v3 offset:61440
    v_mfma_f32_16x16x32_bf16 v[56:59], v[228:231], v[100:103], v[56:59]
    ds_read_b128 v[116:119], v2 offset:49152
    v_mfma_f32_16x16x32_bf16 v[72:75], v[228:231], v[108:111], v[72:75]
    ds_read_b128 v[124:127], v2 offset:51200
    v_mfma_f32_16x16x32_bf16 v[72:75], v[224:227], v[104:107], v[72:75]
    ds_read_b128 v[120:123], v1 offset:51200
    v_mfma_f32_16x16x32_bf16 v[76:79], v[232:235], v[104:107], v[76:79]
    ds_read_b128 v[128:131], v1 offset:53248
    v_mfma_f32_16x16x32_bf16 v[76:79], v[236:239], v[108:111], v[76:79]
    ds_read_b128 v[132:135], v2 offset:53248
    v_mfma_f32_16x16x32_bf16 v[60:63], v[236:239], v[100:103], v[60:63]
    ds_read_b128 v[140:143], v2 offset:55296
    v_mfma_f32_16x16x32_bf16 v[60:63], v[232:235], v[96:99], v[60:63]
    ds_read_b128 v[136:139], v1 offset:55296
    v_mfma_f32_16x16x32_bf16 v[44:47], v[232:235], v[88:91], v[44:47]
    ds_read_b64_tr_b16 v[216:217], v4 offset:49152
    v_mfma_f32_16x16x32_bf16 v[44:47], v[236:239], v[92:95], v[44:47]
    ds_read_b64_tr_b16 v[218:219], v4 offset:53248
    v_mfma_f32_16x16x32_bf16 v[28:31], v[236:239], v[84:87], v[28:31]
    ds_read_b64_tr_b16 v[220:221], v4 offset:57344
    v_mfma_f32_16x16x32_bf16 v[28:31], v[232:235], v[80:83], v[28:31]
    ds_read_b64_tr_b16 v[222:223], v4 offset:61440
    s_waitcnt lgkmcnt(13)
    v_mfma_f32_16x16x32_bf16 v[16:19], v[208:211], v[112:115], v[16:19]
    ds_read_b64_tr_b16 v[224:225], v5 offset:49152
    s_waitcnt lgkmcnt(11)
    v_mfma_f32_16x16x32_bf16 v[16:19], v[212:215], v[116:119], v[16:19]
    ds_read_b64_tr_b16 v[226:227], v5 offset:53248
    s_waitcnt lgkmcnt(11)
    v_mfma_f32_16x16x32_bf16 v[32:35], v[212:215], v[124:127], v[32:35]
    ds_read_b64_tr_b16 v[228:229], v5 offset:57344
    s_waitcnt lgkmcnt(11)
    v_mfma_f32_16x16x32_bf16 v[32:35], v[208:211], v[120:123], v[32:35]
    ds_read_b64_tr_b16 v[230:231], v5 offset:61440
    s_waitcnt lgkmcnt(11)
    v_mfma_f32_16x16x32_bf16 v[48:51], v[208:211], v[128:131], v[48:51]
    ds_read_b64_tr_b16 v[232:233], v6 offset:49152
    s_waitcnt lgkmcnt(11)
    v_mfma_f32_16x16x32_bf16 v[48:51], v[212:215], v[132:135], v[48:51]
    ds_read_b64_tr_b16 v[234:235], v6 offset:53248
    s_waitcnt lgkmcnt(11)
    v_mfma_f32_16x16x32_bf16 v[64:67], v[212:215], v[140:143], v[64:67]
    ds_read_b64_tr_b16 v[236:237], v6 offset:57344
    s_waitcnt lgkmcnt(11)
    v_mfma_f32_16x16x32_bf16 v[64:67], v[208:211], v[136:139], v[64:67]
    ds_read_b64_tr_b16 v[238:239], v6 offset:61440
    s_waitcnt lgkmcnt(10)
    v_mfma_f32_16x16x32_bf16 v[68:71], v[216:219], v[136:139], v[68:71]
    s_waitcnt lgkmcnt(8)
    v_mfma_f32_16x16x32_bf16 v[68:71], v[220:223], v[140:143], v[68:71]
    v_mfma_f32_16x16x32_bf16 v[52:55], v[220:223], v[132:135], v[52:55]
    v_mfma_f32_16x16x32_bf16 v[52:55], v[216:219], v[128:131], v[52:55]
    v_mfma_f32_16x16x32_bf16 v[36:39], v[216:219], v[120:123], v[36:39]
    v_mfma_f32_16x16x32_bf16 v[36:39], v[220:223], v[124:127], v[36:39]
    v_mfma_f32_16x16x32_bf16 v[20:23], v[220:223], v[116:119], v[20:23]
    v_mfma_f32_16x16x32_bf16 v[20:23], v[216:219], v[112:115], v[20:23]
    s_waitcnt lgkmcnt(6)
    v_mfma_f32_16x16x32_bf16 v[24:27], v[224:227], v[112:115], v[24:27]
    s_waitcnt lgkmcnt(0)
    s_barrier
    v_mfma_f32_16x16x32_bf16 v[24:27], v[228:231], v[116:119], v[24:27]
    ds_read_b64_tr_b16 v[208:209], v3 offset:0
    v_mfma_f32_16x16x32_bf16 v[40:43], v[228:231], v[124:127], v[40:43]
    ds_read_b64_tr_b16 v[210:211], v3 offset:4096
    v_mfma_f32_16x16x32_bf16 v[40:43], v[224:227], v[120:123], v[40:43]
    ds_read_b64_tr_b16 v[212:213], v3 offset:8192
    v_mfma_f32_16x16x32_bf16 v[56:59], v[224:227], v[128:131], v[56:59]
    ds_read_b64_tr_b16 v[214:215], v3 offset:12288
    v_mfma_f32_16x16x32_bf16 v[56:59], v[228:231], v[132:135], v[56:59]
    ds_read_b64_tr_b16 v[216:217], v4 offset:0
    v_mfma_f32_16x16x32_bf16 v[72:75], v[228:231], v[140:143], v[72:75]
    ds_read_b64_tr_b16 v[218:219], v4 offset:4096
    v_mfma_f32_16x16x32_bf16 v[72:75], v[224:227], v[136:139], v[72:75]
    ds_read_b64_tr_b16 v[220:221], v4 offset:8192
    v_mfma_f32_16x16x32_bf16 v[76:79], v[232:235], v[136:139], v[76:79]
    ds_read_b64_tr_b16 v[222:223], v4 offset:12288
    v_mfma_f32_16x16x32_bf16 v[76:79], v[236:239], v[140:143], v[76:79]
    v_mfma_f32_16x16x32_bf16 v[60:63], v[236:239], v[132:135], v[60:63]
    v_mfma_f32_16x16x32_bf16 v[60:63], v[232:235], v[128:131], v[60:63]
    v_mfma_f32_16x16x32_bf16 v[44:47], v[232:235], v[120:123], v[44:47]
    v_mfma_f32_16x16x32_bf16 v[44:47], v[236:239], v[124:127], v[44:47]
    v_mfma_f32_16x16x32_bf16 v[28:31], v[236:239], v[116:119], v[28:31]
    v_mfma_f32_16x16x32_bf16 v[28:31], v[232:235], v[112:115], v[28:31]
    s_nop 8
    s_cmp_eq_u32 s74, 0
    s_cbranch_scc1 L_slow0
    v_pk_mul_f32 v[112:113], v[144:145], v[16:17]
    v_pk_mul_f32 v[114:115], v[146:147], v[18:19]
    v_pk_mul_f32 v[116:117], v[148:149], v[20:21]
    v_pk_mul_f32 v[118:119], v[150:151], v[22:23]
    v_cvt_pk_bf16_f32 v80, v112, v113
    v_cvt_pk_bf16_f32 v81, v114, v115
    v_cvt_pk_bf16_f32 v82, v116, v117
    v_cvt_pk_bf16_f32 v83, v118, v119
    buffer_store_dwordx4 v[80:83], v8, s[16:19], s60 offen offset:0
    ds_write_b128 v7, v[80:83] offset:0
    v_pk_mul_f32 v[120:121], v[152:153], v[24:25]
    v_pk_mul_f32 v[122:123], v[154:155], v[26:27]
    v_pk_mul_f32 v[124:125], v[156:157], v[28:29]
    v_pk_mul_f32 v[126:127], v[158:159], v[30:31]
    v_cvt_pk_bf16_f32 v84, v120, v121
    v_cvt_pk_bf16_f32 v85, v122, v123
    v_cvt_pk_bf16_f32 v86, v124, v125
    v_cvt_pk_bf16_f32 v87, v126, v127
    buffer_store_dwordx4 v[84:87], v8, s[16:19], s60 offen offset:1024
    ds_write_b128 v7, v[84:87] offset:1024
    v_pk_mul_f32 v[128:129], v[160:161], v[32:33]
    v_pk_mul_f32 v[130:131], v[162:163], v[34:35]
    v_pk_mul_f32 v[132:133], v[164:165], v[36:37]
    v_pk_mul_f32 v[134:135], v[166:167], v[38:39]
    v_cvt_pk_bf16_f32 v88, v128, v129
    v_cvt_pk_bf16_f32 v89, v130, v131
    v_cvt_pk_bf16_f32 v90, v132, v133
    v_cvt_pk_bf16_f32 v91, v134, v135
    buffer_store_dwordx4 v[88:91], v8, s[16:19], s60 offen offset:2048
    ds_write_b128 v7, v[88:91] offset:2048
    v_pk_mul_f32 v[136:137], v[168:169], v[40:41]
    v_pk_mul_f32 v[138:139], v[170:171], v[42:43]
    v_pk_mul_f32 v[140:141], v[172:173], v[44:45]
    v_pk_mul_f32 v[142:143], v[174:175], v[46:47]
    v_cvt_pk_bf16_f32 v92, v136, v137
    v_cvt_pk_bf16_f32 v93, v138, v139
    v_cvt_pk_bf16_f32 v94, v140, v141
    v_cvt_pk_bf16_f32 v95, v142, v143
    buffer_store_dwordx4 v[92:95], v8, s[16:19], s60 offen offset:3072
    ds_write_b128 v7, v[92:95] offset:3072
    v_pk_mul_f32 v[112:113], v[176:177], v[48:49]
    v_pk_mul_f32 v[114:115], v[178:179], v[50:51]
    v_pk_mul_f32 v[116:117], v[180:181], v[52:53]
    v_pk_mul_f32 v[118:119], v[182:183], v[54:55]
    v_cvt_pk_bf16_f32 v96, v112, v113
    v_cvt_pk_bf16_f32 v97, v114, v115
    v_cvt_pk_bf16_f32 v98, v116, v117
    v_cvt_pk_bf16_f32 v99, v118, v119
    buffer_store_dwordx4 v[96:99], v8, s[16:19], s61 offen offset:0
    ds_write_b128 v7, v[96:99] offset:4096
    v_pk_mul_f32 v[120:121], v[184:185], v[56:57]
    v_pk_mul_f32 v[122:123], v[186:187], v[58:59]
    v_pk_mul_f32 v[124:125], v[188:189], v[60:61]
    v_pk_mul_f32 v[126:127], v[190:191], v[62:63]
    v_cvt_pk_bf16_f32 v100, v120, v121
    v_cvt_pk_bf16_f32 v101, v122, v123
    v_cvt_pk_bf16_f32 v102, v124, v125
    v_cvt_pk_bf16_f32 v103, v126, v127
    buffer_store_dwordx4 v[100:103], v8, s[16:19], s61 offen offset:1024
    ds_write_b128 v7, v[100:103] offset:5120
    v_pk_mul_f32 v[128:129], v[192:193], v[64:65]
    v_pk_mul_f32 v[130:131], v[194:195], v[66:67]
    v_pk_mul_f32 v[132:133], v[196:197], v[68:69]
    v_pk_mul_f32 v[134:135], v[198:199], v[70:71]
    v_cvt_pk_bf16_f32 v104, v128, v129
    v_cvt_pk_bf16_f32 v105, v130, v131
    v_cvt_pk_bf16_f32 v106, v132, v133
    v_cvt_pk_bf16_f32 v107, v134, v135
    buffer_store_dwordx4 v[104:107], v8, s[16:19], s61 offen offset:2048
    ds_write_b128 v7, v[104:107] offset:6144
    v_pk_mul_f32 v[136:137], v[200:201], v[72:73]
    v_pk_mul_f32 v[138:139], v[202:203], v[74:75]
    v_pk_mul_f32 v[140:141], v[204:205], v[76:77]
    v_pk_mul_f32 v[142:143], v[206:207], v[78:79]
    v_cvt_pk_bf16_f32 v108, v136, v137
    v_cvt_pk_bf16_f32 v109, v138, v139
    v_cvt_pk_bf16_f32 v110, v140, v141
    v_cvt_pk_bf16_f32 v111, v142, v143
    buffer_store_dwordx4 v[108:111], v8, s[16:19], s61 offen offset:3072
    ds_write_b128 v7, v[108:111] offset:7168
    s_branch L_join0
L_slow0:
    v_pk_mul_f32 v[112:113], v[144:145], v[16:17]
    v_pk_mul_f32 v[114:115], v[146:147], v[18:19]
    v_pk_mul_f32 v[116:117], v[148:149], v[20:21]
    v_pk_mul_f32 v[118:119], v[150:151], v[22:23]
    v_cvt_pk_bf16_f32 v80, v112, v113
    v_cvt_pk_bf16_f32 v81, v114, v115
    v_cvt_pk_bf16_f32 v82, v116, v117
    v_cvt_pk_bf16_f32 v83, v118, v119
    buffer_store_dwordx4 v[80:83], v8, s[16:19], s60 offen offset:0 sc1
    ds_write_b128 v7, v[80:83] offset:0
    v_pk_mul_f32 v[120:121], v[152:153], v[24:25]
    v_pk_mul_f32 v[122:123], v[154:155], v[26:27]
    v_pk_mul_f32 v[124:125], v[156:157], v[28:29]
    v_pk_mul_f32 v[126:127], v[158:159], v[30:31]
    v_cvt_pk_bf16_f32 v84, v120, v121
    v_cvt_pk_bf16_f32 v85, v122, v123
    v_cvt_pk_bf16_f32 v86, v124, v125
    v_cvt_pk_bf16_f32 v87, v126, v127
    buffer_store_dwordx4 v[84:87], v8, s[16:19], s60 offen offset:1024 sc1
    ds_write_b128 v7, v[84:87] offset:1024
    v_pk_mul_f32 v[128:129], v[160:161], v[32:33]
    v_pk_mul_f32 v[130:131], v[162:163], v[34:35]
    v_pk_mul_f32 v[132:133], v[164:165], v[36:37]
    v_pk_mul_f32 v[134:135], v[166:167], v[38:39]
    v_cvt_pk_bf16_f32 v88, v128, v129
    v_cvt_pk_bf16_f32 v89, v130, v131
    v_cvt_pk_bf16_f32 v90, v132, v133
    v_cvt_pk_bf16_f32 v91, v134, v135
    buffer_store_dwordx4 v[88:91], v8, s[16:19], s60 offen offset:2048 sc1
    ds_write_b128 v7, v[88:91] offset:2048
    v_pk_mul_f32 v[136:137], v[168:169], v[40:41]
    v_pk_mul_f32 v[138:139], v[170:171], v[42:43]
    v_pk_mul_f32 v[140:141], v[172:173], v[44:45]
    v_pk_mul_f32 v[142:143], v[174:175], v[46:47]
    v_cvt_pk_bf16_f32 v92, v136, v137
    v_cvt_pk_bf16_f32 v93, v138, v139
    v_cvt_pk_bf16_f32 v94, v140, v141
    v_cvt_pk_bf16_f32 v95, v142, v143
    buffer_store_dwordx4 v[92:95], v8, s[16:19], s60 offen offset:3072 sc1
    ds_write_b128 v7, v[92:95] offset:3072
    v_pk_mul_f32 v[112:113], v[176:177], v[48:49]
    v_pk_mul_f32 v[114:115], v[178:179], v[50:51]
    v_pk_mul_f32 v[116:117], v[180:181], v[52:53]
    v_pk_mul_f32 v[118:119], v[182:183], v[54:55]
    v_cvt_pk_bf16_f32 v96, v112, v113
    v_cvt_pk_bf16_f32 v97, v114, v115
    v_cvt_pk_bf16_f32 v98, v116, v117
    v_cvt_pk_bf16_f32 v99, v118, v119
    buffer_store_dwordx4 v[96:99], v8, s[16:19], s61 offen offset:0 sc1
    ds_write_b128 v7, v[96:99] offset:4096
    v_pk_mul_f32 v[120:121], v[184:185], v[56:57]
    v_pk_mul_f32 v[122:123], v[186:187], v[58:59]
    v_pk_mul_f32 v[124:125], v[188:189], v[60:61]
    v_pk_mul_f32 v[126:127], v[190:191], v[62:63]
    v_cvt_pk_bf16_f32 v100, v120, v121
    v_cvt_pk_bf16_f32 v101, v122, v123
    v_cvt_pk_bf16_f32 v102, v124, v125
    v_cvt_pk_bf16_f32 v103, v126, v127
    buffer_store_dwordx4 v[100:103], v8, s[16:19], s61 offen offset:1024 sc1
    ds_write_b128 v7, v[100:103] offset:5120
    v_pk_mul_f32 v[128:129], v[192:193], v[64:65]
    v_pk_mul_f32 v[130:131], v[194:195], v[66:67]
    v_pk_mul_f32 v[132:133], v[196:197], v[68:69]
    v_pk_mul_f32 v[134:135], v[198:199], v[70:71]
    v_cvt_pk_bf16_f32 v104, v128, v129
    v_cvt_pk_bf16_f32 v105, v130, v131
    v_cvt_pk_bf16_f32 v106, v132, v133
    v_cvt_pk_bf16_f32 v107, v134, v135
    buffer_store_dwordx4 v[104:107], v8, s[16:19], s61 offen offset:2048 sc1
    ds_write_b128 v7, v[104:107] offset:6144
    v_pk_mul_f32 v[136:137], v[200:201], v[72:73]
    v_pk_mul_f32 v[138:139], v[202:203], v[74:75]
    v_pk_mul_f32 v[140:141], v[204:205], v[76:77]
    v_pk_mul_f32 v[142:143], v[206:207], v[78:79]
    v_cvt_pk_bf16_f32 v108, v136, v137
    v_cvt_pk_bf16_f32 v109, v138, v139
    v_cvt_pk_bf16_f32 v110, v140, v141
    v_cvt_pk_bf16_f32 v111, v142, v143
    buffer_store_dwordx4 v[108:111], v8, s[16:19], s61 offen offset:3072 sc1
    ds_write_b128 v7, v[108:111] offset:7168
L_join0:
    s_add_u32 s60, s60, 8388608
    s_add_u32 s61, s61, 8388608
    s_lshl_b32 s34, s30, 13
    v_add_u32 v1, s34, v8
    v_add_u32 v2, 1024, v1
    s_waitcnt lgkmcnt(0)
    s_barrier
    ds_read_b128 v[80:83], v1 offset:0
    ds_read_b128 v[84:87], v2 offset:0
    ds_read_b128 v[92:95], v2 offset:2048
    ds_read_b128 v[88:91], v1 offset:2048
    ds_read_b128 v[96:99], v1 offset:4096
    ds_read_b128 v[100:103], v2 offset:4096
    ds_read_b128 v[108:111], v2 offset:6144
    ds_read_b128 v[104:107], v1 offset:6144
    s_nop 1
    s_waitcnt lgkmcnt(7)
    v_mfma_f32_16x16x32_bf16 v[16:19], v[208:211], v[80:83], v[16:19]
    ds_read_b64_tr_b16 v[224:225], v5 offset:0
    s_waitcnt lgkmcnt(7)
    v_mfma_f32_16x16x32_bf16 v[16:19], v[212:215], v[84:87], v[16:19]
    ds_read_b64_tr_b16 v[226:227], v5 offset:4096
    s_waitcnt lgkmcnt(7)
    v_mfma_f32_16x16x32_bf16 v[32:35], v[212:215], v[92:95], v[32:35]
    ds_read_b64_tr_b16 v[228:229], v5 offset:8192
    s_waitcnt lgkmcnt(7)
    v_mfma_f32_16x16x32_bf16 v[32:35], v[208:211], v[88:91], v[32:35]
    ds_read_b64_tr_b16 v[230:231], v5 offset:12288
    s_waitcnt vmcnt(0)
    buffer_store_dword v10, v9, s[16:19], 0 offen offset:0
    buffer_store_dword v10, v9, s[16:19], s59 offen offset:0 sc1
    s_waitcnt lgkmcnt(7)
    v_mfma_f32_16x16x32_bf16 v[48:51], v[208:211], v[96:99], v[48:51]
    ds_read_b64_tr_b16 v[232:233], v6 offset:0
    s_waitcnt lgkmcnt(7)
    v_mfma_f32_16x16x32_bf16 v[48:51], v[212:215], v[100:103], v[48:51]
    ds_read_b64_tr_b16 v[234:235], v6 offset:4096
    s_waitcnt lgkmcnt(7)
    v_mfma_f32_16x16x32_bf16 v[64:67], v[212:215], v[108:111], v[64:67]
    ds_read_b64_tr_b16 v[236:237], v6 offset:8192
    s_waitcnt lgkmcnt(7)
    v_mfma_f32_16x16x32_bf16 v[64:67], v[208:211], v[104:107], v[64:67]
    ds_read_b64_tr_b16 v[238:239], v6 offset:12288
    v_mfma_f32_16x16x32_bf16 v[68:71], v[216:219], v[104:107], v[68:71]
    v_mfma_f32_16x16x32_bf16 v[68:71], v[220:223], v[108:111], v[68:71]
    v_mfma_f32_16x16x32_bf16 v[52:55], v[220:223], v[100:103], v[52:55]
    v_mfma_f32_16x16x32_bf16 v[52:55], v[216:219], v[96:99], v[52:55]
    v_mfma_f32_16x16x32_bf16 v[36:39], v[216:219], v[88:91], v[36:39]
    v_mfma_f32_16x16x32_bf16 v[36:39], v[220:223], v[92:95], v[36:39]
    v_mfma_f32_16x16x32_bf16 v[20:23], v[220:223], v[84:87], v[20:23]
    v_mfma_f32_16x16x32_bf16 v[20:23], v[216:219], v[80:83], v[20:23]
    s_waitcnt lgkmcnt(6)
    v_mfma_f32_16x16x32_bf16 v[24:27], v[224:227], v[80:83], v[24:27]
    ds_read_b64_tr_b16 v[208:209], v3 offset:16384
    s_waitcnt lgkmcnt(5)
    v_mfma_f32_16x16x32_bf16 v[24:27], v[228:231], v[84:87], v[24:27]
    ds_read_b64_tr_b16 v[210:211], v3 offset:20480
    v_mfma_f32_16x16x32_bf16 v[40:43], v[228:231], v[92:95], v[40:43]
    ds_read_b128 v[112:115], v1 offset:16384
    v_mfma_f32_16x16x32_bf16 v[40:43], v[224:227], v[88:91], v[40:43]
    ds_read_b64_tr_b16 v[212:213], v3 offset:24576
    v_mfma_f32_16x16x32_bf16 v[56:59], v[224:227], v[96:99], v[56:59]
    ds_read_b64_tr_b16 v[214:215], v3 offset:28672
    v_mfma_f32_16x16x32_bf16 v[56:59], v[228:231], v[100:103], v[56:59]
    ds_read_b128 v[116:119], v2 offset:16384
    v_mfma_f32_16x16x32_bf16 v[72:75], v[228:231], v[108:111], v[72:75]
    ds_read_b128 v[124:127], v2 offset:18432
    v_mfma_f32_16x16x32_bf16 v[72:75], v[224:227], v[104:107], v[72:75]
    ds_read_b128 v[120:123], v1 offset:18432
    s_waitcnt lgkmcnt(10)
    v_mfma_f32_16x16x32_bf16 v[76:79], v[232:235], v[104:107], v[76:79]
    ds_read_b128 v[128:131], v1 offset:20480
    s_waitcnt lgkmcnt(9)
    v_mfma_f32_16x16x32_bf16 v[76:79], v[236:239], v[108:111], v[76:79]
    ds_read_b128 v[132:135], v2 offset:20480
    v_mfma_f32_16x16x32_bf16 v[60:63], v[236:239], v[100:103], v[60:63]
    ds_read_b128 v[140:143], v2 offset:22528
    v_mfma_f32_16x16x32_bf16 v[60:63], v[232:235], v[96:99], v[60:63]
    ds_read_b128 v[136:139], v1 offset:22528
    v_mfma_f32_16x16x32_bf16 v[44:47], v[232:235], v[88:91], v[44:47]
    ds_read_b64_tr_b16 v[216:217], v4 offset:16384
    v_mfma_f32_16x16x32_bf16 v[44:47], v[236:239], v[92:95], v[44:47]
    ds_read_b64_tr_b16 v[218:219], v4 offset:20480
    v_mfma_f32_16x16x32_bf16 v[28:31], v[236:239], v[84:87], v[28:31]
    ds_read_b64_tr_b16 v[220:221], v4 offset:24576
    v_mfma_f32_16x16x32_bf16 v[28:31], v[232:235], v[80:83], v[28:31]
    ds_read_b64_tr_b16 v[222:223], v4 offset:28672
    s_waitcnt lgkmcnt(13)
    v_mfma_f32_16x16x32_bf16 v[16:19], v[208:211], v[112:115], v[16:19]
    ds_read_b64_tr_b16 v[224:225], v5 offset:16384
    s_waitcnt lgkmcnt(11)
    v_mfma_f32_16x16x32_bf16 v[16:19], v[212:215], v[116:119], v[16:19]
    ds_read_b64_tr_b16 v[226:227], v5 offset:20480
    s_waitcnt lgkmcnt(11)
    v_mfma_f32_16x16x32_bf16 v[32:35], v[212:215], v[124:127], v[32:35]
    ds_read_b64_tr_b16 v[228:229], v5 offset:24576
    s_waitcnt lgkmcnt(11)
    v_mfma_f32_16x16x32_bf16 v[32:35], v[208:211], v[120:123], v[32:35]
    ds_read_b64_tr_b16 v[230:231], v5 offset:28672
    s_waitcnt lgkmcnt(11)
    v_mfma_f32_16x16x32_bf16 v[48:51], v[208:211], v[128:131], v[48:51]
    ds_read_b64_tr_b16 v[232:233], v6 offset:16384
    s_waitcnt lgkmcnt(11)
    v_mfma_f32_16x16x32_bf16 v[48:51], v[212:215], v[132:135], v[48:51]
    ds_read_b64_tr_b16 v[234:235], v6 offset:20480
    s_waitcnt lgkmcnt(11)
    v_mfma_f32_16x16x32_bf16 v[64:67], v[212:215], v[140:143], v[64:67]
    ds_read_b64_tr_b16 v[236:237], v6 offset:24576
    s_waitcnt lgkmcnt(11)
    v_mfma_f32_16x16x32_bf16 v[64:67], v[208:211], v[136:139], v[64:67]
    ds_read_b64_tr_b16 v[238:239], v6 offset:28672
    s_waitcnt lgkmcnt(10)
    v_mfma_f32_16x16x32_bf16 v[68:71], v[216:219], v[136:139], v[68:71]
    s_waitcnt lgkmcnt(8)
    v_mfma_f32_16x16x32_bf16 v[68:71], v[220:223], v[140:143], v[68:71]
    v_mfma_f32_16x16x32_bf16 v[52:55], v[220:223], v[132:135], v[52:55]
    v_mfma_f32_16x16x32_bf16 v[52:55], v[216:219], v[128:131], v[52:55]
    v_mfma_f32_16x16x32_bf16 v[36:39], v[216:219], v[120:123], v[36:39]
    v_mfma_f32_16x16x32_bf16 v[36:39], v[220:223], v[124:127], v[36:39]
    s_add_u32 s34, s77, 4194304
    s_mov_b32 m0, 132096
    s_nop 0
    buffer_load_dwordx4 v8, s[12:15], s34 offen lds
    v_mfma_f32_16x16x32_bf16 v[20:23], v[220:223], v[116:119], v[20:23]
    s_add_u32 s34, s77, 4195328
    s_mov_b32 m0, 132096
    s_nop 0
    buffer_load_dwordx4 v8, s[12:15], s34 offen lds
    v_mfma_f32_16x16x32_bf16 v[20:23], v[216:219], v[112:115], v[20:23]
    s_waitcnt lgkmcnt(6)
    v_mfma_f32_16x16x32_bf16 v[24:27], v[224:227], v[112:115], v[24:27]
    s_waitcnt lgkmcnt(0)
    s_barrier
    v_mfma_f32_16x16x32_bf16 v[24:27], v[228:231], v[116:119], v[24:27]
    ds_read_b64_tr_b16 v[208:209], v3 offset:32768
    ds_read_b64_tr_b16 v[210:211], v3 offset:36864
    v_mfma_f32_16x16x32_bf16 v[40:43], v[228:231], v[124:127], v[40:43]
    ds_read_b128 v[80:83], v1 offset:32768
    v_mfma_f32_16x16x32_bf16 v[40:43], v[224:227], v[120:123], v[40:43]
    ds_read_b64_tr_b16 v[212:213], v3 offset:40960
    v_mfma_f32_16x16x32_bf16 v[56:59], v[224:227], v[128:131], v[56:59]
    ds_read_b64_tr_b16 v[214:215], v3 offset:45056
    v_mfma_f32_16x16x32_bf16 v[56:59], v[228:231], v[132:135], v[56:59]
    ds_read_b128 v[84:87], v2 offset:32768
    v_mfma_f32_16x16x32_bf16 v[72:75], v[228:231], v[140:143], v[72:75]
    ds_read_b128 v[92:95], v2 offset:34816
    v_mfma_f32_16x16x32_bf16 v[72:75], v[224:227], v[136:139], v[72:75]
    ds_read_b128 v[88:91], v1 offset:34816
    v_mfma_f32_16x16x32_bf16 v[76:79], v[232:235], v[136:139], v[76:79]
    ds_read_b128 v[96:99], v1 offset:36864
    v_mfma_f32_16x16x32_bf16 v[76:79], v[236:239], v[140:143], v[76:79]
    ds_read_b128 v[100:103], v2 offset:36864
    v_mfma_f32_16x16x32_bf16 v[60:63], v[236:239], v[132:135], v[60:63]
    ds_read_b128 v[108:111], v2 offset:38912
    v_mfma_f32_16x16x32_bf16 v[60:63], v[232:235], v[128:131], v[60:63]
    ds_read_b128 v[104:107], v1 offset:38912
    v_mfma_f32_16x16x32_bf16 v[44:47], v[232:235], v[120:123], v[44:47]
    ds_read_b64_tr_b16 v[216:217], v4 offset:32768
    v_mfma_f32_16x16x32_bf16 v[44:47], v[236:239], v[124:127], v[44:47]
    ds_read_b64_tr_b16 v[218:219], v4 offset:36864
    v_mfma_f32_16x16x32_bf16 v[28:31], v[236:239], v[116:119], v[28:31]
    ds_read_b64_tr_b16 v[220:221], v4 offset:40960
    v_mfma_f32_16x16x32_bf16 v[28:31], v[232:235], v[112:115], v[28:31]
    ds_read_b64_tr_b16 v[222:223], v4 offset:45056
    s_waitcnt lgkmcnt(13)
    v_mfma_f32_16x16x32_bf16 v[16:19], v[208:211], v[80:83], v[16:19]
    ds_read_b64_tr_b16 v[224:225], v5 offset:32768
    s_waitcnt lgkmcnt(11)
    v_mfma_f32_16x16x32_bf16 v[16:19], v[212:215], v[84:87], v[16:19]
    ds_read_b64_tr_b16 v[226:227], v5 offset:36864
    s_waitcnt lgkmcnt(11)
    v_mfma_f32_16x16x32_bf16 v[32:35], v[212:215], v[92:95], v[32:35]
    ds_read_b64_tr_b16 v[228:229], v5 offset:40960
    s_waitcnt lgkmcnt(11)
    v_mfma_f32_16x16x32_bf16 v[32:35], v[208:211], v[88:91], v[32:35]
    ds_read_b64_tr_b16 v[230:231], v5 offset:45056
    s_waitcnt lgkmcnt(11)
    v_mfma_f32_16x16x32_bf16 v[48:51], v[208:211], v[96:99], v[48:51]
    ds_read_b64_tr_b16 v[232:233], v6 offset:32768
    s_waitcnt lgkmcnt(11)
    v_mfma_f32_16x16x32_bf16 v[48:51], v[212:215], v[100:103], v[48:51]
    ds_read_b64_tr_b16 v[234:235], v6 offset:36864
    s_waitcnt lgkmcnt(11)
    v_mfma_f32_16x16x32_bf16 v[64:67], v[212:215], v[108:111], v[64:67]
    ds_read_b64_tr_b16 v[236:237], v6 offset:40960
    s_waitcnt lgkmcnt(11)
    v_mfma_f32_16x16x32_bf16 v[64:67], v[208:211], v[104:107], v[64:67]
    ds_read_b64_tr_b16 v[238:239], v6 offset:45056
    s_waitcnt lgkmcnt(10)
    v_mfma_f32_16x16x32_bf16 v[68:71], v[216:219], v[104:107], v[68:71]
    s_waitcnt lgkmcnt(8)
    v_mfma_f32_16x16x32_bf16 v[68:71], v[220:223], v[108:111], v[68:71]
    v_lshrrev_b32 v11, 4, v0
    v_lshlrev_b32 v11, 3, v11
    s_lshl_b32 s34, s31, 7
    s_add_u32 s34, s34, 131072
    v_add_u32 v11, s34, v11
    v_mfma_f32_16x16x32_bf16 v[52:55], v[220:223], v[100:103], v[52:55]
    ds_read_b64 v[242:243], v11 offset:256
    ds_read_b64 v[246:247], v11 offset:288
    v_mfma_f32_16x16x32_bf16 v[52:55], v[216:219], v[96:99], v[52:55]
    ds_read_b64 v[250:251], v11 offset:320
    ds_read_b64 v[254:255], v11 offset:352
    v_mfma_f32_16x16x32_bf16 v[36:39], v[216:219], v[88:91], v[36:39]
    v_mfma_f32_16x16x32_bf16 v[36:39], v[220:223], v[92:95], v[36:39]
    v_mfma_f32_16x16x32_bf16 v[20:23], v[220:223], v[84:87], v[20:23]
    v_mfma_f32_16x16x32_bf16 v[20:23], v[216:219], v[80:83], v[20:23]
    s_waitcnt lgkmcnt(10)
    v_mfma_f32_16x16x32_bf16 v[24:27], v[224:227], v[80:83], v[24:27]
    s_waitcnt lgkmcnt(0)
    s_barrier
    v_mfma_f32_16x16x32_bf16 v[24:27], v[228:231], v[84:87], v[24:27]
    ds_read_b64_tr_b16 v[208:209], v3 offset:49152
    ds_read_b64_tr_b16 v[210:211], v3 offset:53248
    v_mfma_f32_16x16x32_bf16 v[40:43], v[228:231], v[92:95], v[40:43]
    ds_read_b128 v[112:115], v1 offset:49152
    v_mfma_f32_16x16x32_bf16 v[40:43], v[224:227], v[88:91], v[40:43]
    ds_read_b64_tr_b16 v[212:213], v3 offset:57344
    v_mfma_f32_16x16x32_bf16 v[56:59], v[224:227], v[96:99], v[56:59]
    ds_read_b64_tr_b16 v[214:215], v3 offset:61440
    v_mfma_f32_16x16x32_bf16 v[56:59], v[228:231], v[100:103], v[56:59]
    ds_read_b128 v[116:119], v2 offset:49152
    v_mfma_f32_16x16x32_bf16 v[72:75], v[228:231], v[108:111], v[72:75]
    ds_read_b128 v[124:127], v2 offset:51200
    v_mfma_f32_16x16x32_bf16 v[72:75], v[224:227], v[104:107], v[72:75]
    ds_read_b128 v[120:123], v1 offset:51200
    v_mfma_f32_16x16x32_bf16 v[76:79], v[232:235], v[104:107], v[76:79]
    ds_read_b128 v[128:131], v1 offset:53248
    v_mfma_f32_16x16x32_bf16 v[76:79], v[236:239], v[108:111], v[76:79]
    ds_read_b128 v[132:135], v2 offset:53248
    v_mfma_f32_16x16x32_bf16 v[60:63], v[236:239], v[100:103], v[60:63]
    ds_read_b128 v[140:143], v2 offset:55296
    v_mfma_f32_16x16x32_bf16 v[60:63], v[232:235], v[96:99], v[60:63]
    ds_read_b128 v[136:139], v1 offset:55296
    v_mfma_f32_16x16x32_bf16 v[44:47], v[232:235], v[88:91], v[44:47]
    ds_read_b64_tr_b16 v[216:217], v4 offset:49152
    v_mfma_f32_16x16x32_bf16 v[44:47], v[236:239], v[92:95], v[44:47]
    ds_read_b64_tr_b16 v[218:219], v4 offset:53248
    v_mfma_f32_16x16x32_bf16 v[28:31], v[236:239], v[84:87], v[28:31]
    ds_read_b64_tr_b16 v[220:221], v4 offset:57344
    v_mfma_f32_16x16x32_bf16 v[28:31], v[232:235], v[80:83], v[28:31]
    ds_read_b64_tr_b16 v[222:223], v4 offset:61440
    s_waitcnt lgkmcnt(13)
    v_mfma_f32_16x16x32_bf16 v[16:19], v[208:211], v[112:115], v[16:19]
    ds_read_b64_tr_b16 v[224:225], v5 offset:49152
    s_waitcnt lgkmcnt(11)
    v_mfma_f32_16x16x32_bf16 v[16:19], v[212:215], v[116:119], v[16:19]
    ds_read_b64_tr_b16 v[226:227], v5 offset:53248
    s_waitcnt lgkmcnt(11)
    v_mfma_f32_16x16x32_bf16 v[32:35], v[212:215], v[124:127], v[32:35]
    ds_read_b64_tr_b16 v[228:229], v5 offset:57344
    s_waitcnt lgkmcnt(11)
    v_mfma_f32_16x16x32_bf16 v[32:35], v[208:211], v[120:123], v[32:35]
    ds_read_b64_tr_b16 v[230:231], v5 offset:61440
    s_waitcnt lgkmcnt(11)
    v_mfma_f32_16x16x32_bf16 v[48:51], v[208:211], v[128:131], v[48:51]
    ds_read_b64_tr_b16 v[232:233], v6 offset:49152
    s_waitcnt lgkmcnt(11)
    v_mfma_f32_16x16x32_bf16 v[48:51], v[212:215], v[132:135], v[48:51]
    ds_read_b64_tr_b16 v[234:235], v6 offset:53248
    s_waitcnt lgkmcnt(11)
    v_mfma_f32_16x16x32_bf16 v[64:67], v[212:215], v[140:143], v[64:67]
    ds_read_b64_tr_b16 v[236:237], v6 offset:57344
    s_waitcnt lgkmcnt(11)
    v_mfma_f32_16x16x32_bf16 v[64:67], v[208:211], v[136:139], v[64:67]
    ds_read_b64_tr_b16 v[238:239], v6 offset:61440
    s_waitcnt lgkmcnt(10)
    v_mfma_f32_16x16x32_bf16 v[68:71], v[216:219], v[136:139], v[68:71]
    s_waitcnt lgkmcnt(8)
    v_mfma_f32_16x16x32_bf16 v[68:71], v[220:223], v[140:143], v[68:71]
    v_lshlrev_b32 v240, 16, v242
    v_and_b32 v241, s33, v242
    v_lshlrev_b32 v242, 16, v243
    v_and_b32 v243, s33, v243
    v_mfma_f32_16x16x32_bf16 v[52:55], v[220:223], v[132:135], v[52:55]
    v_mfma_f32_16x16x32_bf16 v[52:55], v[216:219], v[128:131], v[52:55]
    v_lshlrev_b32 v244, 16, v246
    v_and_b32 v245, s33, v246
    v_lshlrev_b32 v246, 16, v247
    v_and_b32 v247, s33, v247
    v_mfma_f32_16x16x32_bf16 v[36:39], v[216:219], v[120:123], v[36:39]
    v_mfma_f32_16x16x32_bf16 v[36:39], v[220:223], v[124:127], v[36:39]
    v_lshlrev_b32 v248, 16, v250
    v_and_b32 v249, s33, v250
    v_lshlrev_b32 v250, 16, v251
    v_and_b32 v251, s33, v251
    v_mfma_f32_16x16x32_bf16 v[20:23], v[220:223], v[116:119], v[20:23]
    v_mfma_f32_16x16x32_bf16 v[20:23], v[216:219], v[112:115], v[20:23]
    v_lshlrev_b32 v252, 16, v254
    v_and_b32 v253, s33, v254
    v_lshlrev_b32 v254, 16, v255
    v_and_b32 v255, s33, v255
    s_waitcnt lgkmcnt(6)
    v_mfma_f32_16x16x32_bf16 v[24:27], v[224:227], v[112:115], v[24:27]
    s_waitcnt lgkmcnt(0)
    s_barrier
    v_mfma_f32_16x16x32_bf16 v[24:27], v[228:231], v[116:119], v[24:27]
    ds_read_b64_tr_b16 v[208:209], v3 offset:0
    ds_read_b64_tr_b16 v[210:211], v3 offset:4096
    v_mfma_f32_16x16x32_bf16 v[40:43], v[228:231], v[124:127], v[40:43]
    ds_read_b128 v[80:83], v1 offset:0
    v_mfma_f32_16x16x32_bf16 v[40:43], v[224:227], v[120:123], v[40:43]
    ds_read_b64_tr_b16 v[212:213], v3 offset:8192
    v_mfma_f32_16x16x32_bf16 v[56:59], v[224:227], v[128:131], v[56:59]
    ds_read_b64_tr_b16 v[214:215], v3 offset:12288
    v_mfma_f32_16x16x32_bf16 v[56:59], v[228:231], v[132:135], v[56:59]
    ds_read_b128 v[84:87], v2 offset:0
    v_mfma_f32_16x16x32_bf16 v[72:75], v[228:231], v[140:143], v[72:75]
    ds_read_b128 v[92:95], v2 offset:2048
    v_mfma_f32_16x16x32_bf16 v[72:75], v[224:227], v[136:139], v[72:75]
    ds_read_b128 v[88:91], v1 offset:2048
    v_mfma_f32_16x16x32_bf16 v[76:79], v[232:235], v[136:139], v[76:79]
    ds_read_b128 v[96:99], v1 offset:4096
    v_mfma_f32_16x16x32_bf16 v[76:79], v[236:239], v[140:143], v[76:79]
    ds_read_b128 v[100:103], v2 offset:4096
    v_mfma_f32_16x16x32_bf16 v[60:63], v[236:239], v[132:135], v[60:63]
    ds_read_b128 v[108:111], v2 offset:6144
    v_mfma_f32_16x16x32_bf16 v[60:63], v[232:235], v[128:131], v[60:63]
    ds_read_b128 v[104:107], v1 offset:6144
    v_mfma_f32_16x16x32_bf16 v[44:47], v[232:235], v[120:123], v[44:47]
    ds_read_b64_tr_b16 v[216:217], v4 offset:0
    v_mfma_f32_16x16x32_bf16 v[44:47], v[236:239], v[124:127], v[44:47]
    ds_read_b64_tr_b16 v[218:219], v4 offset:4096
    v_mfma_f32_16x16x32_bf16 v[28:31], v[236:239], v[116:119], v[28:31]
    ds_read_b64_tr_b16 v[220:221], v4 offset:8192
    v_mfma_f32_16x16x32_bf16 v[28:31], v[232:235], v[112:115], v[28:31]
    ds_read_b64_tr_b16 v[222:223], v4 offset:12288
    s_waitcnt lgkmcnt(13)
    v_mfma_f32_16x16x32_bf16 v[16:19], v[208:211], v[80:83], v[16:19]
    ds_read_b64_tr_b16 v[224:225], v5 offset:0
    s_waitcnt lgkmcnt(11)
    v_mfma_f32_16x16x32_bf16 v[16:19], v[212:215], v[84:87], v[16:19]
    ds_read_b64_tr_b16 v[226:227], v5 offset:4096
    s_waitcnt lgkmcnt(11)
    v_mfma_f32_16x16x32_bf16 v[32:35], v[212:215], v[92:95], v[32:35]
    ds_read_b64_tr_b16 v[228:229], v5 offset:8192
    s_waitcnt lgkmcnt(11)
    v_mfma_f32_16x16x32_bf16 v[32:35], v[208:211], v[88:91], v[32:35]
    ds_read_b64_tr_b16 v[230:231], v5 offset:12288
    s_waitcnt lgkmcnt(11)
    v_mfma_f32_16x16x32_bf16 v[48:51], v[208:211], v[96:99], v[48:51]
    ds_read_b64_tr_b16 v[232:233], v6 offset:0
    s_waitcnt lgkmcnt(11)
    v_mfma_f32_16x16x32_bf16 v[48:51], v[212:215], v[100:103], v[48:51]
    ds_read_b64_tr_b16 v[234:235], v6 offset:4096
    s_waitcnt lgkmcnt(11)
    v_mfma_f32_16x16x32_bf16 v[64:67], v[212:215], v[108:111], v[64:67]
    ds_read_b64_tr_b16 v[236:237], v6 offset:8192
    s_waitcnt lgkmcnt(11)
    v_mfma_f32_16x16x32_bf16 v[64:67], v[208:211], v[104:107], v[64:67]
    ds_read_b64_tr_b16 v[238:239], v6 offset:12288
    s_waitcnt lgkmcnt(10)
    v_mfma_f32_16x16x32_bf16 v[68:71], v[216:219], v[104:107], v[68:71]
    v_add_f32 v24, v248, v24
    v_add_f32 v28, v252, v28
    s_waitcnt lgkmcnt(8)
    v_mfma_f32_16x16x32_bf16 v[68:71], v[220:223], v[108:111], v[68:71]
    v_add_f32 v40, v248, v40
    v_add_f32 v44, v252, v44
    v_mfma_f32_16x16x32_bf16 v[52:55], v[220:223], v[100:103], v[52:55]
    v_add_f32 v56, v248, v56
    v_add_f32 v60, v252, v60
    v_mfma_f32_16x16x32_bf16 v[52:55], v[216:219], v[96:99], v[52:55]
    v_add_f32 v72, v248, v72
    v_add_f32 v76, v252, v76
    v_mfma_f32_16x16x32_bf16 v[36:39], v[216:219], v[88:91], v[36:39]
    v_add_f32 v25, v249, v25
    v_add_f32 v29, v253, v29
    v_mfma_f32_16x16x32_bf16 v[36:39], v[220:223], v[92:95], v[36:39]
    v_add_f32 v41, v249, v41
    v_add_f32 v45, v253, v45
    v_mfma_f32_16x16x32_bf16 v[20:23], v[220:223], v[84:87], v[20:23]
    v_mfma_f32_16x16x32_bf16 v[20:23], v[216:219], v[80:83], v[20:23]
    s_waitcnt lgkmcnt(6)
    v_mfma_f32_16x16x32_bf16 v[24:27], v[224:227], v[80:83], v[24:27]
    s_waitcnt lgkmcnt(0)
    s_barrier
    v_mfma_f32_16x16x32_bf16 v[24:27], v[228:231], v[84:87], v[24:27]
    ds_read_b64_tr_b16 v[208:209], v3 offset:16384
    ds_read_b64_tr_b16 v[210:211], v3 offset:20480
    v_mfma_f32_16x16x32_bf16 v[40:43], v[228:231], v[92:95], v[40:43]
    ds_read_b128 v[112:115], v1 offset:16384
    v_mfma_f32_16x16x32_bf16 v[40:43], v[224:227], v[88:91], v[40:43]
    ds_read_b64_tr_b16 v[212:213], v3 offset:24576
    v_mfma_f32_16x16x32_bf16 v[56:59], v[224:227], v[96:99], v[56:59]
    ds_read_b64_tr_b16 v[214:215], v3 offset:28672
    v_mfma_f32_16x16x32_bf16 v[56:59], v[228:231], v[100:103], v[56:59]
    ds_read_b128 v[116:119], v2 offset:16384
    v_mfma_f32_16x16x32_bf16 v[72:75], v[228:231], v[108:111], v[72:75]
    ds_read_b128 v[124:127], v2 offset:18432
    v_mfma_f32_16x16x32_bf16 v[72:75], v[224:227], v[104:107], v[72:75]
    ds_read_b128 v[120:123], v1 offset:18432
    v_mfma_f32_16x16x32_bf16 v[76:79], v[232:235], v[104:107], v[76:79]
    ds_read_b128 v[128:131], v1 offset:20480
    v_add_f32 v16, v240, v16
    v_mfma_f32_16x16x32_bf16 v[76:79], v[236:239], v[108:111], v[76:79]
    ds_read_b128 v[132:135], v2 offset:20480
    v_add_f32 v20, v244, v20
    v_mfma_f32_16x16x32_bf16 v[60:63], v[236:239], v[100:103], v[60:63]
    ds_read_b128 v[140:143], v2 offset:22528
    v_add_f32 v32, v240, v32
    v_mfma_f32_16x16x32_bf16 v[60:63], v[232:235], v[96:99], v[60:63]
    ds_read_b128 v[136:139], v1 offset:22528
    v_add_f32 v36, v244, v36
    v_mfma_f32_16x16x32_bf16 v[44:47], v[232:235], v[88:91], v[44:47]
    ds_read_b64_tr_b16 v[216:217], v4 offset:16384
    v_add_f32 v48, v240, v48
    v_mfma_f32_16x16x32_bf16 v[44:47], v[236:239], v[92:95], v[44:47]
    ds_read_b64_tr_b16 v[218:219], v4 offset:20480
    v_add_f32 v52, v244, v52
    v_mfma_f32_16x16x32_bf16 v[28:31], v[236:239], v[84:87], v[28:31]
    ds_read_b64_tr_b16 v[220:221], v4 offset:24576
    v_mfma_f32_16x16x32_bf16 v[28:31], v[232:235], v[80:83], v[28:31]
    ds_read_b64_tr_b16 v[222:223], v4 offset:28672
    s_waitcnt lgkmcnt(13)
    v_mfma_f32_16x16x32_bf16 v[16:19], v[208:211], v[112:115], v[16:19]
    ds_read_b64_tr_b16 v[224:225], v5 offset:16384
    s_waitcnt lgkmcnt(11)
    v_mfma_f32_16x16x32_bf16 v[16:19], v[212:215], v[116:119], v[16:19]
    ds_read_b64_tr_b16 v[226:227], v5 offset:20480
    s_waitcnt lgkmcnt(11)
    v_mfma_f32_16x16x32_bf16 v[32:35], v[212:215], v[124:127], v[32:35]
    ds_read_b64_tr_b16 v[228:229], v5 offset:24576
    s_waitcnt lgkmcnt(11)
    v_mfma_f32_16x16x32_bf16 v[32:35], v[208:211], v[120:123], v[32:35]
    ds_read_b64_tr_b16 v[230:231], v5 offset:28672
    s_waitcnt lgkmcnt(11)
    v_mfma_f32_16x16x32_bf16 v[48:51], v[208:211], v[128:131], v[48:51]
    ds_read_b64_tr_b16 v[232:233], v6 offset:16384
    s_waitcnt lgkmcnt(11)
    v_mfma_f32_16x16x32_bf16 v[48:51], v[212:215], v[132:135], v[48:51]
    ds_read_b64_tr_b16 v[234:235], v6 offset:20480
    s_waitcnt lgkmcnt(11)
    v_mfma_f32_16x16x32_bf16 v[64:67], v[212:215], v[140:143], v[64:67]
    ds_read_b64_tr_b16 v[236:237], v6 offset:24576
    s_waitcnt lgkmcnt(11)
    v_mfma_f32_16x16x32_bf16 v[64:67], v[208:211], v[136:139], v[64:67]
    ds_read_b64_tr_b16 v[238:239], v6 offset:28672
    s_waitcnt lgkmcnt(10)
    v_mfma_f32_16x16x32_bf16 v[68:71], v[216:219], v[136:139], v[68:71]
    v_add_f32 v57, v249, v57
    v_add_f32 v61, v253, v61
    s_waitcnt lgkmcnt(8)
    v_mfma_f32_16x16x32_bf16 v[68:71], v[220:223], v[140:143], v[68:71]
    v_add_f32 v73, v249, v73
    v_add_f32 v77, v253, v77
    v_mfma_f32_16x16x32_bf16 v[52:55], v[220:223], v[132:135], v[52:55]
    v_add_f32 v26, v250, v26
    v_add_f32 v30, v254, v30
    v_mfma_f32_16x16x32_bf16 v[52:55], v[216:219], v[128:131], v[52:55]
    v_add_f32 v42, v250, v42
    v_add_f32 v46, v254, v46
    v_mfma_f32_16x16x32_bf16 v[36:39], v[216:219], v[120:123], v[36:39]
    v_add_f32 v58, v250, v58
    v_add_f32 v62, v254, v62
    v_mfma_f32_16x16x32_bf16 v[36:39], v[220:223], v[124:127], v[36:39]
    v_add_f32 v74, v250, v74
    v_add_f32 v78, v254, v78
    v_mfma_f32_16x16x32_bf16 v[20:23], v[220:223], v[116:119], v[20:23]
    v_mfma_f32_16x16x32_bf16 v[20:23], v[216:219], v[112:115], v[20:23]
    s_waitcnt lgkmcnt(6)
    v_mfma_f32_16x16x32_bf16 v[24:27], v[224:227], v[112:115], v[24:27]
    s_waitcnt lgkmcnt(0)
    s_barrier
    v_mfma_f32_16x16x32_bf16 v[24:27], v[228:231], v[116:119], v[24:27]
    ds_read_b64_tr_b16 v[208:209], v3 offset:32768
    ds_read_b64_tr_b16 v[210:211], v3 offset:36864
    v_mfma_f32_16x16x32_bf16 v[40:43], v[228:231], v[124:127], v[40:43]
    ds_read_b128 v[80:83], v1 offset:32768
    v_mfma_f32_16x16x32_bf16 v[40:43], v[224:227], v[120:123], v[40:43]
    ds_read_b64_tr_b16 v[212:213], v3 offset:40960
    v_mfma_f32_16x16x32_bf16 v[56:59], v[224:227], v[128:131], v[56:59]
    ds_read_b64_tr_b16 v[214:215], v3 offset:45056
    v_mfma_f32_16x16x32_bf16 v[56:59], v[228:231], v[132:135], v[56:59]
    ds_read_b128 v[84:87], v2 offset:32768
    v_mfma_f32_16x16x32_bf16 v[72:75], v[228:231], v[140:143], v[72:75]
    ds_read_b128 v[92:95], v2 offset:34816
    v_mfma_f32_16x16x32_bf16 v[72:75], v[224:227], v[136:139], v[72:75]
    ds_read_b128 v[88:91], v1 offset:34816
    v_mfma_f32_16x16x32_bf16 v[76:79], v[232:235], v[136:139], v[76:79]
    ds_read_b128 v[96:99], v1 offset:36864
    v_add_f32 v64, v240, v64
    v_mfma_f32_16x16x32_bf16 v[76:79], v[236:239], v[140:143], v[76:79]
    ds_read_b128 v[100:103], v2 offset:36864
    v_add_f32 v68, v244, v68
    v_mfma_f32_16x16x32_bf16 v[60:63], v[236:239], v[132:135], v[60:63]
    ds_read_b128 v[108:111], v2 offset:38912
    v_add_f32 v17, v241, v17
    v_mfma_f32_16x16x32_bf16 v[60:63], v[232:235], v[128:131], v[60:63]
    ds_read_b128 v[104:107], v1 offset:38912
    v_add_f32 v21, v245, v21
    v_mfma_f32_16x16x32_bf16 v[44:47], v[232:235], v[120:123], v[44:47]
    ds_read_b64_tr_b16 v[216:217], v4 offset:32768
    v_add_f32 v33, v241, v33
    v_mfma_f32_16x16x32_bf16 v[44:47], v[236:239], v[124:127], v[44:47]
    ds_read_b64_tr_b16 v[218:219], v4 offset:36864
    v_add_f32 v37, v245, v37
    v_mfma_f32_16x16x32_bf16 v[28:31], v[236:239], v[116:119], v[28:31]
    ds_read_b64_tr_b16 v[220:221], v4 offset:40960
    v_mfma_f32_16x16x32_bf16 v[28:31], v[232:235], v[112:115], v[28:31]
    ds_read_b64_tr_b16 v[222:223], v4 offset:45056
    s_waitcnt lgkmcnt(13)
    v_mfma_f32_16x16x32_bf16 v[16:19], v[208:211], v[80:83], v[16:19]
    ds_read_b64_tr_b16 v[224:225], v5 offset:32768
    s_waitcnt lgkmcnt(11)
    v_mfma_f32_16x16x32_bf16 v[16:19], v[212:215], v[84:87], v[16:19]
    ds_read_b64_tr_b16 v[226:227], v5 offset:36864
    s_waitcnt lgkmcnt(11)
    v_mfma_f32_16x16x32_bf16 v[32:35], v[212:215], v[92:95], v[32:35]
    ds_read_b64_tr_b16 v[228:229], v5 offset:40960
    s_waitcnt lgkmcnt(11)
    v_mfma_f32_16x16x32_bf16 v[32:35], v[208:211], v[88:91], v[32:35]
    ds_read_b64_tr_b16 v[230:231], v5 offset:45056
    s_waitcnt lgkmcnt(11)
    v_mfma_f32_16x16x32_bf16 v[48:51], v[208:211], v[96:99], v[48:51]
    ds_read_b64_tr_b16 v[232:233], v6 offset:32768
    s_waitcnt lgkmcnt(11)
    v_mfma_f32_16x16x32_bf16 v[48:51], v[212:215], v[100:103], v[48:51]
    ds_read_b64_tr_b16 v[234:235], v6 offset:36864
    s_waitcnt lgkmcnt(11)
    v_mfma_f32_16x16x32_bf16 v[64:67], v[212:215], v[108:111], v[64:67]
    ds_read_b64_tr_b16 v[236:237], v6 offset:40960
    s_waitcnt lgkmcnt(11)
    v_mfma_f32_16x16x32_bf16 v[64:67], v[208:211], v[104:107], v[64:67]
    ds_read_b64_tr_b16 v[238:239], v6 offset:45056
    s_waitcnt lgkmcnt(10)
    v_mfma_f32_16x16x32_bf16 v[68:71], v[216:219], v[104:107], v[68:71]
    v_add_f32 v27, v251, v27
    v_add_f32 v31, v255, v31
    s_waitcnt lgkmcnt(8)
    v_mfma_f32_16x16x32_bf16 v[68:71], v[220:223], v[108:111], v[68:71]
    v_add_f32 v43, v251, v43
    v_add_f32 v47, v255, v47
    v_mfma_f32_16x16x32_bf16 v[52:55], v[220:223], v[100:103], v[52:55]
    v_add_f32 v59, v251, v59
    v_add_f32 v63, v255, v63
    v_mfma_f32_16x16x32_bf16 v[52:55], v[216:219], v[96:99], v[52:55]
    v_add_f32 v75, v251, v75
    v_add_f32 v79, v255, v79
    v_mfma_f32_16x16x32_bf16 v[36:39], v[216:219], v[88:91], v[36:39]
    v_mfma_f32_16x16x32_bf16 v[36:39], v[220:223], v[92:95], v[36:39]
    v_mfma_f32_16x16x32_bf16 v[20:23], v[220:223], v[84:87], v[20:23]
    v_mfma_f32_16x16x32_bf16 v[20:23], v[216:219], v[80:83], v[20:23]
    s_waitcnt lgkmcnt(6)
    v_mfma_f32_16x16x32_bf16 v[24:27], v[224:227], v[80:83], v[24:27]
    s_waitcnt lgkmcnt(0)
    s_barrier
    v_mfma_f32_16x16x32_bf16 v[24:27], v[228:231], v[84:87], v[24:27]
    ds_read_b64_tr_b16 v[208:209], v3 offset:49152
    ds_read_b64_tr_b16 v[210:211], v3 offset:53248
    v_mfma_f32_16x16x32_bf16 v[40:43], v[228:231], v[92:95], v[40:43]
    ds_read_b128 v[112:115], v1 offset:49152
    v_mfma_f32_16x16x32_bf16 v[40:43], v[224:227], v[88:91], v[40:43]
    ds_read_b64_tr_b16 v[212:213], v3 offset:57344
    v_mfma_f32_16x16x32_bf16 v[56:59], v[224:227], v[96:99], v[56:59]
    ds_read_b64_tr_b16 v[214:215], v3 offset:61440
    v_mfma_f32_16x16x32_bf16 v[56:59], v[228:231], v[100:103], v[56:59]
    ds_read_b128 v[116:119], v2 offset:49152
    v_mfma_f32_16x16x32_bf16 v[72:75], v[228:231], v[108:111], v[72:75]
    ds_read_b128 v[124:127], v2 offset:51200
    v_mfma_f32_16x16x32_bf16 v[72:75], v[224:227], v[104:107], v[72:75]
    ds_read_b128 v[120:123], v1 offset:51200
    v_mfma_f32_16x16x32_bf16 v[76:79], v[232:235], v[104:107], v[76:79]
    ds_read_b128 v[128:131], v1 offset:53248
    v_add_f32 v49, v241, v49
    v_mfma_f32_16x16x32_bf16 v[76:79], v[236:239], v[108:111], v[76:79]
    ds_read_b128 v[132:135], v2 offset:53248
    v_add_f32 v53, v245, v53
    v_mfma_f32_16x16x32_bf16 v[60:63], v[236:239], v[100:103], v[60:63]
    ds_read_b128 v[140:143], v2 offset:55296
    v_add_f32 v65, v241, v65
    v_mfma_f32_16x16x32_bf16 v[60:63], v[232:235], v[96:99], v[60:63]
    ds_read_b128 v[136:139], v1 offset:55296
    v_add_f32 v69, v245, v69
    v_mfma_f32_16x16x32_bf16 v[44:47], v[232:235], v[88:91], v[44:47]
    ds_read_b64_tr_b16 v[216:217], v4 offset:49152
    v_add_f32 v18, v242, v18
    v_mfma_f32_16x16x32_bf16 v[44:47], v[236:239], v[92:95], v[44:47]
    ds_read_b64_tr_b16 v[218:219], v4 offset:53248
    v_add_f32 v22, v246, v22
    v_mfma_f32_16x16x32_bf16 v[28:31], v[236:239], v[84:87], v[28:31]
    ds_read_b64_tr_b16 v[220:221], v4 offset:57344
    v_mfma_f32_16x16x32_bf16 v[28:31], v[232:235], v[80:83], v[28:31]
    ds_read_b64_tr_b16 v[222:223], v4 offset:61440
    s_waitcnt lgkmcnt(13)
    v_mfma_f32_16x16x32_bf16 v[16:19], v[208:211], v[112:115], v[16:19]
    ds_read_b64_tr_b16 v[224:225], v5 offset:49152
    s_waitcnt lgkmcnt(11)
    v_mfma_f32_16x16x32_bf16 v[16:19], v[212:215], v[116:119], v[16:19]
    ds_read_b64_tr_b16 v[226:227], v5 offset:53248
    s_waitcnt lgkmcnt(11)
    v_mfma_f32_16x16x32_bf16 v[32:35], v[212:215], v[124:127], v[32:35]
    ds_read_b64_tr_b16 v[228:229], v5 offset:57344
    s_waitcnt lgkmcnt(11)
    v_mfma_f32_16x16x32_bf16 v[32:35], v[208:211], v[120:123], v[32:35]
    ds_read_b64_tr_b16 v[230:231], v5 offset:61440
    s_waitcnt lgkmcnt(11)
    v_mfma_f32_16x16x32_bf16 v[48:51], v[208:211], v[128:131], v[48:51]
    ds_read_b64_tr_b16 v[232:233], v6 offset:49152
    s_waitcnt lgkmcnt(11)
    v_mfma_f32_16x16x32_bf16 v[48:51], v[212:215], v[132:135], v[48:51]
    ds_read_b64_tr_b16 v[234:235], v6 offset:53248
    s_waitcnt lgkmcnt(11)
    v_mfma_f32_16x16x32_bf16 v[64:67], v[212:215], v[140:143], v[64:67]
    ds_read_b64_tr_b16 v[236:237], v6 offset:57344
    s_waitcnt lgkmcnt(11)
    v_mfma_f32_16x16x32_bf16 v[64:67], v[208:211], v[136:139], v[64:67]
    ds_read_b64_tr_b16 v[238:239], v6 offset:61440
    s_waitcnt lgkmcnt(10)
    v_mfma_f32_16x16x32_bf16 v[68:71], v[216:219], v[136:139], v[68:71]
    s_waitcnt lgkmcnt(8)
    v_mfma_f32_16x16x32_bf16 v[68:71], v[220:223], v[140:143], v[68:71]
    v_mfma_f32_16x16x32_bf16 v[52:55], v[220:223], v[132:135], v[52:55]
    v_mfma_f32_16x16x32_bf16 v[52:55], v[216:219], v[128:131], v[52:55]
    v_mfma_f32_16x16x32_bf16 v[36:39], v[216:219], v[120:123], v[36:39]
    v_mfma_f32_16x16x32_bf16 v[36:39], v[220:223], v[124:127], v[36:39]
    v_mfma_f32_16x16x32_bf16 v[20:23], v[220:223], v[116:119], v[20:23]
    v_mfma_f32_16x16x32_bf16 v[20:23], v[216:219], v[112:115], v[20:23]
    s_waitcnt lgkmcnt(6)
    v_mfma_f32_16x16x32_bf16 v[24:27], v[224:227], v[112:115], v[24:27]
    s_waitcnt lgkmcnt(0)
    s_barrier
    v_mfma_f32_16x16x32_bf16 v[24:27], v[228:231], v[116:119], v[24:27]
    ds_read_b64_tr_b16 v[208:209], v3 offset:0
    ds_read_b64_tr_b16 v[210:211], v3 offset:4096
    v_mfma_f32_16x16x32_bf16 v[40:43], v[228:231], v[124:127], v[40:43]
    ds_read_b128 v[80:83], v1 offset:0
    v_mfma_f32_16x16x32_bf16 v[40:43], v[224:227], v[120:123], v[40:43]
    ds_read_b64_tr_b16 v[212:213], v3 offset:8192
    v_mfma_f32_16x16x32_bf16 v[56:59], v[224:227], v[128:131], v[56:59]
    ds_read_b64_tr_b16 v[214:215], v3 offset:12288
    v_mfma_f32_16x16x32_bf16 v[56:59], v[228:231], v[132:135], v[56:59]
    ds_read_b128 v[84:87], v2 offset:0
    v_mfma_f32_16x16x32_bf16 v[72:75], v[228:231], v[140:143], v[72:75]
    ds_read_b128 v[92:95], v2 offset:2048
    v_mfma_f32_16x16x32_bf16 v[72:75], v[224:227], v[136:139], v[72:75]
    ds_read_b128 v[88:91], v1 offset:2048
    v_mfma_f32_16x16x32_bf16 v[76:79], v[232:235], v[136:139], v[76:79]
    ds_read_b128 v[96:99], v1 offset:4096
    v_add_f32 v34, v242, v34
    v_mfma_f32_16x16x32_bf16 v[76:79], v[236:239], v[140:143], v[76:79]
    ds_read_b128 v[100:103], v2 offset:4096
    v_add_f32 v38, v246, v38
    v_mfma_f32_16x16x32_bf16 v[60:63], v[236:239], v[132:135], v[60:63]
    ds_read_b128 v[108:111], v2 offset:6144
    v_add_f32 v50, v242, v50
    v_mfma_f32_16x16x32_bf16 v[60:63], v[232:235], v[128:131], v[60:63]
    ds_read_b128 v[104:107], v1 offset:6144
    v_add_f32 v54, v246, v54
    v_mfma_f32_16x16x32_bf16 v[44:47], v[232:235], v[120:123], v[44:47]
    ds_read_b64_tr_b16 v[216:217], v4 offset:0
    v_add_f32 v66, v242, v66
    v_mfma_f32_16x16x32_bf16 v[44:47], v[236:239], v[124:127], v[44:47]
    ds_read_b64_tr_b16 v[218:219], v4 offset:4096
    v_add_f32 v70, v246, v70
    v_mfma_f32_16x16x32_bf16 v[28:31], v[236:239], v[116:119], v[28:31]
    ds_read_b64_tr_b16 v[220:221], v4 offset:8192
    v_mfma_f32_16x16x32_bf16 v[28:31], v[232:235], v[112:115], v[28:31]
    ds_read_b64_tr_b16 v[222:223], v4 offset:12288
    s_waitcnt lgkmcnt(13)
    v_mfma_f32_16x16x32_bf16 v[16:19], v[208:211], v[80:83], v[16:19]
    ds_read_b64_tr_b16 v[224:225], v5 offset:0
    s_waitcnt lgkmcnt(11)
    v_mfma_f32_16x16x32_bf16 v[16:19], v[212:215], v[84:87], v[16:19]
    ds_read_b64_tr_b16 v[226:227], v5 offset:4096
    s_waitcnt lgkmcnt(11)
    v_mfma_f32_16x16x32_bf16 v[32:35], v[212:215], v[92:95], v[32:35]
    ds_read_b64_tr_b16 v[228:229], v5 offset:8192
    s_waitcnt lgkmcnt(11)
    v_mfma_f32_16x16x32_bf16 v[32:35], v[208:211], v[88:91], v[32:35]
    ds_read_b64_tr_b16 v[230:231], v5 offset:12288
    s_waitcnt lgkmcnt(11)
    v_mfma_f32_16x16x32_bf16 v[48:51], v[208:211], v[96:99], v[48:51]
    ds_read_b64_tr_b16 v[232:233], v6 offset:0
    s_waitcnt lgkmcnt(11)
    v_mfma_f32_16x16x32_bf16 v[48:51], v[212:215], v[100:103], v[48:51]
    ds_read_b64_tr_b16 v[234:235], v6 offset:4096
    s_waitcnt lgkmcnt(11)
    v_mfma_f32_16x16x32_bf16 v[64:67], v[212:215], v[108:111], v[64:67]
    ds_read_b64_tr_b16 v[236:237], v6 offset:8192
    s_waitcnt lgkmcnt(11)
    v_mfma_f32_16x16x32_bf16 v[64:67], v[208:211], v[104:107], v[64:67]
    ds_read_b64_tr_b16 v[238:239], v6 offset:12288
    s_waitcnt lgkmcnt(10)
    v_mfma_f32_16x16x32_bf16 v[68:71], v[216:219], v[104:107], v[68:71]
    s_waitcnt lgkmcnt(8)
    v_mfma_f32_16x16x32_bf16 v[68:71], v[220:223], v[108:111], v[68:71]
    v_mfma_f32_16x16x32_bf16 v[52:55], v[220:223], v[100:103], v[52:55]
    v_mfma_f32_16x16x32_bf16 v[52:55], v[216:219], v[96:99], v[52:55]
    v_mfma_f32_16x16x32_bf16 v[36:39], v[216:219], v[88:91], v[36:39]
    v_mfma_f32_16x16x32_bf16 v[36:39], v[220:223], v[92:95], v[36:39]
    v_mfma_f32_16x16x32_bf16 v[20:23], v[220:223], v[84:87], v[20:23]
    v_mfma_f32_16x16x32_bf16 v[20:23], v[216:219], v[80:83], v[20:23]
    s_waitcnt lgkmcnt(6)
    v_mfma_f32_16x16x32_bf16 v[24:27], v[224:227], v[80:83], v[24:27]
    s_waitcnt lgkmcnt(0)
    s_barrier
    v_mfma_f32_16x16x32_bf16 v[24:27], v[228:231], v[84:87], v[24:27]
    ds_read_b64_tr_b16 v[208:209], v3 offset:16384
    ds_read_b64_tr_b16 v[210:211], v3 offset:20480
    v_mfma_f32_16x16x32_bf16 v[40:43], v[228:231], v[92:95], v[40:43]
    ds_read_b128 v[112:115], v1 offset:16384
    v_mfma_f32_16x16x32_bf16 v[40:43], v[224:227], v[88:91], v[40:43]
    ds_read_b64_tr_b16 v[212:213], v3 offset:24576
    v_mfma_f32_16x16x32_bf16 v[56:59], v[224:227], v[96:99], v[56:59]
    ds_read_b64_tr_b16 v[214:215], v3 offset:28672
    v_mfma_f32_16x16x32_bf16 v[56:59], v[228:231], v[100:103], v[56:59]
    ds_read_b128 v[116:119], v2 offset:16384
    v_mfma_f32_16x16x32_bf16 v[72:75], v[228:231], v[108:111], v[72:75]
    ds_read_b128 v[124:127], v2 offset:18432
    v_mfma_f32_16x16x32_bf16 v[72:75], v[224:227], v[104:107], v[72:75]
    ds_read_b128 v[120:123], v1 offset:18432
    v_mfma_f32_16x16x32_bf16 v[76:79], v[232:235], v[104:107], v[76:79]
    ds_read_b128 v[128:131], v1 offset:20480
    v_add_f32 v19, v243, v19
    v_mfma_f32_16x16x32_bf16 v[76:79], v[236:239], v[108:111], v[76:79]
    ds_read_b128 v[132:135], v2 offset:20480
    v_add_f32 v23, v247, v23
    v_mfma_f32_16x16x32_bf16 v[60:63], v[236:239], v[100:103], v[60:63]
    ds_read_b128 v[140:143], v2 offset:22528
    v_add_f32 v35, v243, v35
    v_mfma_f32_16x16x32_bf16 v[60:63], v[232:235], v[96:99], v[60:63]
    ds_read_b128 v[136:139], v1 offset:22528
    v_add_f32 v39, v247, v39
    v_mfma_f32_16x16x32_bf16 v[44:47], v[232:235], v[88:91], v[44:47]
    ds_read_b64_tr_b16 v[216:217], v4 offset:16384
    v_add_f32 v51, v243, v51
    v_mfma_f32_16x16x32_bf16 v[44:47], v[236:239], v[92:95], v[44:47]
    ds_read_b64_tr_b16 v[218:219], v4 offset:20480
    v_add_f32 v55, v247, v55
    v_mfma_f32_16x16x32_bf16 v[28:31], v[236:239], v[84:87], v[28:31]
    ds_read_b64_tr_b16 v[220:221], v4 offset:24576
    v_mfma_f32_16x16x32_bf16 v[28:31], v[232:235], v[80:83], v[28:31]
    ds_read_b64_tr_b16 v[222:223], v4 offset:28672
    s_waitcnt lgkmcnt(13)
    v_mfma_f32_16x16x32_bf16 v[16:19], v[208:211], v[112:115], v[16:19]
    ds_read_b64_tr_b16 v[224:225], v5 offset:16384
    s_waitcnt lgkmcnt(11)
    v_mfma_f32_16x16x32_bf16 v[16:19], v[212:215], v[116:119], v[16:19]
    ds_read_b64_tr_b16 v[226:227], v5 offset:20480
    s_waitcnt lgkmcnt(11)
    v_mfma_f32_16x16x32_bf16 v[32:35], v[212:215], v[124:127], v[32:35]
    ds_read_b64_tr_b16 v[228:229], v5 offset:24576
    s_waitcnt lgkmcnt(11)
    v_mfma_f32_16x16x32_bf16 v[32:35], v[208:211], v[120:123], v[32:35]
    ds_read_b64_tr_b16 v[230:231], v5 offset:28672
    s_waitcnt lgkmcnt(11)
    v_mfma_f32_16x16x32_bf16 v[48:51], v[208:211], v[128:131], v[48:51]
    ds_read_b64_tr_b16 v[232:233], v6 offset:16384
    s_waitcnt lgkmcnt(11)
    v_mfma_f32_16x16x32_bf16 v[48:51], v[212:215], v[132:135], v[48:51]
    ds_read_b64_tr_b16 v[234:235], v6 offset:20480
    s_waitcnt lgkmcnt(11)
    v_mfma_f32_16x16x32_bf16 v[64:67], v[212:215], v[140:143], v[64:67]
    ds_read_b64_tr_b16 v[236:237], v6 offset:24576
    s_waitcnt lgkmcnt(11)
    v_mfma_f32_16x16x32_bf16 v[64:67], v[208:211], v[136:139], v[64:67]
    ds_read_b64_tr_b16 v[238:239], v6 offset:28672
    s_waitcnt lgkmcnt(10)
    v_mfma_f32_16x16x32_bf16 v[68:71], v[216:219], v[136:139], v[68:71]
    s_waitcnt lgkmcnt(8)
    v_mfma_f32_16x16x32_bf16 v[68:71], v[220:223], v[140:143], v[68:71]
    v_mfma_f32_16x16x32_bf16 v[52:55], v[220:223], v[132:135], v[52:55]
    v_mfma_f32_16x16x32_bf16 v[52:55], v[216:219], v[128:131], v[52:55]
    v_mfma_f32_16x16x32_bf16 v[36:39], v[216:219], v[120:123], v[36:39]
    v_mfma_f32_16x16x32_bf16 v[36:39], v[220:223], v[124:127], v[36:39]
    v_mfma_f32_16x16x32_bf16 v[20:23], v[220:223], v[116:119], v[20:23]
    v_mfma_f32_16x16x32_bf16 v[20:23], v[216:219], v[112:115], v[20:23]
    s_waitcnt lgkmcnt(6)
    v_mfma_f32_16x16x32_bf16 v[24:27], v[224:227], v[112:115], v[24:27]
    s_waitcnt lgkmcnt(0)
    s_barrier
    v_mfma_f32_16x16x32_bf16 v[24:27], v[228:231], v[116:119], v[24:27]
    ds_read_b64_tr_b16 v[208:209], v3 offset:32768
    ds_read_b64_tr_b16 v[210:211], v3 offset:36864
    v_mfma_f32_16x16x32_bf16 v[40:43], v[228:231], v[124:127], v[40:43]
    ds_read_b128 v[80:83], v1 offset:32768
    v_mfma_f32_16x16x32_bf16 v[40:43], v[224:227], v[120:123], v[40:43]
    ds_read_b64_tr_b16 v[212:213], v3 offset:40960
    v_mfma_f32_16x16x32_bf16 v[56:59], v[224:227], v[128:131], v[56:59]
    ds_read_b64_tr_b16 v[214:215], v3 offset:45056
    v_mfma_f32_16x16x32_bf16 v[56:59], v[228:231], v[132:135], v[56:59]
    ds_read_b128 v[84:87], v2 offset:32768
    v_mfma_f32_16x16x32_bf16 v[72:75], v[228:231], v[140:143], v[72:75]
    ds_read_b128 v[92:95], v2 offset:34816
    v_mfma_f32_16x16x32_bf16 v[72:75], v[224:227], v[136:139], v[72:75]
    ds_read_b128 v[88:91], v1 offset:34816
    v_mfma_f32_16x16x32_bf16 v[76:79], v[232:235], v[136:139], v[76:79]
    ds_read_b128 v[96:99], v1 offset:36864
    v_add_f32 v67, v243, v67
    v_mfma_f32_16x16x32_bf16 v[76:79], v[236:239], v[140:143], v[76:79]
    ds_read_b128 v[100:103], v2 offset:36864
    v_add_f32 v71, v247, v71
    v_mfma_f32_16x16x32_bf16 v[60:63], v[236:239], v[132:135], v[60:63]
    ds_read_b128 v[108:111], v2 offset:38912
    v_mfma_f32_16x16x32_bf16 v[60:63], v[232:235], v[128:131], v[60:63]
    ds_read_b128 v[104:107], v1 offset:38912
    v_mfma_f32_16x16x32_bf16 v[44:47], v[232:235], v[120:123], v[44:47]
    ds_read_b64_tr_b16 v[216:217], v4 offset:32768
    v_mfma_f32_16x16x32_bf16 v[44:47], v[236:239], v[124:127], v[44:47]
    ds_read_b64_tr_b16 v[218:219], v4 offset:36864
    v_mfma_f32_16x16x32_bf16 v[28:31], v[236:239], v[116:119], v[28:31]
    ds_read_b64_tr_b16 v[220:221], v4 offset:40960
    v_mfma_f32_16x16x32_bf16 v[28:31], v[232:235], v[112:115], v[28:31]
    ds_read_b64_tr_b16 v[222:223], v4 offset:45056
    s_waitcnt lgkmcnt(13)
    v_mfma_f32_16x16x32_bf16 v[16:19], v[208:211], v[80:83], v[16:19]
    ds_read_b64_tr_b16 v[224:225], v5 offset:32768
    s_waitcnt lgkmcnt(11)
    v_mfma_f32_16x16x32_bf16 v[16:19], v[212:215], v[84:87], v[16:19]
    ds_read_b64_tr_b16 v[226:227], v5 offset:36864
    s_waitcnt lgkmcnt(11)
    v_mfma_f32_16x16x32_bf16 v[32:35], v[212:215], v[92:95], v[32:35]
    ds_read_b64_tr_b16 v[228:229], v5 offset:40960
    s_waitcnt lgkmcnt(11)
    v_mfma_f32_16x16x32_bf16 v[32:35], v[208:211], v[88:91], v[32:35]
    ds_read_b64_tr_b16 v[230:231], v5 offset:45056
    s_waitcnt lgkmcnt(11)
    v_mfma_f32_16x16x32_bf16 v[48:51], v[208:211], v[96:99], v[48:51]
    ds_read_b64_tr_b16 v[232:233], v6 offset:32768
    s_waitcnt lgkmcnt(11)
    v_mfma_f32_16x16x32_bf16 v[48:51], v[212:215], v[100:103], v[48:51]
    ds_read_b64_tr_b16 v[234:235], v6 offset:36864
    s_waitcnt lgkmcnt(11)
    v_mfma_f32_16x16x32_bf16 v[64:67], v[212:215], v[108:111], v[64:67]
    ds_read_b64_tr_b16 v[236:237], v6 offset:40960
    s_waitcnt lgkmcnt(11)
    v_mfma_f32_16x16x32_bf16 v[64:67], v[208:211], v[104:107], v[64:67]
    ds_read_b64_tr_b16 v[238:239], v6 offset:45056
    s_waitcnt lgkmcnt(10)
    v_mfma_f32_16x16x32_bf16 v[68:71], v[216:219], v[104:107], v[68:71]
    s_waitcnt lgkmcnt(8)
    v_mfma_f32_16x16x32_bf16 v[68:71], v[220:223], v[108:111], v[68:71]
    v_mfma_f32_16x16x32_bf16 v[52:55], v[220:223], v[100:103], v[52:55]
    v_mfma_f32_16x16x32_bf16 v[52:55], v[216:219], v[96:99], v[52:55]
    v_mfma_f32_16x16x32_bf16 v[36:39], v[216:219], v[88:91], v[36:39]
    v_mfma_f32_16x16x32_bf16 v[36:39], v[220:223], v[92:95], v[36:39]
    v_mfma_f32_16x16x32_bf16 v[20:23], v[220:223], v[84:87], v[20:23]
    v_mfma_f32_16x16x32_bf16 v[20:23], v[216:219], v[80:83], v[20:23]
    s_waitcnt lgkmcnt(6)
    v_mfma_f32_16x16x32_bf16 v[24:27], v[224:227], v[80:83], v[24:27]
    s_waitcnt lgkmcnt(0)
    s_barrier
    v_mfma_f32_16x16x32_bf16 v[24:27], v[228:231], v[84:87], v[24:27]
    ds_read_b64_tr_b16 v[208:209], v3 offset:49152
    ds_read_b64_tr_b16 v[210:211], v3 offset:53248
    v_mfma_f32_16x16x32_bf16 v[40:43], v[228:231], v[92:95], v[40:43]
    ds_read_b128 v[112:115], v1 offset:49152
    v_mfma_f32_16x16x32_bf16 v[40:43], v[224:227], v[88:91], v[40:43]
    ds_read_b64_tr_b16 v[212:213], v3 offset:57344
    v_mfma_f32_16x16x32_bf16 v[56:59], v[224:227], v[96:99], v[56:59]
    ds_read_b64_tr_b16 v[214:215], v3 offset:61440
    v_mfma_f32_16x16x32_bf16 v[56:59], v[228:231], v[100:103], v[56:59]
    ds_read_b128 v[116:119], v2 offset:49152
    v_mfma_f32_16x16x32_bf16 v[72:75], v[228:231], v[108:111], v[72:75]
    ds_read_b128 v[124:127], v2 offset:51200
    v_mfma_f32_16x16x32_bf16 v[72:75], v[224:227], v[104:107], v[72:75]
    ds_read_b128 v[120:123], v1 offset:51200
    v_mfma_f32_16x16x32_bf16 v[76:79], v[232:235], v[104:107], v[76:79]
    ds_read_b128 v[128:131], v1 offset:53248
    v_mfma_f32_16x16x32_bf16 v[76:79], v[236:239], v[108:111], v[76:79]
    ds_read_b128 v[132:135], v2 offset:53248
    v_mfma_f32_16x16x32_bf16 v[60:63], v[236:239], v[100:103], v[60:63]
    ds_read_b128 v[140:143], v2 offset:55296
    v_mfma_f32_16x16x32_bf16 v[60:63], v[232:235], v[96:99], v[60:63]
    ds_read_b128 v[136:139], v1 offset:55296
    v_mfma_f32_16x16x32_bf16 v[44:47], v[232:235], v[88:91], v[44:47]
    ds_read_b64_tr_b16 v[216:217], v4 offset:49152
    v_mfma_f32_16x16x32_bf16 v[44:47], v[236:239], v[92:95], v[44:47]
    ds_read_b64_tr_b16 v[218:219], v4 offset:53248
    v_mfma_f32_16x16x32_bf16 v[28:31], v[236:239], v[84:87], v[28:31]
    ds_read_b64_tr_b16 v[220:221], v4 offset:57344
    v_mfma_f32_16x16x32_bf16 v[28:31], v[232:235], v[80:83], v[28:31]
    ds_read_b64_tr_b16 v[222:223], v4 offset:61440
    s_waitcnt lgkmcnt(13)
    v_mfma_f32_16x16x32_bf16 v[16:19], v[208:211], v[112:115], v[16:19]
    ds_read_b64_tr_b16 v[224:225], v5 offset:49152
    s_waitcnt lgkmcnt(11)
    v_mfma_f32_16x16x32_bf16 v[16:19], v[212:215], v[116:119], v[16:19]
    ds_read_b64_tr_b16 v[226:227], v5 offset:53248
    s_waitcnt lgkmcnt(11)
    v_mfma_f32_16x16x32_bf16 v[32:35], v[212:215], v[124:127], v[32:35]
    ds_read_b64_tr_b16 v[228:229], v5 offset:57344
    s_waitcnt lgkmcnt(11)
    v_mfma_f32_16x16x32_bf16 v[32:35], v[208:211], v[120:123], v[32:35]
    ds_read_b64_tr_b16 v[230:231], v5 offset:61440
    s_waitcnt lgkmcnt(11)
    v_mfma_f32_16x16x32_bf16 v[48:51], v[208:211], v[128:131], v[48:51]
    ds_read_b64_tr_b16 v[232:233], v6 offset:49152
    s_waitcnt lgkmcnt(11)
    v_mfma_f32_16x16x32_bf16 v[48:51], v[212:215], v[132:135], v[48:51]
    ds_read_b64_tr_b16 v[234:235], v6 offset:53248
    s_waitcnt lgkmcnt(11)
    v_mfma_f32_16x16x32_bf16 v[64:67], v[212:215], v[140:143], v[64:67]
    ds_read_b64_tr_b16 v[236:237], v6 offset:57344
    s_waitcnt lgkmcnt(11)
    v_mfma_f32_16x16x32_bf16 v[64:67], v[208:211], v[136:139], v[64:67]
    ds_read_b64_tr_b16 v[238:239], v6 offset:61440
    s_waitcnt lgkmcnt(10)
    v_mfma_f32_16x16x32_bf16 v[68:71], v[216:219], v[136:139], v[68:71]
    s_waitcnt lgkmcnt(8)
    v_mfma_f32_16x16x32_bf16 v[68:71], v[220:223], v[140:143], v[68:71]
    v_mfma_f32_16x16x32_bf16 v[52:55], v[220:223], v[132:135], v[52:55]
    v_mfma_f32_16x16x32_bf16 v[52:55], v[216:219], v[128:131], v[52:55]
    v_mfma_f32_16x16x32_bf16 v[36:39], v[216:219], v[120:123], v[36:39]
    v_mfma_f32_16x16x32_bf16 v[36:39], v[220:223], v[124:127], v[36:39]
    v_mfma_f32_16x16x32_bf16 v[20:23], v[220:223], v[116:119], v[20:23]
    v_mfma_f32_16x16x32_bf16 v[20:23], v[216:219], v[112:115], v[20:23]
    s_waitcnt lgkmcnt(6)
    v_mfma_f32_16x16x32_bf16 v[24:27], v[224:227], v[112:115], v[24:27]
    s_waitcnt lgkmcnt(0)
    s_barrier
    v_mfma_f32_16x16x32_bf16 v[24:27], v[228:231], v[116:119], v[24:27]
    ds_read_b64_tr_b16 v[208:209], v3 offset:0
    ds_read_b64_tr_b16 v[210:211], v3 offset:4096
    v_mfma_f32_16x16x32_bf16 v[40:43], v[228:231], v[124:127], v[40:43]
    ds_read_b128 v[80:83], v1 offset:0
    v_mfma_f32_16x16x32_bf16 v[40:43], v[224:227], v[120:123], v[40:43]
    ds_read_b64_tr_b16 v[212:213], v3 offset:8192
    v_mfma_f32_16x16x32_bf16 v[56:59], v[224:227], v[128:131], v[56:59]
    ds_read_b64_tr_b16 v[214:215], v3 offset:12288
    v_mfma_f32_16x16x32_bf16 v[56:59], v[228:231], v[132:135], v[56:59]
    ds_read_b128 v[84:87], v2 offset:0
    v_mfma_f32_16x16x32_bf16 v[72:75], v[228:231], v[140:143], v[72:75]
    ds_read_b128 v[92:95], v2 offset:2048
    v_mfma_f32_16x16x32_bf16 v[72:75], v[224:227], v[136:139], v[72:75]
    ds_read_b128 v[88:91], v1 offset:2048
    v_mfma_f32_16x16x32_bf16 v[76:79], v[232:235], v[136:139], v[76:79]
    ds_read_b128 v[96:99], v1 offset:4096
    v_mfma_f32_16x16x32_bf16 v[76:79], v[236:239], v[140:143], v[76:79]
    ds_read_b128 v[100:103], v2 offset:4096
    v_mfma_f32_16x16x32_bf16 v[60:63], v[236:239], v[132:135], v[60:63]
    ds_read_b128 v[108:111], v2 offset:6144
    v_mfma_f32_16x16x32_bf16 v[60:63], v[232:235], v[128:131], v[60:63]
    ds_read_b128 v[104:107], v1 offset:6144
    v_mfma_f32_16x16x32_bf16 v[44:47], v[232:235], v[120:123], v[44:47]
    ds_read_b64_tr_b16 v[216:217], v4 offset:0
    v_mfma_f32_16x16x32_bf16 v[44:47], v[236:239], v[124:127], v[44:47]
    ds_read_b64_tr_b16 v[218:219], v4 offset:4096
    v_mfma_f32_16x16x32_bf16 v[28:31], v[236:239], v[116:119], v[28:31]
    ds_read_b64_tr_b16 v[220:221], v4 offset:8192
    v_mfma_f32_16x16x32_bf16 v[28:31], v[232:235], v[112:115], v[28:31]
    ds_read_b64_tr_b16 v[222:223], v4 offset:12288
    s_waitcnt lgkmcnt(13)
    v_mfma_f32_16x16x32_bf16 v[16:19], v[208:211], v[80:83], v[16:19]
    ds_read_b64_tr_b16 v[224:225], v5 offset:0
    s_waitcnt lgkmcnt(11)
    v_mfma_f32_16x16x32_bf16 v[16:19], v[212:215], v[84:87], v[16:19]
    ds_read_b64_tr_b16 v[226:227], v5 offset:4096
    s_waitcnt lgkmcnt(11)
    v_mfma_f32_16x16x32_bf16 v[32:35], v[212:215], v[92:95], v[32:35]
    ds_read_b64_tr_b16 v[228:229], v5 offset:8192
    s_waitcnt lgkmcnt(11)
    v_mfma_f32_16x16x32_bf16 v[32:35], v[208:211], v[88:91], v[32:35]
    ds_read_b64_tr_b16 v[230:231], v5 offset:12288
    s_waitcnt lgkmcnt(11)
    v_mfma_f32_16x16x32_bf16 v[48:51], v[208:211], v[96:99], v[48:51]
    ds_read_b64_tr_b16 v[232:233], v6 offset:0
    s_waitcnt lgkmcnt(11)
    v_mfma_f32_16x16x32_bf16 v[48:51], v[212:215], v[100:103], v[48:51]
    ds_read_b64_tr_b16 v[234:235], v6 offset:4096
    s_waitcnt lgkmcnt(11)
    v_mfma_f32_16x16x32_bf16 v[64:67], v[212:215], v[108:111], v[64:67]
    ds_read_b64_tr_b16 v[236:237], v6 offset:8192
    s_waitcnt lgkmcnt(11)
    v_mfma_f32_16x16x32_bf16 v[64:67], v[208:211], v[104:107], v[64:67]
    ds_read_b64_tr_b16 v[238:239], v6 offset:12288
    s_waitcnt lgkmcnt(10)
    v_mfma_f32_16x16x32_bf16 v[68:71], v[216:219], v[104:107], v[68:71]
    s_waitcnt lgkmcnt(8)
    v_mfma_f32_16x16x32_bf16 v[68:71], v[220:223], v[108:111], v[68:71]
    v_mfma_f32_16x16x32_bf16 v[52:55], v[220:223], v[100:103], v[52:55]
    v_mfma_f32_16x16x32_bf16 v[52:55], v[216:219], v[96:99], v[52:55]
    v_mfma_f32_16x16x32_bf16 v[36:39], v[216:219], v[88:91], v[36:39]
    v_mfma_f32_16x16x32_bf16 v[36:39], v[220:223], v[92:95], v[36:39]
    v_mfma_f32_16x16x32_bf16 v[20:23], v[220:223], v[84:87], v[20:23]
    v_mfma_f32_16x16x32_bf16 v[20:23], v[216:219], v[80:83], v[20:23]
    s_waitcnt lgkmcnt(6)
    v_mfma_f32_16x16x32_bf16 v[24:27], v[224:227], v[80:83], v[24:27]
    s_waitcnt lgkmcnt(0)
    s_barrier
    v_mfma_f32_16x16x32_bf16 v[24:27], v[228:231], v[84:87], v[24:27]
    ds_read_b64_tr_b16 v[208:209], v3 offset:16384
    ds_read_b64_tr_b16 v[210:211], v3 offset:20480
    v_mfma_f32_16x16x32_bf16 v[40:43], v[228:231], v[92:95], v[40:43]
    ds_read_b128 v[112:115], v1 offset:16384
    v_mfma_f32_16x16x32_bf16 v[40:43], v[224:227], v[88:91], v[40:43]
    ds_read_b64_tr_b16 v[212:213], v3 offset:24576
    v_mfma_f32_16x16x32_bf16 v[56:59], v[224:227], v[96:99], v[56:59]
    ds_read_b64_tr_b16 v[214:215], v3 offset:28672
    v_mfma_f32_16x16x32_bf16 v[56:59], v[228:231], v[100:103], v[56:59]
    ds_read_b128 v[116:119], v2 offset:16384
    v_mfma_f32_16x16x32_bf16 v[72:75], v[228:231], v[108:111], v[72:75]
    ds_read_b128 v[124:127], v2 offset:18432
    v_mfma_f32_16x16x32_bf16 v[72:75], v[224:227], v[104:107], v[72:75]
    ds_read_b128 v[120:123], v1 offset:18432
    v_mfma_f32_16x16x32_bf16 v[76:79], v[232:235], v[104:107], v[76:79]
    ds_read_b128 v[128:131], v1 offset:20480
    v_mfma_f32_16x16x32_bf16 v[76:79], v[236:239], v[108:111], v[76:79]
    ds_read_b128 v[132:135], v2 offset:20480
    v_mfma_f32_16x16x32_bf16 v[60:63], v[236:239], v[100:103], v[60:63]
    ds_read_b128 v[140:143], v2 offset:22528
    v_mfma_f32_16x16x32_bf16 v[60:63], v[232:235], v[96:99], v[60:63]
    ds_read_b128 v[136:139], v1 offset:22528
    v_mfma_f32_16x16x32_bf16 v[44:47], v[232:235], v[88:91], v[44:47]
    ds_read_b64_tr_b16 v[216:217], v4 offset:16384
    v_mfma_f32_16x16x32_bf16 v[44:47], v[236:239], v[92:95], v[44:47]
    ds_read_b64_tr_b16 v[218:219], v4 offset:20480
    v_mfma_f32_16x16x32_bf16 v[28:31], v[236:239], v[84:87], v[28:31]
    ds_read_b64_tr_b16 v[220:221], v4 offset:24576
    v_mfma_f32_16x16x32_bf16 v[28:31], v[232:235], v[80:83], v[28:31]
    ds_read_b64_tr_b16 v[222:223], v4 offset:28672
    s_waitcnt lgkmcnt(13)
    v_mfma_f32_16x16x32_bf16 v[16:19], v[208:211], v[112:115], v[16:19]
    ds_read_b64_tr_b16 v[224:225], v5 offset:16384
    s_waitcnt lgkmcnt(11)
    v_mfma_f32_16x16x32_bf16 v[16:19], v[212:215], v[116:119], v[16:19]
    ds_read_b64_tr_b16 v[226:227], v5 offset:20480
    s_waitcnt lgkmcnt(11)
    v_mfma_f32_16x16x32_bf16 v[32:35], v[212:215], v[124:127], v[32:35]
    ds_read_b64_tr_b16 v[228:229], v5 offset:24576
    s_waitcnt lgkmcnt(11)
    v_mfma_f32_16x16x32_bf16 v[32:35], v[208:211], v[120:123], v[32:35]
    ds_read_b64_tr_b16 v[230:231], v5 offset:28672
    s_waitcnt lgkmcnt(11)
    v_mfma_f32_16x16x32_bf16 v[48:51], v[208:211], v[128:131], v[48:51]
    ds_read_b64_tr_b16 v[232:233], v6 offset:16384
    s_waitcnt lgkmcnt(11)
    v_mfma_f32_16x16x32_bf16 v[48:51], v[212:215], v[132:135], v[48:51]
    ds_read_b64_tr_b16 v[234:235], v6 offset:20480
    s_waitcnt lgkmcnt(11)
    v_mfma_f32_16x16x32_bf16 v[64:67], v[212:215], v[140:143], v[64:67]
    ds_read_b64_tr_b16 v[236:237], v6 offset:24576
    s_waitcnt lgkmcnt(11)
    v_mfma_f32_16x16x32_bf16 v[64:67], v[208:211], v[136:139], v[64:67]
    ds_read_b64_tr_b16 v[238:239], v6 offset:28672
    s_waitcnt lgkmcnt(10)
    v_mfma_f32_16x16x32_bf16 v[68:71], v[216:219], v[136:139], v[68:71]
    s_waitcnt lgkmcnt(8)
    v_mfma_f32_16x16x32_bf16 v[68:71], v[220:223], v[140:143], v[68:71]
    v_mfma_f32_16x16x32_bf16 v[52:55], v[220:223], v[132:135], v[52:55]
    v_mfma_f32_16x16x32_bf16 v[52:55], v[216:219], v[128:131], v[52:55]
    v_mfma_f32_16x16x32_bf16 v[36:39], v[216:219], v[120:123], v[36:39]
    v_mfma_f32_16x16x32_bf16 v[36:39], v[220:223], v[124:127], v[36:39]
    v_mfma_f32_16x16x32_bf16 v[20:23], v[220:223], v[116:119], v[20:23]
    v_mfma_f32_16x16x32_bf16 v[20:23], v[216:219], v[112:115], v[20:23]
    s_waitcnt lgkmcnt(6)
    v_mfma_f32_16x16x32_bf16 v[24:27], v[224:227], v[112:115], v[24:27]
    s_waitcnt lgkmcnt(0)
    s_barrier
    v_mfma_f32_16x16x32_bf16 v[24:27], v[228:231], v[116:119], v[24:27]
    ds_read_b64_tr_b16 v[208:209], v3 offset:32768
    ds_read_b64_tr_b16 v[210:211], v3 offset:36864
    v_mfma_f32_16x16x32_bf16 v[40:43], v[228:231], v[124:127], v[40:43]
    ds_read_b128 v[80:83], v1 offset:32768
    v_mfma_f32_16x16x32_bf16 v[40:43], v[224:227], v[120:123], v[40:43]
    ds_read_b64_tr_b16 v[212:213], v3 offset:40960
    v_mfma_f32_16x16x32_bf16 v[56:59], v[224:227], v[128:131], v[56:59]
    ds_read_b64_tr_b16 v[214:215], v3 offset:45056
    v_mfma_f32_16x16x32_bf16 v[56:59], v[228:231], v[132:135], v[56:59]
    ds_read_b128 v[84:87], v2 offset:32768
    v_mfma_f32_16x16x32_bf16 v[72:75], v[228:231], v[140:143], v[72:75]
    ds_read_b128 v[92:95], v2 offset:34816
    v_mfma_f32_16x16x32_bf16 v[72:75], v[224:227], v[136:139], v[72:75]
    ds_read_b128 v[88:91], v1 offset:34816
    v_mfma_f32_16x16x32_bf16 v[76:79], v[232:235], v[136:139], v[76:79]
    ds_read_b128 v[96:99], v1 offset:36864
    v_mfma_f32_16x16x32_bf16 v[76:79], v[236:239], v[140:143], v[76:79]
    ds_read_b128 v[100:103], v2 offset:36864
    v_mfma_f32_16x16x32_bf16 v[60:63], v[236:239], v[132:135], v[60:63]
    ds_read_b128 v[108:111], v2 offset:38912
    v_mfma_f32_16x16x32_bf16 v[60:63], v[232:235], v[128:131], v[60:63]
    ds_read_b128 v[104:107], v1 offset:38912
    v_mfma_f32_16x16x32_bf16 v[44:47], v[232:235], v[120:123], v[44:47]
    ds_read_b64_tr_b16 v[216:217], v4 offset:32768
    v_mfma_f32_16x16x32_bf16 v[44:47], v[236:239], v[124:127], v[44:47]
    ds_read_b64_tr_b16 v[218:219], v4 offset:36864
    v_mfma_f32_16x16x32_bf16 v[28:31], v[236:239], v[116:119], v[28:31]
    ds_read_b64_tr_b16 v[220:221], v4 offset:40960
    v_mfma_f32_16x16x32_bf16 v[28:31], v[232:235], v[112:115], v[28:31]
    ds_read_b64_tr_b16 v[222:223], v4 offset:45056
    s_waitcnt lgkmcnt(13)
    v_mfma_f32_16x16x32_bf16 v[16:19], v[208:211], v[80:83], v[16:19]
    ds_read_b64_tr_b16 v[224:225], v5 offset:32768
    s_waitcnt lgkmcnt(11)
    v_mfma_f32_16x16x32_bf16 v[16:19], v[212:215], v[84:87], v[16:19]
    ds_read_b64_tr_b16 v[226:227], v5 offset:36864
    s_waitcnt lgkmcnt(11)
    v_mfma_f32_16x16x32_bf16 v[32:35], v[212:215], v[92:95], v[32:35]
    ds_read_b64_tr_b16 v[228:229], v5 offset:40960
    s_waitcnt lgkmcnt(11)
    v_mfma_f32_16x16x32_bf16 v[32:35], v[208:211], v[88:91], v[32:35]
    ds_read_b64_tr_b16 v[230:231], v5 offset:45056
    s_waitcnt lgkmcnt(11)
    v_mfma_f32_16x16x32_bf16 v[48:51], v[208:211], v[96:99], v[48:51]
    ds_read_b64_tr_b16 v[232:233], v6 offset:32768
    s_waitcnt lgkmcnt(11)
    v_mfma_f32_16x16x32_bf16 v[48:51], v[212:215], v[100:103], v[48:51]
    ds_read_b64_tr_b16 v[234:235], v6 offset:36864
    s_waitcnt lgkmcnt(11)
    v_mfma_f32_16x16x32_bf16 v[64:67], v[212:215], v[108:111], v[64:67]
    ds_read_b64_tr_b16 v[236:237], v6 offset:40960
    s_waitcnt lgkmcnt(11)
    v_mfma_f32_16x16x32_bf16 v[64:67], v[208:211], v[104:107], v[64:67]
    ds_read_b64_tr_b16 v[238:239], v6 offset:45056
    s_waitcnt lgkmcnt(10)
    v_mfma_f32_16x16x32_bf16 v[68:71], v[216:219], v[104:107], v[68:71]
    s_waitcnt lgkmcnt(8)
    v_mfma_f32_16x16x32_bf16 v[68:71], v[220:223], v[108:111], v[68:71]
    v_mfma_f32_16x16x32_bf16 v[52:55], v[220:223], v[100:103], v[52:55]
    v_mfma_f32_16x16x32_bf16 v[52:55], v[216:219], v[96:99], v[52:55]
    v_mfma_f32_16x16x32_bf16 v[36:39], v[216:219], v[88:91], v[36:39]
    v_mfma_f32_16x16x32_bf16 v[36:39], v[220:223], v[92:95], v[36:39]
    v_mfma_f32_16x16x32_bf16 v[20:23], v[220:223], v[84:87], v[20:23]
    v_mfma_f32_16x16x32_bf16 v[20:23], v[216:219], v[80:83], v[20:23]
    s_waitcnt lgkmcnt(6)
    v_mfma_f32_16x16x32_bf16 v[24:27], v[224:227], v[80:83], v[24:27]
    s_waitcnt lgkmcnt(0)
    s_barrier
    v_mfma_f32_16x16x32_bf16 v[24:27], v[228:231], v[84:87], v[24:27]
    ds_read_b64_tr_b16 v[208:209], v3 offset:49152
    ds_read_b64_tr_b16 v[210:211], v3 offset:53248
    v_mfma_f32_16x16x32_bf16 v[40:43], v[228:231], v[92:95], v[40:43]
    ds_read_b128 v[112:115], v1 offset:49152
    v_mfma_f32_16x16x32_bf16 v[40:43], v[224:227], v[88:91], v[40:43]
    ds_read_b64_tr_b16 v[212:213], v3 offset:57344
    v_mfma_f32_16x16x32_bf16 v[56:59], v[224:227], v[96:99], v[56:59]
    ds_read_b64_tr_b16 v[214:215], v3 offset:61440
    v_mfma_f32_16x16x32_bf16 v[56:59], v[228:231], v[100:103], v[56:59]
    ds_read_b128 v[116:119], v2 offset:49152
    v_mfma_f32_16x16x32_bf16 v[72:75], v[228:231], v[108:111], v[72:75]
    ds_read_b128 v[124:127], v2 offset:51200
    v_mfma_f32_16x16x32_bf16 v[72:75], v[224:227], v[104:107], v[72:75]
    ds_read_b128 v[120:123], v1 offset:51200
    v_mfma_f32_16x16x32_bf16 v[76:79], v[232:235], v[104:107], v[76:79]
    ds_read_b128 v[128:131], v1 offset:53248
    v_mfma_f32_16x16x32_bf16 v[76:79], v[236:239], v[108:111], v[76:79]
    ds_read_b128 v[132:135], v2 offset:53248
    v_mfma_f32_16x16x32_bf16 v[60:63], v[236:239], v[100:103], v[60:63]
    ds_read_b128 v[140:143], v2 offset:55296
    v_mfma_f32_16x16x32_bf16 v[60:63], v[232:235], v[96:99], v[60:63]
    ds_read_b128 v[136:139], v1 offset:55296
    v_mfma_f32_16x16x32_bf16 v[44:47], v[232:235], v[88:91], v[44:47]
    ds_read_b64_tr_b16 v[216:217], v4 offset:49152
    v_mfma_f32_16x16x32_bf16 v[44:47], v[236:239], v[92:95], v[44:47]
    ds_read_b64_tr_b16 v[218:219], v4 offset:53248
    v_mfma_f32_16x16x32_bf16 v[28:31], v[236:239], v[84:87], v[28:31]
    ds_read_b64_tr_b16 v[220:221], v4 offset:57344
    v_mfma_f32_16x16x32_bf16 v[28:31], v[232:235], v[80:83], v[28:31]
    ds_read_b64_tr_b16 v[222:223], v4 offset:61440
    s_waitcnt lgkmcnt(13)
    v_mfma_f32_16x16x32_bf16 v[16:19], v[208:211], v[112:115], v[16:19]
    ds_read_b64_tr_b16 v[224:225], v5 offset:49152
    s_waitcnt lgkmcnt(11)
    v_mfma_f32_16x16x32_bf16 v[16:19], v[212:215], v[116:119], v[16:19]
    ds_read_b64_tr_b16 v[226:227], v5 offset:53248
    s_waitcnt lgkmcnt(11)
    v_mfma_f32_16x16x32_bf16 v[32:35], v[212:215], v[124:127], v[32:35]
    ds_read_b64_tr_b16 v[228:229], v5 offset:57344
    s_waitcnt lgkmcnt(11)
    v_mfma_f32_16x16x32_bf16 v[32:35], v[208:211], v[120:123], v[32:35]
    ds_read_b64_tr_b16 v[230:231], v5 offset:61440
    s_waitcnt lgkmcnt(11)
    v_mfma_f32_16x16x32_bf16 v[48:51], v[208:211], v[128:131], v[48:51]
    ds_read_b64_tr_b16 v[232:233], v6 offset:49152
    s_waitcnt lgkmcnt(11)
    v_mfma_f32_16x16x32_bf16 v[48:51], v[212:215], v[132:135], v[48:51]
    ds_read_b64_tr_b16 v[234:235], v6 offset:53248
    s_waitcnt lgkmcnt(11)
    v_mfma_f32_16x16x32_bf16 v[64:67], v[212:215], v[140:143], v[64:67]
    ds_read_b64_tr_b16 v[236:237], v6 offset:57344
    s_waitcnt lgkmcnt(11)
    v_mfma_f32_16x16x32_bf16 v[64:67], v[208:211], v[136:139], v[64:67]
    ds_read_b64_tr_b16 v[238:239], v6 offset:61440
    s_waitcnt lgkmcnt(10)
    v_mfma_f32_16x16x32_bf16 v[68:71], v[216:219], v[136:139], v[68:71]
    s_waitcnt lgkmcnt(8)
    v_mfma_f32_16x16x32_bf16 v[68:71], v[220:223], v[140:143], v[68:71]
    v_mfma_f32_16x16x32_bf16 v[52:55], v[220:223], v[132:135], v[52:55]
    v_mfma_f32_16x16x32_bf16 v[52:55], v[216:219], v[128:131], v[52:55]
    v_mfma_f32_16x16x32_bf16 v[36:39], v[216:219], v[120:123], v[36:39]
    v_mfma_f32_16x16x32_bf16 v[36:39], v[220:223], v[124:127], v[36:39]
    v_mfma_f32_16x16x32_bf16 v[20:23], v[220:223], v[116:119], v[20:23]
    v_mfma_f32_16x16x32_bf16 v[20:23], v[216:219], v[112:115], v[20:23]
    s_waitcnt lgkmcnt(6)
    v_mfma_f32_16x16x32_bf16 v[24:27], v[224:227], v[112:115], v[24:27]
    s_waitcnt lgkmcnt(0)
    s_barrier
    v_mfma_f32_16x16x32_bf16 v[24:27], v[228:231], v[116:119], v[24:27]
    ds_read_b64_tr_b16 v[208:209], v3 offset:0
    v_mfma_f32_16x16x32_bf16 v[40:43], v[228:231], v[124:127], v[40:43]
    ds_read_b64_tr_b16 v[210:211], v3 offset:4096
    v_mfma_f32_16x16x32_bf16 v[40:43], v[224:227], v[120:123], v[40:43]
    ds_read_b64_tr_b16 v[212:213], v3 offset:8192
    v_mfma_f32_16x16x32_bf16 v[56:59], v[224:227], v[128:131], v[56:59]
    ds_read_b64_tr_b16 v[214:215], v3 offset:12288
    v_mfma_f32_16x16x32_bf16 v[56:59], v[228:231], v[132:135], v[56:59]
    ds_read_b64_tr_b16 v[216:217], v4 offset:0
    v_mfma_f32_16x16x32_bf16 v[72:75], v[228:231], v[140:143], v[72:75]
    ds_read_b64_tr_b16 v[218:219], v4 offset:4096
    v_mfma_f32_16x16x32_bf16 v[72:75], v[224:227], v[136:139], v[72:75]
    ds_read_b64_tr_b16 v[220:221], v4 offset:8192
    v_mfma_f32_16x16x32_bf16 v[76:79], v[232:235], v[136:139], v[76:79]
    ds_read_b64_tr_b16 v[222:223], v4 offset:12288
    v_mfma_f32_16x16x32_bf16 v[76:79], v[236:239], v[140:143], v[76:79]
    v_mfma_f32_16x16x32_bf16 v[60:63], v[236:239], v[132:135], v[60:63]
    v_mfma_f32_16x16x32_bf16 v[60:63], v[232:235], v[128:131], v[60:63]
    v_mfma_f32_16x16x32_bf16 v[44:47], v[232:235], v[120:123], v[44:47]
    v_mfma_f32_16x16x32_bf16 v[44:47], v[236:239], v[124:127], v[44:47]
    v_mfma_f32_16x16x32_bf16 v[28:31], v[236:239], v[116:119], v[28:31]
    v_mfma_f32_16x16x32_bf16 v[28:31], v[232:235], v[112:115], v[28:31]
    s_nop 8
    s_cmp_eq_u32 s74, 0
    s_cbranch_scc1 L_slow1
    v_pk_mul_f32 v[112:113], v[144:145], v[16:17]
    v_pk_mul_f32 v[114:115], v[146:147], v[18:19]
    v_pk_mul_f32 v[116:117], v[148:149], v[20:21]
    v_pk_mul_f32 v[118:119], v[150:151], v[22:23]
    v_cvt_pk_bf16_f32 v80, v112, v113
    v_cvt_pk_bf16_f32 v81, v114, v115
    v_cvt_pk_bf16_f32 v82, v116, v117
    v_cvt_pk_bf16_f32 v83, v118, v119
    buffer_store_dwordx4 v[80:83], v8, s[16:19], s60 offen offset:0
    ds_write_b128 v7, v[80:83] offset:0
    v_pk_mul_f32 v[120:121], v[152:153], v[24:25]
    v_pk_mul_f32 v[122:123], v[154:155], v[26:27]
    v_pk_mul_f32 v[124:125], v[156:157], v[28:29]
    v_pk_mul_f32 v[126:127], v[158:159], v[30:31]
    v_cvt_pk_bf16_f32 v84, v120, v121
    v_cvt_pk_bf16_f32 v85, v122, v123
    v_cvt_pk_bf16_f32 v86, v124, v125
    v_cvt_pk_bf16_f32 v87, v126, v127
    buffer_store_dwordx4 v[84:87], v8, s[16:19], s60 offen offset:1024
    ds_write_b128 v7, v[84:87] offset:1024
    v_pk_mul_f32 v[128:129], v[160:161], v[32:33]
    v_pk_mul_f32 v[130:131], v[162:163], v[34:35]
    v_pk_mul_f32 v[132:133], v[164:165], v[36:37]
    v_pk_mul_f32 v[134:135], v[166:167], v[38:39]
    v_cvt_pk_bf16_f32 v88, v128, v129
    v_cvt_pk_bf16_f32 v89, v130, v131
    v_cvt_pk_bf16_f32 v90, v132, v133
    v_cvt_pk_bf16_f32 v91, v134, v135
    buffer_store_dwordx4 v[88:91], v8, s[16:19], s60 offen offset:2048
    ds_write_b128 v7, v[88:91] offset:2048
    v_pk_mul_f32 v[136:137], v[168:169], v[40:41]
    v_pk_mul_f32 v[138:139], v[170:171], v[42:43]
    v_pk_mul_f32 v[140:141], v[172:173], v[44:45]
    v_pk_mul_f32 v[142:143], v[174:175], v[46:47]
    v_cvt_pk_bf16_f32 v92, v136, v137
    v_cvt_pk_bf16_f32 v93, v138, v139
    v_cvt_pk_bf16_f32 v94, v140, v141
    v_cvt_pk_bf16_f32 v95, v142, v143
    buffer_store_dwordx4 v[92:95], v8, s[16:19], s60 offen offset:3072
    ds_write_b128 v7, v[92:95] offset:3072
    v_pk_mul_f32 v[112:113], v[176:177], v[48:49]
    v_pk_mul_f32 v[114:115], v[178:179], v[50:51]
    v_pk_mul_f32 v[116:117], v[180:181], v[52:53]
    v_pk_mul_f32 v[118:119], v[182:183], v[54:55]
    v_cvt_pk_bf16_f32 v96, v112, v113
    v_cvt_pk_bf16_f32 v97, v114, v115
    v_cvt_pk_bf16_f32 v98, v116, v117
    v_cvt_pk_bf16_f32 v99, v118, v119
    buffer_store_dwordx4 v[96:99], v8, s[16:19], s61 offen offset:0
    ds_write_b128 v7, v[96:99] offset:4096
    v_pk_mul_f32 v[120:121], v[184:185], v[56:57]
    v_pk_mul_f32 v[122:123], v[186:187], v[58:59]
    v_pk_mul_f32 v[124:125], v[188:189], v[60:61]
    v_pk_mul_f32 v[126:127], v[190:191], v[62:63]
    v_cvt_pk_bf16_f32 v100, v120, v121
    v_cvt_pk_bf16_f32 v101, v122, v123
    v_cvt_pk_bf16_f32 v102, v124, v125
    v_cvt_pk_bf16_f32 v103, v126, v127
    buffer_store_dwordx4 v[100:103], v8, s[16:19], s61 offen offset:1024
    ds_write_b128 v7, v[100:103] offset:5120
    v_pk_mul_f32 v[128:129], v[192:193], v[64:65]
    v_pk_mul_f32 v[130:131], v[194:195], v[66:67]
    v_pk_mul_f32 v[132:133], v[196:197], v[68:69]
    v_pk_mul_f32 v[134:135], v[198:199], v[70:71]
    v_cvt_pk_bf16_f32 v104, v128, v129
    v_cvt_pk_bf16_f32 v105, v130, v131
    v_cvt_pk_bf16_f32 v106, v132, v133
    v_cvt_pk_bf16_f32 v107, v134, v135
    buffer_store_dwordx4 v[104:107], v8, s[16:19], s61 offen offset:2048
    ds_write_b128 v7, v[104:107] offset:6144
    v_pk_mul_f32 v[136:137], v[200:201], v[72:73]
    v_pk_mul_f32 v[138:139], v[202:203], v[74:75]
    v_pk_mul_f32 v[140:141], v[204:205], v[76:77]
    v_pk_mul_f32 v[142:143], v[206:207], v[78:79]
    v_cvt_pk_bf16_f32 v108, v136, v137
    v_cvt_pk_bf16_f32 v109, v138, v139
    v_cvt_pk_bf16_f32 v110, v140, v141
    v_cvt_pk_bf16_f32 v111, v142, v143
    buffer_store_dwordx4 v[108:111], v8, s[16:19], s61 offen offset:3072
    ds_write_b128 v7, v[108:111] offset:7168
    s_branch L_join1
L_slow1:
    v_pk_mul_f32 v[112:113], v[144:145], v[16:17]
    v_pk_mul_f32 v[114:115], v[146:147], v[18:19]
    v_pk_mul_f32 v[116:117], v[148:149], v[20:21]
    v_pk_mul_f32 v[118:119], v[150:151], v[22:23]
    v_cvt_pk_bf16_f32 v80, v112, v113
    v_cvt_pk_bf16_f32 v81, v114, v115
    v_cvt_pk_bf16_f32 v82, v116, v117
    v_cvt_pk_bf16_f32 v83, v118, v119
    buffer_store_dwordx4 v[80:83], v8, s[16:19], s60 offen offset:0 sc1
    ds_write_b128 v7, v[80:83] offset:0
    v_pk_mul_f32 v[120:121], v[152:153], v[24:25]
    v_pk_mul_f32 v[122:123], v[154:155], v[26:27]
    v_pk_mul_f32 v[124:125], v[156:157], v[28:29]
    v_pk_mul_f32 v[126:127], v[158:159], v[30:31]
    v_cvt_pk_bf16_f32 v84, v120, v121
    v_cvt_pk_bf16_f32 v85, v122, v123
    v_cvt_pk_bf16_f32 v86, v124, v125
    v_cvt_pk_bf16_f32 v87, v126, v127
    buffer_store_dwordx4 v[84:87], v8, s[16:19], s60 offen offset:1024 sc1
    ds_write_b128 v7, v[84:87] offset:1024
    v_pk_mul_f32 v[128:129], v[160:161], v[32:33]
    v_pk_mul_f32 v[130:131], v[162:163], v[34:35]
    v_pk_mul_f32 v[132:133], v[164:165], v[36:37]
    v_pk_mul_f32 v[134:135], v[166:167], v[38:39]
    v_cvt_pk_bf16_f32 v88, v128, v129
    v_cvt_pk_bf16_f32 v89, v130, v131
    v_cvt_pk_bf16_f32 v90, v132, v133
    v_cvt_pk_bf16_f32 v91, v134, v135
    buffer_store_dwordx4 v[88:91], v8, s[16:19], s60 offen offset:2048 sc1
    ds_write_b128 v7, v[88:91] offset:2048
    v_pk_mul_f32 v[136:137], v[168:169], v[40:41]
    v_pk_mul_f32 v[138:139], v[170:171], v[42:43]
    v_pk_mul_f32 v[140:141], v[172:173], v[44:45]
    v_pk_mul_f32 v[142:143], v[174:175], v[46:47]
    v_cvt_pk_bf16_f32 v92, v136, v137
    v_cvt_pk_bf16_f32 v93, v138, v139
    v_cvt_pk_bf16_f32 v94, v140, v141
    v_cvt_pk_bf16_f32 v95, v142, v143
    buffer_store_dwordx4 v[92:95], v8, s[16:19], s60 offen offset:3072 sc1
    ds_write_b128 v7, v[92:95] offset:3072
    v_pk_mul_f32 v[112:113], v[176:177], v[48:49]
    v_pk_mul_f32 v[114:115], v[178:179], v[50:51]
    v_pk_mul_f32 v[116:117], v[180:181], v[52:53]
    v_pk_mul_f32 v[118:119], v[182:183], v[54:55]
    v_cvt_pk_bf16_f32 v96, v112, v113
    v_cvt_pk_bf16_f32 v97, v114, v115
    v_cvt_pk_bf16_f32 v98, v116, v117
    v_cvt_pk_bf16_f32 v99, v118, v119
    buffer_store_dwordx4 v[96:99], v8, s[16:19], s61 offen offset:0 sc1
    ds_write_b128 v7, v[96:99] offset:4096
    v_pk_mul_f32 v[120:121], v[184:185], v[56:57]
    v_pk_mul_f32 v[122:123], v[186:187], v[58:59]
    v_pk_mul_f32 v[124:125], v[188:189], v[60:61]
    v_pk_mul_f32 v[126:127], v[190:191], v[62:63]
    v_cvt_pk_bf16_f32 v100, v120, v121
    v_cvt_pk_bf16_f32 v101, v122, v123
    v_cvt_pk_bf16_f32 v102, v124, v125
    v_cvt_pk_bf16_f32 v103, v126, v127
    buffer_store_dwordx4 v[100:103], v8, s[16:19], s61 offen offset:1024 sc1
    ds_write_b128 v7, v[100:103] offset:5120
    v_pk_mul_f32 v[128:129], v[192:193], v[64:65]
    v_pk_mul_f32 v[130:131], v[194:195], v[66:67]
    v_pk_mul_f32 v[132:133], v[196:197], v[68:69]
    v_pk_mul_f32 v[134:135], v[198:199], v[70:71]
    v_cvt_pk_bf16_f32 v104, v128, v129
    v_cvt_pk_bf16_f32 v105, v130, v131
    v_cvt_pk_bf16_f32 v106, v132, v133
    v_cvt_pk_bf16_f32 v107, v134, v135
    buffer_store_dwordx4 v[104:107], v8, s[16:19], s61 offen offset:2048 sc1
    ds_write_b128 v7, v[104:107] offset:6144
    v_pk_mul_f32 v[136:137], v[200:201], v[72:73]
    v_pk_mul_f32 v[138:139], v[202:203], v[74:75]
    v_pk_mul_f32 v[140:141], v[204:205], v[76:77]
    v_pk_mul_f32 v[142:143], v[206:207], v[78:79]
    v_cvt_pk_bf16_f32 v108, v136, v137
    v_cvt_pk_bf16_f32 v109, v138, v139
    v_cvt_pk_bf16_f32 v110, v140, v141
    v_cvt_pk_bf16_f32 v111, v142, v143
    buffer_store_dwordx4 v[108:111], v8, s[16:19], s61 offen offset:3072 sc1
    ds_write_b128 v7, v[108:111] offset:7168
L_join1:
    s_add_u32 s60, s60, 8388608
    s_add_u32 s61, s61, 8388608
    s_waitcnt lgkmcnt(0)
    s_barrier
    ds_read_b128 v[80:83], v1 offset:0
    ds_read_b128 v[84:87], v2 offset:0
    ds_read_b128 v[92:95], v2 offset:2048
    ds_read_b128 v[88:91], v1 offset:2048
    ds_read_b128 v[96:99], v1 offset:4096
    ds_read_b128 v[100:103], v2 offset:4096
    ds_read_b128 v[108:111], v2 offset:6144
    ds_read_b128 v[104:107], v1 offset:6144
    s_nop 1
    s_waitcnt lgkmcnt(7)
    v_mfma_f32_16x16x32_bf16 v[16:19], v[208:211], v[80:83], v[16:19]
    ds_read_b64_tr_b16 v[224:225], v5 offset:0
    s_waitcnt lgkmcnt(7)
    v_mfma_f32_16x16x32_bf16 v[16:19], v[212:215], v[84:87], v[16:19]
    ds_read_b64_tr_b16 v[226:227], v5 offset:4096
    s_waitcnt lgkmcnt(7)
    v_mfma_f32_16x16x32_bf16 v[32:35], v[212:215], v[92:95], v[32:35]
    ds_read_b64_tr_b16 v[228:229], v5 offset:8192
    s_waitcnt lgkmcnt(7)
    v_mfma_f32_16x16x32_bf16 v[32:35], v[208:211], v[88:91], v[32:35]
    ds_read_b64_tr_b16 v[230:231], v5 offset:12288
    s_waitcnt vmcnt(0)
    buffer_store_dword v10, v9, s[16:19], 0 offen offset:128
    buffer_store_dword v10, v9, s[16:19], s59 offen offset:128 sc1
    s_waitcnt lgkmcnt(7)
    v_mfma_f32_16x16x32_bf16 v[48:51], v[208:211], v[96:99], v[48:51]
    ds_read_b64_tr_b16 v[232:233], v6 offset:0
    s_waitcnt lgkmcnt(7)
    v_mfma_f32_16x16x32_bf16 v[48:51], v[212:215], v[100:103], v[48:51]
    ds_read_b64_tr_b16 v[234:235], v6 offset:4096
    s_waitcnt lgkmcnt(7)
    v_mfma_f32_16x16x32_bf16 v[64:67], v[212:215], v[108:111], v[64:67]
    ds_read_b64_tr_b16 v[236:237], v6 offset:8192
    s_waitcnt lgkmcnt(7)
    v_mfma_f32_16x16x32_bf16 v[64:67], v[208:211], v[104:107], v[64:67]
    ds_read_b64_tr_b16 v[238:239], v6 offset:12288
    v_mfma_f32_16x16x32_bf16 v[68:71], v[216:219], v[104:107], v[68:71]
    v_mfma_f32_16x16x32_bf16 v[68:71], v[220:223], v[108:111], v[68:71]
    v_mfma_f32_16x16x32_bf16 v[52:55], v[220:223], v[100:103], v[52:55]
    v_mfma_f32_16x16x32_bf16 v[52:55], v[216:219], v[96:99], v[52:55]
    v_mfma_f32_16x16x32_bf16 v[36:39], v[216:219], v[88:91], v[36:39]
    v_mfma_f32_16x16x32_bf16 v[36:39], v[220:223], v[92:95], v[36:39]
    v_mfma_f32_16x16x32_bf16 v[20:23], v[220:223], v[84:87], v[20:23]
    v_mfma_f32_16x16x32_bf16 v[20:23], v[216:219], v[80:83], v[20:23]
    s_waitcnt lgkmcnt(6)
    v_mfma_f32_16x16x32_bf16 v[24:27], v[224:227], v[80:83], v[24:27]
    ds_read_b64_tr_b16 v[208:209], v3 offset:16384
    s_waitcnt lgkmcnt(5)
    v_mfma_f32_16x16x32_bf16 v[24:27], v[228:231], v[84:87], v[24:27]
    ds_read_b64_tr_b16 v[210:211], v3 offset:20480
    v_mfma_f32_16x16x32_bf16 v[40:43], v[228:231], v[92:95], v[40:43]
    ds_read_b128 v[112:115], v1 offset:16384
    v_mfma_f32_16x16x32_bf16 v[40:43], v[224:227], v[88:91], v[40:43]
    ds_read_b64_tr_b16 v[212:213], v3 offset:24576
    v_mfma_f32_16x16x32_bf16 v[56:59], v[224:227], v[96:99], v[56:59]
    ds_read_b64_tr_b16 v[214:215], v3 offset:28672
    v_mfma_f32_16x16x32_bf16 v[56:59], v[228:231], v[100:103], v[56:59]
    ds_read_b128 v[116:119], v2 offset:16384
    v_mfma_f32_16x16x32_bf16 v[72:75], v[228:231], v[108:111], v[72:75]
    ds_read_b128 v[124:127], v2 offset:18432
    v_mfma_f32_16x16x32_bf16 v[72:75], v[224:227], v[104:107], v[72:75]
    ds_read_b128 v[120:123], v1 offset:18432
    s_waitcnt lgkmcnt(10)
    v_mfma_f32_16x16x32_bf16 v[76:79], v[232:235], v[104:107], v[76:79]
    ds_read_b128 v[128:131], v1 offset:20480
    s_waitcnt lgkmcnt(9)
    v_mfma_f32_16x16x32_bf16 v[76:79], v[236:239], v[108:111], v[76:79]
    ds_read_b128 v[132:135], v2 offset:20480
    v_mfma_f32_16x16x32_bf16 v[60:63], v[236:239], v[100:103], v[60:63]
    ds_read_b128 v[140:143], v2 offset:22528
    v_mfma_f32_16x16x32_bf16 v[60:63], v[232:235], v[96:99], v[60:63]
    ds_read_b128 v[136:139], v1 offset:22528
    v_mfma_f32_16x16x32_bf16 v[44:47], v[232:235], v[88:91], v[44:47]
    ds_read_b64_tr_b16 v[216:217], v4 offset:16384
    v_mfma_f32_16x16x32_bf16 v[44:47], v[236:239], v[92:95], v[44:47]
    ds_read_b64_tr_b16 v[218:219], v4 offset:20480
    v_mfma_f32_16x16x32_bf16 v[28:31], v[236:239], v[84:87], v[28:31]
    ds_read_b64_tr_b16 v[220:221], v4 offset:24576
    v_mfma_f32_16x16x32_bf16 v[28:31], v[232:235], v[80:83], v[28:31]
    ds_read_b64_tr_b16 v[222:223], v4 offset:28672
    s_waitcnt lgkmcnt(13)
    v_mfma_f32_16x16x32_bf16 v[16:19], v[208:211], v[112:115], v[16:19]
    ds_read_b64_tr_b16 v[224:225], v5 offset:16384
    s_waitcnt lgkmcnt(11)
    v_mfma_f32_16x16x32_bf16 v[16:19], v[212:215], v[116:119], v[16:19]
    ds_read_b64_tr_b16 v[226:227], v5 offset:20480
    s_waitcnt lgkmcnt(11)
    v_mfma_f32_16x16x32_bf16 v[32:35], v[212:215], v[124:127], v[32:35]
    ds_read_b64_tr_b16 v[228:229], v5 offset:24576
    s_waitcnt lgkmcnt(11)
    v_mfma_f32_16x16x32_bf16 v[32:35], v[208:211], v[120:123], v[32:35]
    ds_read_b64_tr_b16 v[230:231], v5 offset:28672
    s_waitcnt lgkmcnt(11)
    v_mfma_f32_16x16x32_bf16 v[48:51], v[208:211], v[128:131], v[48:51]
    ds_read_b64_tr_b16 v[232:233], v6 offset:16384
    s_waitcnt lgkmcnt(11)
    v_mfma_f32_16x16x32_bf16 v[48:51], v[212:215], v[132:135], v[48:51]
    ds_read_b64_tr_b16 v[234:235], v6 offset:20480
    s_waitcnt lgkmcnt(11)
    v_mfma_f32_16x16x32_bf16 v[64:67], v[212:215], v[140:143], v[64:67]
    ds_read_b64_tr_b16 v[236:237], v6 offset:24576
    s_waitcnt lgkmcnt(11)
    v_mfma_f32_16x16x32_bf16 v[64:67], v[208:211], v[136:139], v[64:67]
    ds_read_b64_tr_b16 v[238:239], v6 offset:28672
    s_waitcnt lgkmcnt(10)
    v_mfma_f32_16x16x32_bf16 v[68:71], v[216:219], v[136:139], v[68:71]
    s_waitcnt lgkmcnt(8)
    v_mfma_f32_16x16x32_bf16 v[68:71], v[220:223], v[140:143], v[68:71]
    v_mfma_f32_16x16x32_bf16 v[52:55], v[220:223], v[132:135], v[52:55]
    v_mfma_f32_16x16x32_bf16 v[52:55], v[216:219], v[128:131], v[52:55]
    v_mfma_f32_16x16x32_bf16 v[36:39], v[216:219], v[120:123], v[36:39]
    v_mfma_f32_16x16x32_bf16 v[36:39], v[220:223], v[124:127], v[36:39]
    v_mfma_f32_16x16x32_bf16 v[20:23], v[220:223], v[116:119], v[20:23]
    v_mfma_f32_16x16x32_bf16 v[20:23], v[216:219], v[112:115], v[20:23]
    s_waitcnt lgkmcnt(6)
    v_mfma_f32_16x16x32_bf16 v[24:27], v[224:227], v[112:115], v[24:27]
    s_waitcnt lgkmcnt(0)
    s_barrier
    v_mfma_f32_16x16x32_bf16 v[24:27], v[228:231], v[116:119], v[24:27]
    ds_read_b64_tr_b16 v[208:209], v3 offset:32768
    ds_read_b64_tr_b16 v[210:211], v3 offset:36864
    v_mfma_f32_16x16x32_bf16 v[40:43], v[228:231], v[124:127], v[40:43]
    ds_read_b128 v[80:83], v1 offset:32768
    v_mfma_f32_16x16x32_bf16 v[40:43], v[224:227], v[120:123], v[40:43]
    ds_read_b64_tr_b16 v[212:213], v3 offset:40960
    v_mfma_f32_16x16x32_bf16 v[56:59], v[224:227], v[128:131], v[56:59]
    ds_read_b64_tr_b16 v[214:215], v3 offset:45056
    v_mfma_f32_16x16x32_bf16 v[56:59], v[228:231], v[132:135], v[56:59]
    ds_read_b128 v[84:87], v2 offset:32768
    v_mfma_f32_16x16x32_bf16 v[72:75], v[228:231], v[140:143], v[72:75]
    ds_read_b128 v[92:95], v2 offset:34816
    v_mfma_f32_16x16x32_bf16 v[72:75], v[224:227], v[136:139], v[72:75]
    ds_read_b128 v[88:91], v1 offset:34816
    v_mfma_f32_16x16x32_bf16 v[76:79], v[232:235], v[136:139], v[76:79]
    ds_read_b128 v[96:99], v1 offset:36864
    v_mfma_f32_16x16x32_bf16 v[76:79], v[236:239], v[140:143], v[76:79]
    ds_read_b128 v[100:103], v2 offset:36864
    v_mfma_f32_16x16x32_bf16 v[60:63], v[236:239], v[132:135], v[60:63]
    ds_read_b128 v[108:111], v2 offset:38912
    v_mfma_f32_16x16x32_bf16 v[60:63], v[232:235], v[128:131], v[60:63]
    ds_read_b128 v[104:107], v1 offset:38912
    v_mfma_f32_16x16x32_bf16 v[44:47], v[232:235], v[120:123], v[44:47]
    ds_read_b64_tr_b16 v[216:217], v4 offset:32768
    v_mfma_f32_16x16x32_bf16 v[44:47], v[236:239], v[124:127], v[44:47]
    ds_read_b64_tr_b16 v[218:219], v4 offset:36864
    v_mfma_f32_16x16x32_bf16 v[28:31], v[236:239], v[116:119], v[28:31]
    ds_read_b64_tr_b16 v[220:221], v4 offset:40960
    v_mfma_f32_16x16x32_bf16 v[28:31], v[232:235], v[112:115], v[28:31]
    ds_read_b64_tr_b16 v[222:223], v4 offset:45056
    s_waitcnt lgkmcnt(13)
    v_mfma_f32_16x16x32_bf16 v[16:19], v[208:211], v[80:83], v[16:19]
    ds_read_b64_tr_b16 v[224:225], v5 offset:32768
    s_waitcnt lgkmcnt(11)
    v_mfma_f32_16x16x32_bf16 v[16:19], v[212:215], v[84:87], v[16:19]
    ds_read_b64_tr_b16 v[226:227], v5 offset:36864
    s_waitcnt lgkmcnt(11)
    v_mfma_f32_16x16x32_bf16 v[32:35], v[212:215], v[92:95], v[32:35]
    ds_read_b64_tr_b16 v[228:229], v5 offset:40960
    s_waitcnt lgkmcnt(11)
    v_mfma_f32_16x16x32_bf16 v[32:35], v[208:211], v[88:91], v[32:35]
    ds_read_b64_tr_b16 v[230:231], v5 offset:45056
    s_waitcnt lgkmcnt(11)
    v_mfma_f32_16x16x32_bf16 v[48:51], v[208:211], v[96:99], v[48:51]
    ds_read_b64_tr_b16 v[232:233], v6 offset:32768
    s_waitcnt lgkmcnt(11)
    v_mfma_f32_16x16x32_bf16 v[48:51], v[212:215], v[100:103], v[48:51]
    ds_read_b64_tr_b16 v[234:235], v6 offset:36864
    s_waitcnt lgkmcnt(11)
    v_mfma_f32_16x16x32_bf16 v[64:67], v[212:215], v[108:111], v[64:67]
    ds_read_b64_tr_b16 v[236:237], v6 offset:40960
    s_waitcnt lgkmcnt(11)
    v_mfma_f32_16x16x32_bf16 v[64:67], v[208:211], v[104:107], v[64:67]
    ds_read_b64_tr_b16 v[238:239], v6 offset:45056
    s_waitcnt lgkmcnt(10)
    v_mfma_f32_16x16x32_bf16 v[68:71], v[216:219], v[104:107], v[68:71]
    s_waitcnt lgkmcnt(8)
    v_mfma_f32_16x16x32_bf16 v[68:71], v[220:223], v[108:111], v[68:71]
    v_lshrrev_b32 v11, 4, v0
    v_lshlrev_b32 v11, 3, v11
    s_lshl_b32 s34, s31, 7
    s_add_u32 s34, s34, 131072
    v_add_u32 v11, s34, v11
    v_mfma_f32_16x16x32_bf16 v[52:55], v[220:223], v[100:103], v[52:55]
    ds_read_b64 v[242:243], v11 offset:512
    ds_read_b64 v[246:247], v11 offset:544
    v_mfma_f32_16x16x32_bf16 v[52:55], v[216:219], v[96:99], v[52:55]
    ds_read_b64 v[250:251], v11 offset:576
    ds_read_b64 v[254:255], v11 offset:608
    v_mfma_f32_16x16x32_bf16 v[36:39], v[216:219], v[88:91], v[36:39]
    v_mfma_f32_16x16x32_bf16 v[36:39], v[220:223], v[92:95], v[36:39]
    v_mfma_f32_16x16x32_bf16 v[20:23], v[220:223], v[84:87], v[20:23]
    v_mfma_f32_16x16x32_bf16 v[20:23], v[216:219], v[80:83], v[20:23]
    s_waitcnt lgkmcnt(10)
    v_mfma_f32_16x16x32_bf16 v[24:27], v[224:227], v[80:83], v[24:27]
    s_waitcnt lgkmcnt(0)
    s_barrier
    v_mfma_f32_16x16x32_bf16 v[24:27], v[228:231], v[84:87], v[24:27]
    ds_read_b64_tr_b16 v[208:209], v3 offset:49152
    ds_read_b64_tr_b16 v[210:211], v3 offset:53248
    v_mfma_f32_16x16x32_bf16 v[40:43], v[228:231], v[92:95], v[40:43]
    ds_read_b128 v[112:115], v1 offset:49152
    v_mfma_f32_16x16x32_bf16 v[40:43], v[224:227], v[88:91], v[40:43]
    ds_read_b64_tr_b16 v[212:213], v3 offset:57344
    v_mfma_f32_16x16x32_bf16 v[56:59], v[224:227], v[96:99], v[56:59]
    ds_read_b64_tr_b16 v[214:215], v3 offset:61440
    v_mfma_f32_16x16x32_bf16 v[56:59], v[228:231], v[100:103], v[56:59]
    ds_read_b128 v[116:119], v2 offset:49152
    v_mfma_f32_16x16x32_bf16 v[72:75], v[228:231], v[108:111], v[72:75]
    ds_read_b128 v[124:127], v2 offset:51200
    v_mfma_f32_16x16x32_bf16 v[72:75], v[224:227], v[104:107], v[72:75]
    ds_read_b128 v[120:123], v1 offset:51200
    v_mfma_f32_16x16x32_bf16 v[76:79], v[232:235], v[104:107], v[76:79]
    ds_read_b128 v[128:131], v1 offset:53248
    v_mfma_f32_16x16x32_bf16 v[76:79], v[236:239], v[108:111], v[76:79]
    ds_read_b128 v[132:135], v2 offset:53248
    v_mfma_f32_16x16x32_bf16 v[60:63], v[236:239], v[100:103], v[60:63]
    ds_read_b128 v[140:143], v2 offset:55296
    v_mfma_f32_16x16x32_bf16 v[60:63], v[232:235], v[96:99], v[60:63]
    ds_read_b128 v[136:139], v1 offset:55296
    v_mfma_f32_16x16x32_bf16 v[44:47], v[232:235], v[88:91], v[44:47]
    ds_read_b64_tr_b16 v[216:217], v4 offset:49152
    v_mfma_f32_16x16x32_bf16 v[44:47], v[236:239], v[92:95], v[44:47]
    ds_read_b64_tr_b16 v[218:219], v4 offset:53248
    v_mfma_f32_16x16x32_bf16 v[28:31], v[236:239], v[84:87], v[28:31]
    ds_read_b64_tr_b16 v[220:221], v4 offset:57344
    v_mfma_f32_16x16x32_bf16 v[28:31], v[232:235], v[80:83], v[28:31]
    ds_read_b64_tr_b16 v[222:223], v4 offset:61440
    s_waitcnt lgkmcnt(13)
    v_mfma_f32_16x16x32_bf16 v[16:19], v[208:211], v[112:115], v[16:19]
    ds_read_b64_tr_b16 v[224:225], v5 offset:49152
    s_waitcnt lgkmcnt(11)
    v_mfma_f32_16x16x32_bf16 v[16:19], v[212:215], v[116:119], v[16:19]
    ds_read_b64_tr_b16 v[226:227], v5 offset:53248
    s_waitcnt lgkmcnt(11)
    v_mfma_f32_16x16x32_bf16 v[32:35], v[212:215], v[124:127], v[32:35]
    ds_read_b64_tr_b16 v[228:229], v5 offset:57344
    s_waitcnt lgkmcnt(11)
    v_mfma_f32_16x16x32_bf16 v[32:35], v[208:211], v[120:123], v[32:35]
    ds_read_b64_tr_b16 v[230:231], v5 offset:61440
    s_waitcnt lgkmcnt(11)
    v_mfma_f32_16x16x32_bf16 v[48:51], v[208:211], v[128:131], v[48:51]
    ds_read_b64_tr_b16 v[232:233], v6 offset:49152
    s_waitcnt lgkmcnt(11)
    v_mfma_f32_16x16x32_bf16 v[48:51], v[212:215], v[132:135], v[48:51]
    ds_read_b64_tr_b16 v[234:235], v6 offset:53248
    s_waitcnt lgkmcnt(11)
    v_mfma_f32_16x16x32_bf16 v[64:67], v[212:215], v[140:143], v[64:67]
    ds_read_b64_tr_b16 v[236:237], v6 offset:57344
    s_waitcnt lgkmcnt(11)
    v_mfma_f32_16x16x32_bf16 v[64:67], v[208:211], v[136:139], v[64:67]
    ds_read_b64_tr_b16 v[238:239], v6 offset:61440
    s_waitcnt lgkmcnt(10)
    v_mfma_f32_16x16x32_bf16 v[68:71], v[216:219], v[136:139], v[68:71]
    s_waitcnt lgkmcnt(8)
    v_mfma_f32_16x16x32_bf16 v[68:71], v[220:223], v[140:143], v[68:71]
    v_lshlrev_b32 v240, 16, v242
    v_and_b32 v241, s33, v242
    v_lshlrev_b32 v242, 16, v243
    v_and_b32 v243, s33, v243
    v_mfma_f32_16x16x32_bf16 v[52:55], v[220:223], v[132:135], v[52:55]
    v_mfma_f32_16x16x32_bf16 v[52:55], v[216:219], v[128:131], v[52:55]
    v_lshlrev_b32 v244, 16, v246
    v_and_b32 v245, s33, v246
    v_lshlrev_b32 v246, 16, v247
    v_and_b32 v247, s33, v247
    v_mfma_f32_16x16x32_bf16 v[36:39], v[216:219], v[120:123], v[36:39]
    v_mfma_f32_16x16x32_bf16 v[36:39], v[220:223], v[124:127], v[36:39]
    v_lshlrev_b32 v248, 16, v250
    v_and_b32 v249, s33, v250
    v_lshlrev_b32 v250, 16, v251
    v_and_b32 v251, s33, v251
    v_mfma_f32_16x16x32_bf16 v[20:23], v[220:223], v[116:119], v[20:23]
    v_mfma_f32_16x16x32_bf16 v[20:23], v[216:219], v[112:115], v[20:23]
    v_lshlrev_b32 v252, 16, v254
    v_and_b32 v253, s33, v254
    v_lshlrev_b32 v254, 16, v255
    v_and_b32 v255, s33, v255
    s_waitcnt lgkmcnt(6)
    v_mfma_f32_16x16x32_bf16 v[24:27], v[224:227], v[112:115], v[24:27]
    s_waitcnt lgkmcnt(0)
    s_barrier
    v_mfma_f32_16x16x32_bf16 v[24:27], v[228:231], v[116:119], v[24:27]
    ds_read_b64_tr_b16 v[208:209], v3 offset:0
    ds_read_b64_tr_b16 v[210:211], v3 offset:4096
    v_mfma_f32_16x16x32_bf16 v[40:43], v[228:231], v[124:127], v[40:43]
    ds_read_b128 v[80:83], v1 offset:0
    v_mfma_f32_16x16x32_bf16 v[40:43], v[224:227], v[120:123], v[40:43]
    ds_read_b64_tr_b16 v[212:213], v3 offset:8192
    v_mfma_f32_16x16x32_bf16 v[56:59], v[224:227], v[128:131], v[56:59]
    ds_read_b64_tr_b16 v[214:215], v3 offset:12288
    v_mfma_f32_16x16x32_bf16 v[56:59], v[228:231], v[132:135], v[56:59]
    ds_read_b128 v[84:87], v2 offset:0
    v_mfma_f32_16x16x32_bf16 v[72:75], v[228:231], v[140:143], v[72:75]
    ds_read_b128 v[92:95], v2 offset:2048
    v_mfma_f32_16x16x32_bf16 v[72:75], v[224:227], v[136:139], v[72:75]
    ds_read_b128 v[88:91], v1 offset:2048
    v_mfma_f32_16x16x32_bf16 v[76:79], v[232:235], v[136:139], v[76:79]
    ds_read_b128 v[96:99], v1 offset:4096
    v_mfma_f32_16x16x32_bf16 v[76:79], v[236:239], v[140:143], v[76:79]
    ds_read_b128 v[100:103], v2 offset:4096
    v_mfma_f32_16x16x32_bf16 v[60:63], v[236:239], v[132:135], v[60:63]
    ds_read_b128 v[108:111], v2 offset:6144
    v_mfma_f32_16x16x32_bf16 v[60:63], v[232:235], v[128:131], v[60:63]
    ds_read_b128 v[104:107], v1 offset:6144
    v_mfma_f32_16x16x32_bf16 v[44:47], v[232:235], v[120:123], v[44:47]
    ds_read_b64_tr_b16 v[216:217], v4 offset:0
    v_mfma_f32_16x16x32_bf16 v[44:47], v[236:239], v[124:127], v[44:47]
    ds_read_b64_tr_b16 v[218:219], v4 offset:4096
    v_mfma_f32_16x16x32_bf16 v[28:31], v[236:239], v[116:119], v[28:31]
    ds_read_b64_tr_b16 v[220:221], v4 offset:8192
    v_mfma_f32_16x16x32_bf16 v[28:31], v[232:235], v[112:115], v[28:31]
    ds_read_b64_tr_b16 v[222:223], v4 offset:12288
    s_waitcnt lgkmcnt(13)
    v_mfma_f32_16x16x32_bf16 v[16:19], v[208:211], v[80:83], v[16:19]
    ds_read_b64_tr_b16 v[224:225], v5 offset:0
    s_waitcnt lgkmcnt(11)
    v_mfma_f32_16x16x32_bf16 v[16:19], v[212:215], v[84:87], v[16:19]
    ds_read_b64_tr_b16 v[226:227], v5 offset:4096
    s_waitcnt lgkmcnt(11)
    v_mfma_f32_16x16x32_bf16 v[32:35], v[212:215], v[92:95], v[32:35]
    ds_read_b64_tr_b16 v[228:229], v5 offset:8192
    s_waitcnt lgkmcnt(11)
    v_mfma_f32_16x16x32_bf16 v[32:35], v[208:211], v[88:91], v[32:35]
    ds_read_b64_tr_b16 v[230:231], v5 offset:12288
    s_waitcnt lgkmcnt(11)
    v_mfma_f32_16x16x32_bf16 v[48:51], v[208:211], v[96:99], v[48:51]
    ds_read_b64_tr_b16 v[232:233], v6 offset:0
    s_waitcnt lgkmcnt(11)
    v_mfma_f32_16x16x32_bf16 v[48:51], v[212:215], v[100:103], v[48:51]
    ds_read_b64_tr_b16 v[234:235], v6 offset:4096
    s_waitcnt lgkmcnt(11)
    v_mfma_f32_16x16x32_bf16 v[64:67], v[212:215], v[108:111], v[64:67]
    ds_read_b64_tr_b16 v[236:237], v6 offset:8192
    s_waitcnt lgkmcnt(11)
    v_mfma_f32_16x16x32_bf16 v[64:67], v[208:211], v[104:107], v[64:67]
    ds_read_b64_tr_b16 v[238:239], v6 offset:12288
    s_waitcnt lgkmcnt(10)
    v_mfma_f32_16x16x32_bf16 v[68:71], v[216:219], v[104:107], v[68:71]
    v_add_f32 v24, v248, v24
    v_add_f32 v28, v252, v28
    s_waitcnt lgkmcnt(8)
    v_mfma_f32_16x16x32_bf16 v[68:71], v[220:223], v[108:111], v[68:71]
    v_add_f32 v40, v248, v40
    v_add_f32 v44, v252, v44
    v_mfma_f32_16x16x32_bf16 v[52:55], v[220:223], v[100:103], v[52:55]
    v_add_f32 v56, v248, v56
    v_add_f32 v60, v252, v60
    v_mfma_f32_16x16x32_bf16 v[52:55], v[216:219], v[96:99], v[52:55]
    v_add_f32 v72, v248, v72
    v_add_f32 v76, v252, v76
    v_mfma_f32_16x16x32_bf16 v[36:39], v[216:219], v[88:91], v[36:39]
    v_add_f32 v25, v249, v25
    v_add_f32 v29, v253, v29
    v_mfma_f32_16x16x32_bf16 v[36:39], v[220:223], v[92:95], v[36:39]
    v_add_f32 v41, v249, v41
    v_add_f32 v45, v253, v45
    v_mfma_f32_16x16x32_bf16 v[20:23], v[220:223], v[84:87], v[20:23]
    v_mfma_f32_16x16x32_bf16 v[20:23], v[216:219], v[80:83], v[20:23]
    s_waitcnt lgkmcnt(6)
    v_mfma_f32_16x16x32_bf16 v[24:27], v[224:227], v[80:83], v[24:27]
    s_waitcnt lgkmcnt(0)
    s_barrier
    v_mfma_f32_16x16x32_bf16 v[24:27], v[228:231], v[84:87], v[24:27]
    ds_read_b64_tr_b16 v[208:209], v3 offset:16384
    ds_read_b64_tr_b16 v[210:211], v3 offset:20480
    v_mfma_f32_16x16x32_bf16 v[40:43], v[228:231], v[92:95], v[40:43]
    ds_read_b128 v[112:115], v1 offset:16384
    v_mfma_f32_16x16x32_bf16 v[40:43], v[224:227], v[88:91], v[40:43]
    ds_read_b64_tr_b16 v[212:213], v3 offset:24576
    v_mfma_f32_16x16x32_bf16 v[56:59], v[224:227], v[96:99], v[56:59]
    ds_read_b64_tr_b16 v[214:215], v3 offset:28672
    v_mfma_f32_16x16x32_bf16 v[56:59], v[228:231], v[100:103], v[56:59]
    ds_read_b128 v[116:119], v2 offset:16384
    v_mfma_f32_16x16x32_bf16 v[72:75], v[228:231], v[108:111], v[72:75]
    ds_read_b128 v[124:127], v2 offset:18432
    v_mfma_f32_16x16x32_bf16 v[72:75], v[224:227], v[104:107], v[72:75]
    ds_read_b128 v[120:123], v1 offset:18432
    v_mfma_f32_16x16x32_bf16 v[76:79], v[232:235], v[104:107], v[76:79]
    ds_read_b128 v[128:131], v1 offset:20480
    v_add_f32 v16, v240, v16
    v_mfma_f32_16x16x32_bf16 v[76:79], v[236:239], v[108:111], v[76:79]
    ds_read_b128 v[132:135], v2 offset:20480
    v_add_f32 v20, v244, v20
    v_mfma_f32_16x16x32_bf16 v[60:63], v[236:239], v[100:103], v[60:63]
    ds_read_b128 v[140:143], v2 offset:22528
    v_add_f32 v32, v240, v32
    v_mfma_f32_16x16x32_bf16 v[60:63], v[232:235], v[96:99], v[60:63]
    ds_read_b128 v[136:139], v1 offset:22528
    v_add_f32 v36, v244, v36
    v_mfma_f32_16x16x32_bf16 v[44:47], v[232:235], v[88:91], v[44:47]
    ds_read_b64_tr_b16 v[216:217], v4 offset:16384
    v_add_f32 v48, v240, v48
    v_mfma_f32_16x16x32_bf16 v[44:47], v[236:239], v[92:95], v[44:47]
    ds_read_b64_tr_b16 v[218:219], v4 offset:20480
    v_add_f32 v52, v244, v52
    v_mfma_f32_16x16x32_bf16 v[28:31], v[236:239], v[84:87], v[28:31]
    ds_read_b64_tr_b16 v[220:221], v4 offset:24576
    v_mfma_f32_16x16x32_bf16 v[28:31], v[232:235], v[80:83], v[28:31]
    ds_read_b64_tr_b16 v[222:223], v4 offset:28672
    s_waitcnt lgkmcnt(13)
    v_mfma_f32_16x16x32_bf16 v[16:19], v[208:211], v[112:115], v[16:19]
    ds_read_b64_tr_b16 v[224:225], v5 offset:16384
    s_waitcnt lgkmcnt(11)
    v_mfma_f32_16x16x32_bf16 v[16:19], v[212:215], v[116:119], v[16:19]
    ds_read_b64_tr_b16 v[226:227], v5 offset:20480
    s_waitcnt lgkmcnt(11)
    v_mfma_f32_16x16x32_bf16 v[32:35], v[212:215], v[124:127], v[32:35]
    ds_read_b64_tr_b16 v[228:229], v5 offset:24576
    s_waitcnt lgkmcnt(11)
    v_mfma_f32_16x16x32_bf16 v[32:35], v[208:211], v[120:123], v[32:35]
    ds_read_b64_tr_b16 v[230:231], v5 offset:28672
    s_waitcnt lgkmcnt(11)
    v_mfma_f32_16x16x32_bf16 v[48:51], v[208:211], v[128:131], v[48:51]
    ds_read_b64_tr_b16 v[232:233], v6 offset:16384
    s_waitcnt lgkmcnt(11)
    v_mfma_f32_16x16x32_bf16 v[48:51], v[212:215], v[132:135], v[48:51]
    ds_read_b64_tr_b16 v[234:235], v6 offset:20480
    s_waitcnt lgkmcnt(11)
    v_mfma_f32_16x16x32_bf16 v[64:67], v[212:215], v[140:143], v[64:67]
    ds_read_b64_tr_b16 v[236:237], v6 offset:24576
    s_waitcnt lgkmcnt(11)
    v_mfma_f32_16x16x32_bf16 v[64:67], v[208:211], v[136:139], v[64:67]
    ds_read_b64_tr_b16 v[238:239], v6 offset:28672
    s_waitcnt lgkmcnt(10)
    v_mfma_f32_16x16x32_bf16 v[68:71], v[216:219], v[136:139], v[68:71]
    v_add_f32 v57, v249, v57
    v_add_f32 v61, v253, v61
    s_waitcnt lgkmcnt(8)
    v_mfma_f32_16x16x32_bf16 v[68:71], v[220:223], v[140:143], v[68:71]
    v_add_f32 v73, v249, v73
    v_add_f32 v77, v253, v77
    v_mfma_f32_16x16x32_bf16 v[52:55], v[220:223], v[132:135], v[52:55]
    v_add_f32 v26, v250, v26
    v_add_f32 v30, v254, v30
    v_mfma_f32_16x16x32_bf16 v[52:55], v[216:219], v[128:131], v[52:55]
    v_add_f32 v42, v250, v42
    v_add_f32 v46, v254, v46
    v_mfma_f32_16x16x32_bf16 v[36:39], v[216:219], v[120:123], v[36:39]
    v_add_f32 v58, v250, v58
    v_add_f32 v62, v254, v62
    v_mfma_f32_16x16x32_bf16 v[36:39], v[220:223], v[124:127], v[36:39]
    v_add_f32 v74, v250, v74
    v_add_f32 v78, v254, v78
    v_mfma_f32_16x16x32_bf16 v[20:23], v[220:223], v[116:119], v[20:23]
    v_mfma_f32_16x16x32_bf16 v[20:23], v[216:219], v[112:115], v[20:23]
    s_waitcnt lgkmcnt(6)
    v_mfma_f32_16x16x32_bf16 v[24:27], v[224:227], v[112:115], v[24:27]
    s_waitcnt lgkmcnt(0)
    s_barrier
    v_mfma_f32_16x16x32_bf16 v[24:27], v[228:231], v[116:119], v[24:27]
    ds_read_b64_tr_b16 v[208:209], v3 offset:32768
    ds_read_b64_tr_b16 v[210:211], v3 offset:36864
    v_mfma_f32_16x16x32_bf16 v[40:43], v[228:231], v[124:127], v[40:43]
    ds_read_b128 v[80:83], v1 offset:32768
    v_mfma_f32_16x16x32_bf16 v[40:43], v[224:227], v[120:123], v[40:43]
    ds_read_b64_tr_b16 v[212:213], v3 offset:40960
    v_mfma_f32_16x16x32_bf16 v[56:59], v[224:227], v[128:131], v[56:59]
    ds_read_b64_tr_b16 v[214:215], v3 offset:45056
    v_mfma_f32_16x16x32_bf16 v[56:59], v[228:231], v[132:135], v[56:59]
    ds_read_b128 v[84:87], v2 offset:32768
    v_mfma_f32_16x16x32_bf16 v[72:75], v[228:231], v[140:143], v[72:75]
    ds_read_b128 v[92:95], v2 offset:34816
    v_mfma_f32_16x16x32_bf16 v[72:75], v[224:227], v[136:139], v[72:75]
    ds_read_b128 v[88:91], v1 offset:34816
    v_mfma_f32_16x16x32_bf16 v[76:79], v[232:235], v[136:139], v[76:79]
    ds_read_b128 v[96:99], v1 offset:36864
    v_add_f32 v64, v240, v64
    v_mfma_f32_16x16x32_bf16 v[76:79], v[236:239], v[140:143], v[76:79]
    ds_read_b128 v[100:103], v2 offset:36864
    v_add_f32 v68, v244, v68
    v_mfma_f32_16x16x32_bf16 v[60:63], v[236:239], v[132:135], v[60:63]
    ds_read_b128 v[108:111], v2 offset:38912
    v_add_f32 v17, v241, v17
    v_mfma_f32_16x16x32_bf16 v[60:63], v[232:235], v[128:131], v[60:63]
    ds_read_b128 v[104:107], v1 offset:38912
    v_add_f32 v21, v245, v21
    v_mfma_f32_16x16x32_bf16 v[44:47], v[232:235], v[120:123], v[44:47]
    ds_read_b64_tr_b16 v[216:217], v4 offset:32768
    v_add_f32 v33, v241, v33
    v_mfma_f32_16x16x32_bf16 v[44:47], v[236:239], v[124:127], v[44:47]
    ds_read_b64_tr_b16 v[218:219], v4 offset:36864
    v_add_f32 v37, v245, v37
    v_mfma_f32_16x16x32_bf16 v[28:31], v[236:239], v[116:119], v[28:31]
    ds_read_b64_tr_b16 v[220:221], v4 offset:40960
    v_mfma_f32_16x16x32_bf16 v[28:31], v[232:235], v[112:115], v[28:31]
    ds_read_b64_tr_b16 v[222:223], v4 offset:45056
    s_waitcnt lgkmcnt(13)
    v_mfma_f32_16x16x32_bf16 v[16:19], v[208:211], v[80:83], v[16:19]
    ds_read_b64_tr_b16 v[224:225], v5 offset:32768
    s_waitcnt lgkmcnt(11)
    v_mfma_f32_16x16x32_bf16 v[16:19], v[212:215], v[84:87], v[16:19]
    ds_read_b64_tr_b16 v[226:227], v5 offset:36864
    s_waitcnt lgkmcnt(11)
    v_mfma_f32_16x16x32_bf16 v[32:35], v[212:215], v[92:95], v[32:35]
    ds_read_b64_tr_b16 v[228:229], v5 offset:40960
    s_waitcnt lgkmcnt(11)
    v_mfma_f32_16x16x32_bf16 v[32:35], v[208:211], v[88:91], v[32:35]
    ds_read_b64_tr_b16 v[230:231], v5 offset:45056
    s_waitcnt lgkmcnt(11)
    v_mfma_f32_16x16x32_bf16 v[48:51], v[208:211], v[96:99], v[48:51]
    ds_read_b64_tr_b16 v[232:233], v6 offset:32768
    s_waitcnt lgkmcnt(11)
    v_mfma_f32_16x16x32_bf16 v[48:51], v[212:215], v[100:103], v[48:51]
    ds_read_b64_tr_b16 v[234:235], v6 offset:36864
    s_waitcnt lgkmcnt(11)
    v_mfma_f32_16x16x32_bf16 v[64:67], v[212:215], v[108:111], v[64:67]
    ds_read_b64_tr_b16 v[236:237], v6 offset:40960
    s_waitcnt lgkmcnt(11)
    v_mfma_f32_16x16x32_bf16 v[64:67], v[208:211], v[104:107], v[64:67]
    ds_read_b64_tr_b16 v[238:239], v6 offset:45056
    s_waitcnt lgkmcnt(10)
    v_mfma_f32_16x16x32_bf16 v[68:71], v[216:219], v[104:107], v[68:71]
    v_add_f32 v27, v251, v27
    v_add_f32 v31, v255, v31
    s_waitcnt lgkmcnt(8)
    v_mfma_f32_16x16x32_bf16 v[68:71], v[220:223], v[108:111], v[68:71]
    v_add_f32 v43, v251, v43
    v_add_f32 v47, v255, v47
    v_mfma_f32_16x16x32_bf16 v[52:55], v[220:223], v[100:103], v[52:55]
    v_add_f32 v59, v251, v59
    v_add_f32 v63, v255, v63
    v_mfma_f32_16x16x32_bf16 v[52:55], v[216:219], v[96:99], v[52:55]
    v_add_f32 v75, v251, v75
    v_add_f32 v79, v255, v79
    v_mfma_f32_16x16x32_bf16 v[36:39], v[216:219], v[88:91], v[36:39]
    v_mfma_f32_16x16x32_bf16 v[36:39], v[220:223], v[92:95], v[36:39]
    v_mfma_f32_16x16x32_bf16 v[20:23], v[220:223], v[84:87], v[20:23]
    v_mfma_f32_16x16x32_bf16 v[20:23], v[216:219], v[80:83], v[20:23]
    s_waitcnt lgkmcnt(6)
    v_mfma_f32_16x16x32_bf16 v[24:27], v[224:227], v[80:83], v[24:27]
    s_waitcnt lgkmcnt(0)
    s_barrier
    v_mfma_f32_16x16x32_bf16 v[24:27], v[228:231], v[84:87], v[24:27]
    ds_read_b64_tr_b16 v[208:209], v3 offset:49152
    ds_read_b64_tr_b16 v[210:211], v3 offset:53248
    v_mfma_f32_16x16x32_bf16 v[40:43], v[228:231], v[92:95], v[40:43]
    ds_read_b128 v[112:115], v1 offset:49152
    v_mfma_f32_16x16x32_bf16 v[40:43], v[224:227], v[88:91], v[40:43]
    ds_read_b64_tr_b16 v[212:213], v3 offset:57344
    v_mfma_f32_16x16x32_bf16 v[56:59], v[224:227], v[96:99], v[56:59]
    ds_read_b64_tr_b16 v[214:215], v3 offset:61440
    v_mfma_f32_16x16x32_bf16 v[56:59], v[228:231], v[100:103], v[56:59]
    ds_read_b128 v[116:119], v2 offset:49152
    v_mfma_f32_16x16x32_bf16 v[72:75], v[228:231], v[108:111], v[72:75]
    ds_read_b128 v[124:127], v2 offset:51200
    v_mfma_f32_16x16x32_bf16 v[72:75], v[224:227], v[104:107], v[72:75]
    ds_read_b128 v[120:123], v1 offset:51200
    v_mfma_f32_16x16x32_bf16 v[76:79], v[232:235], v[104:107], v[76:79]
    ds_read_b128 v[128:131], v1 offset:53248
    v_add_f32 v49, v241, v49
    v_mfma_f32_16x16x32_bf16 v[76:79], v[236:239], v[108:111], v[76:79]
    ds_read_b128 v[132:135], v2 offset:53248
    v_add_f32 v53, v245, v53
    v_mfma_f32_16x16x32_bf16 v[60:63], v[236:239], v[100:103], v[60:63]
    ds_read_b128 v[140:143], v2 offset:55296
    v_add_f32 v65, v241, v65
    v_mfma_f32_16x16x32_bf16 v[60:63], v[232:235], v[96:99], v[60:63]
    ds_read_b128 v[136:139], v1 offset:55296
    v_add_f32 v69, v245, v69
    v_mfma_f32_16x16x32_bf16 v[44:47], v[232:235], v[88:91], v[44:47]
    ds_read_b64_tr_b16 v[216:217], v4 offset:49152
    v_add_f32 v18, v242, v18
    v_mfma_f32_16x16x32_bf16 v[44:47], v[236:239], v[92:95], v[44:47]
    ds_read_b64_tr_b16 v[218:219], v4 offset:53248
    v_add_f32 v22, v246, v22
    v_mfma_f32_16x16x32_bf16 v[28:31], v[236:239], v[84:87], v[28:31]
    ds_read_b64_tr_b16 v[220:221], v4 offset:57344
    v_mfma_f32_16x16x32_bf16 v[28:31], v[232:235], v[80:83], v[28:31]
    ds_read_b64_tr_b16 v[222:223], v4 offset:61440
    s_waitcnt lgkmcnt(13)
    v_mfma_f32_16x16x32_bf16 v[16:19], v[208:211], v[112:115], v[16:19]
    ds_read_b64_tr_b16 v[224:225], v5 offset:49152
    s_waitcnt lgkmcnt(11)
    v_mfma_f32_16x16x32_bf16 v[16:19], v[212:215], v[116:119], v[16:19]
    ds_read_b64_tr_b16 v[226:227], v5 offset:53248
    s_waitcnt lgkmcnt(11)
    v_mfma_f32_16x16x32_bf16 v[32:35], v[212:215], v[124:127], v[32:35]
    ds_read_b64_tr_b16 v[228:229], v5 offset:57344
    s_waitcnt lgkmcnt(11)
    v_mfma_f32_16x16x32_bf16 v[32:35], v[208:211], v[120:123], v[32:35]
    ds_read_b64_tr_b16 v[230:231], v5 offset:61440
    s_waitcnt lgkmcnt(11)
    v_mfma_f32_16x16x32_bf16 v[48:51], v[208:211], v[128:131], v[48:51]
    ds_read_b64_tr_b16 v[232:233], v6 offset:49152
    s_waitcnt lgkmcnt(11)
    v_mfma_f32_16x16x32_bf16 v[48:51], v[212:215], v[132:135], v[48:51]
    ds_read_b64_tr_b16 v[234:235], v6 offset:53248
    s_waitcnt lgkmcnt(11)
    v_mfma_f32_16x16x32_bf16 v[64:67], v[212:215], v[140:143], v[64:67]
    ds_read_b64_tr_b16 v[236:237], v6 offset:57344
    s_waitcnt lgkmcnt(11)
    v_mfma_f32_16x16x32_bf16 v[64:67], v[208:211], v[136:139], v[64:67]
    ds_read_b64_tr_b16 v[238:239], v6 offset:61440
    s_waitcnt lgkmcnt(10)
    v_mfma_f32_16x16x32_bf16 v[68:71], v[216:219], v[136:139], v[68:71]
    s_waitcnt lgkmcnt(8)
    v_mfma_f32_16x16x32_bf16 v[68:71], v[220:223], v[140:143], v[68:71]
    v_mfma_f32_16x16x32_bf16 v[52:55], v[220:223], v[132:135], v[52:55]
    v_mfma_f32_16x16x32_bf16 v[52:55], v[216:219], v[128:131], v[52:55]
    v_mfma_f32_16x16x32_bf16 v[36:39], v[216:219], v[120:123], v[36:39]
    v_mfma_f32_16x16x32_bf16 v[36:39], v[220:223], v[124:127], v[36:39]
    v_mfma_f32_16x16x32_bf16 v[20:23], v[220:223], v[116:119], v[20:23]
    v_mfma_f32_16x16x32_bf16 v[20:23], v[216:219], v[112:115], v[20:23]
    s_waitcnt lgkmcnt(6)
    v_mfma_f32_16x16x32_bf16 v[24:27], v[224:227], v[112:115], v[24:27]
    s_waitcnt lgkmcnt(0)
    s_barrier
    v_mfma_f32_16x16x32_bf16 v[24:27], v[228:231], v[116:119], v[24:27]
    ds_read_b64_tr_b16 v[208:209], v3 offset:0
    ds_read_b64_tr_b16 v[210:211], v3 offset:4096
    v_mfma_f32_16x16x32_bf16 v[40:43], v[228:231], v[124:127], v[40:43]
    ds_read_b128 v[80:83], v1 offset:0
    v_mfma_f32_16x16x32_bf16 v[40:43], v[224:227], v[120:123], v[40:43]
    ds_read_b64_tr_b16 v[212:213], v3 offset:8192
    v_mfma_f32_16x16x32_bf16 v[56:59], v[224:227], v[128:131], v[56:59]
    ds_read_b64_tr_b16 v[214:215], v3 offset:12288
    v_mfma_f32_16x16x32_bf16 v[56:59], v[228:231], v[132:135], v[56:59]
    ds_read_b128 v[84:87], v2 offset:0
    v_mfma_f32_16x16x32_bf16 v[72:75], v[228:231], v[140:143], v[72:75]
    ds_read_b128 v[92:95], v2 offset:2048
    v_mfma_f32_16x16x32_bf16 v[72:75], v[224:227], v[136:139], v[72:75]
    ds_read_b128 v[88:91], v1 offset:2048
    v_mfma_f32_16x16x32_bf16 v[76:79], v[232:235], v[136:139], v[76:79]
    ds_read_b128 v[96:99], v1 offset:4096
    v_add_f32 v34, v242, v34
    v_mfma_f32_16x16x32_bf16 v[76:79], v[236:239], v[140:143], v[76:79]
    ds_read_b128 v[100:103], v2 offset:4096
    v_add_f32 v38, v246, v38
    v_mfma_f32_16x16x32_bf16 v[60:63], v[236:239], v[132:135], v[60:63]
    ds_read_b128 v[108:111], v2 offset:6144
    v_add_f32 v50, v242, v50
    v_mfma_f32_16x16x32_bf16 v[60:63], v[232:235], v[128:131], v[60:63]
    ds_read_b128 v[104:107], v1 offset:6144
    v_add_f32 v54, v246, v54
    v_mfma_f32_16x16x32_bf16 v[44:47], v[232:235], v[120:123], v[44:47]
    ds_read_b64_tr_b16 v[216:217], v4 offset:0
    v_add_f32 v66, v242, v66
    v_mfma_f32_16x16x32_bf16 v[44:47], v[236:239], v[124:127], v[44:47]
    ds_read_b64_tr_b16 v[218:219], v4 offset:4096
    v_add_f32 v70, v246, v70
    v_mfma_f32_16x16x32_bf16 v[28:31], v[236:239], v[116:119], v[28:31]
    ds_read_b64_tr_b16 v[220:221], v4 offset:8192
    v_mfma_f32_16x16x32_bf16 v[28:31], v[232:235], v[112:115], v[28:31]
    ds_read_b64_tr_b16 v[222:223], v4 offset:12288
    s_waitcnt lgkmcnt(13)
    v_mfma_f32_16x16x32_bf16 v[16:19], v[208:211], v[80:83], v[16:19]
    ds_read_b64_tr_b16 v[224:225], v5 offset:0
    s_waitcnt lgkmcnt(11)
    v_mfma_f32_16x16x32_bf16 v[16:19], v[212:215], v[84:87], v[16:19]
    ds_read_b64_tr_b16 v[226:227], v5 offset:4096
    s_waitcnt lgkmcnt(11)
    v_mfma_f32_16x16x32_bf16 v[32:35], v[212:215], v[92:95], v[32:35]
    ds_read_b64_tr_b16 v[228:229], v5 offset:8192
    s_waitcnt lgkmcnt(11)
    v_mfma_f32_16x16x32_bf16 v[32:35], v[208:211], v[88:91], v[32:35]
    ds_read_b64_tr_b16 v[230:231], v5 offset:12288
    s_waitcnt lgkmcnt(11)
    v_mfma_f32_16x16x32_bf16 v[48:51], v[208:211], v[96:99], v[48:51]
    ds_read_b64_tr_b16 v[232:233], v6 offset:0
    s_waitcnt lgkmcnt(11)
    v_mfma_f32_16x16x32_bf16 v[48:51], v[212:215], v[100:103], v[48:51]
    ds_read_b64_tr_b16 v[234:235], v6 offset:4096
    s_waitcnt lgkmcnt(11)
    v_mfma_f32_16x16x32_bf16 v[64:67], v[212:215], v[108:111], v[64:67]
    ds_read_b64_tr_b16 v[236:237], v6 offset:8192
    s_waitcnt lgkmcnt(11)
    v_mfma_f32_16x16x32_bf16 v[64:67], v[208:211], v[104:107], v[64:67]
    ds_read_b64_tr_b16 v[238:239], v6 offset:12288
    s_waitcnt lgkmcnt(10)
    v_mfma_f32_16x16x32_bf16 v[68:71], v[216:219], v[104:107], v[68:71]
    s_waitcnt lgkmcnt(8)
    v_mfma_f32_16x16x32_bf16 v[68:71], v[220:223], v[108:111], v[68:71]
    v_mfma_f32_16x16x32_bf16 v[52:55], v[220:223], v[100:103], v[52:55]
    v_mfma_f32_16x16x32_bf16 v[52:55], v[216:219], v[96:99], v[52:55]
    v_mfma_f32_16x16x32_bf16 v[36:39], v[216:219], v[88:91], v[36:39]
    v_mfma_f32_16x16x32_bf16 v[36:39], v[220:223], v[92:95], v[36:39]
    v_mfma_f32_16x16x32_bf16 v[20:23], v[220:223], v[84:87], v[20:23]
    v_mfma_f32_16x16x32_bf16 v[20:23], v[216:219], v[80:83], v[20:23]
    s_waitcnt lgkmcnt(6)
    v_mfma_f32_16x16x32_bf16 v[24:27], v[224:227], v[80:83], v[24:27]
    s_waitcnt lgkmcnt(0)
    s_barrier
    v_mfma_f32_16x16x32_bf16 v[24:27], v[228:231], v[84:87], v[24:27]
    ds_read_b64_tr_b16 v[208:209], v3 offset:16384
    ds_read_b64_tr_b16 v[210:211], v3 offset:20480
    v_mfma_f32_16x16x32_bf16 v[40:43], v[228:231], v[92:95], v[40:43]
    ds_read_b128 v[112:115], v1 offset:16384
    v_mfma_f32_16x16x32_bf16 v[40:43], v[224:227], v[88:91], v[40:43]
    ds_read_b64_tr_b16 v[212:213], v3 offset:24576
    v_mfma_f32_16x16x32_bf16 v[56:59], v[224:227], v[96:99], v[56:59]
    ds_read_b64_tr_b16 v[214:215], v3 offset:28672
    v_mfma_f32_16x16x32_bf16 v[56:59], v[228:231], v[100:103], v[56:59]
    ds_read_b128 v[116:119], v2 offset:16384
    v_mfma_f32_16x16x32_bf16 v[72:75], v[228:231], v[108:111], v[72:75]
    ds_read_b128 v[124:127], v2 offset:18432
    v_mfma_f32_16x16x32_bf16 v[72:75], v[224:227], v[104:107], v[72:75]
    ds_read_b128 v[120:123], v1 offset:18432
    v_mfma_f32_16x16x32_bf16 v[76:79], v[232:235], v[104:107], v[76:79]
    ds_read_b128 v[128:131], v1 offset:20480
    v_add_f32 v19, v243, v19
    v_mfma_f32_16x16x32_bf16 v[76:79], v[236:239], v[108:111], v[76:79]
    ds_read_b128 v[132:135], v2 offset:20480
    v_add_f32 v23, v247, v23
    v_mfma_f32_16x16x32_bf16 v[60:63], v[236:239], v[100:103], v[60:63]
    ds_read_b128 v[140:143], v2 offset:22528
    v_add_f32 v35, v243, v35
    v_mfma_f32_16x16x32_bf16 v[60:63], v[232:235], v[96:99], v[60:63]
    ds_read_b128 v[136:139], v1 offset:22528
    v_add_f32 v39, v247, v39
    v_mfma_f32_16x16x32_bf16 v[44:47], v[232:235], v[88:91], v[44:47]
    ds_read_b64_tr_b16 v[216:217], v4 offset:16384
    v_add_f32 v51, v243, v51
    v_mfma_f32_16x16x32_bf16 v[44:47], v[236:239], v[92:95], v[44:47]
    ds_read_b64_tr_b16 v[218:219], v4 offset:20480
    v_add_f32 v55, v247, v55
    v_mfma_f32_16x16x32_bf16 v[28:31], v[236:239], v[84:87], v[28:31]
    ds_read_b64_tr_b16 v[220:221], v4 offset:24576
    v_mfma_f32_16x16x32_bf16 v[28:31], v[232:235], v[80:83], v[28:31]
    ds_read_b64_tr_b16 v[222:223], v4 offset:28672
    s_waitcnt lgkmcnt(13)
    v_mfma_f32_16x16x32_bf16 v[16:19], v[208:211], v[112:115], v[16:19]
    ds_read_b64_tr_b16 v[224:225], v5 offset:16384
    s_waitcnt lgkmcnt(11)
    v_mfma_f32_16x16x32_bf16 v[16:19], v[212:215], v[116:119], v[16:19]
    ds_read_b64_tr_b16 v[226:227], v5 offset:20480
    s_waitcnt lgkmcnt(11)
    v_mfma_f32_16x16x32_bf16 v[32:35], v[212:215], v[124:127], v[32:35]
    ds_read_b64_tr_b16 v[228:229], v5 offset:24576
    s_waitcnt lgkmcnt(11)
    v_mfma_f32_16x16x32_bf16 v[32:35], v[208:211], v[120:123], v[32:35]
    ds_read_b64_tr_b16 v[230:231], v5 offset:28672
    s_waitcnt lgkmcnt(11)
    v_mfma_f32_16x16x32_bf16 v[48:51], v[208:211], v[128:131], v[48:51]
    ds_read_b64_tr_b16 v[232:233], v6 offset:16384
    s_waitcnt lgkmcnt(11)
    v_mfma_f32_16x16x32_bf16 v[48:51], v[212:215], v[132:135], v[48:51]
    ds_read_b64_tr_b16 v[234:235], v6 offset:20480
    s_waitcnt lgkmcnt(11)
    v_mfma_f32_16x16x32_bf16 v[64:67], v[212:215], v[140:143], v[64:67]
    ds_read_b64_tr_b16 v[236:237], v6 offset:24576
    s_waitcnt lgkmcnt(11)
    v_mfma_f32_16x16x32_bf16 v[64:67], v[208:211], v[136:139], v[64:67]
    ds_read_b64_tr_b16 v[238:239], v6 offset:28672
    s_waitcnt lgkmcnt(10)
    v_mfma_f32_16x16x32_bf16 v[68:71], v[216:219], v[136:139], v[68:71]
    s_waitcnt lgkmcnt(8)
    v_mfma_f32_16x16x32_bf16 v[68:71], v[220:223], v[140:143], v[68:71]
    v_mfma_f32_16x16x32_bf16 v[52:55], v[220:223], v[132:135], v[52:55]
    v_mfma_f32_16x16x32_bf16 v[52:55], v[216:219], v[128:131], v[52:55]
    v_mfma_f32_16x16x32_bf16 v[36:39], v[216:219], v[120:123], v[36:39]
    v_mfma_f32_16x16x32_bf16 v[36:39], v[220:223], v[124:127], v[36:39]
    v_mfma_f32_16x16x32_bf16 v[20:23], v[220:223], v[116:119], v[20:23]
    v_mfma_f32_16x16x32_bf16 v[20:23], v[216:219], v[112:115], v[20:23]
    s_waitcnt lgkmcnt(6)
    v_mfma_f32_16x16x32_bf16 v[24:27], v[224:227], v[112:115], v[24:27]
    s_waitcnt lgkmcnt(0)
    s_barrier
    v_mfma_f32_16x16x32_bf16 v[24:27], v[228:231], v[116:119], v[24:27]
    ds_read_b64_tr_b16 v[208:209], v3 offset:32768
    ds_read_b64_tr_b16 v[210:211], v3 offset:36864
    v_mfma_f32_16x16x32_bf16 v[40:43], v[228:231], v[124:127], v[40:43]
    ds_read_b128 v[80:83], v1 offset:32768
    v_mfma_f32_16x16x32_bf16 v[40:43], v[224:227], v[120:123], v[40:43]
    ds_read_b64_tr_b16 v[212:213], v3 offset:40960
    v_mfma_f32_16x16x32_bf16 v[56:59], v[224:227], v[128:131], v[56:59]
    ds_read_b64_tr_b16 v[214:215], v3 offset:45056
    v_mfma_f32_16x16x32_bf16 v[56:59], v[228:231], v[132:135], v[56:59]
    ds_read_b128 v[84:87], v2 offset:32768
    v_mfma_f32_16x16x32_bf16 v[72:75], v[228:231], v[140:143], v[72:75]
    ds_read_b128 v[92:95], v2 offset:34816
    v_mfma_f32_16x16x32_bf16 v[72:75], v[224:227], v[136:139], v[72:75]
    ds_read_b128 v[88:91], v1 offset:34816
    v_mfma_f32_16x16x32_bf16 v[76:79], v[232:235], v[136:139], v[76:79]
    ds_read_b128 v[96:99], v1 offset:36864
    v_add_f32 v67, v243, v67
    v_mfma_f32_16x16x32_bf16 v[76:79], v[236:239], v[140:143], v[76:79]
    ds_read_b128 v[100:103], v2 offset:36864
    v_add_f32 v71, v247, v71
    v_mfma_f32_16x16x32_bf16 v[60:63], v[236:239], v[132:135], v[60:63]
    ds_read_b128 v[108:111], v2 offset:38912
    v_mfma_f32_16x16x32_bf16 v[60:63], v[232:235], v[128:131], v[60:63]
    ds_read_b128 v[104:107], v1 offset:38912
    v_mfma_f32_16x16x32_bf16 v[44:47], v[232:235], v[120:123], v[44:47]
    ds_read_b64_tr_b16 v[216:217], v4 offset:32768
    v_mfma_f32_16x16x32_bf16 v[44:47], v[236:239], v[124:127], v[44:47]
    ds_read_b64_tr_b16 v[218:219], v4 offset:36864
    v_mfma_f32_16x16x32_bf16 v[28:31], v[236:239], v[116:119], v[28:31]
    ds_read_b64_tr_b16 v[220:221], v4 offset:40960
    v_mfma_f32_16x16x32_bf16 v[28:31], v[232:235], v[112:115], v[28:31]
    ds_read_b64_tr_b16 v[222:223], v4 offset:45056
    s_waitcnt lgkmcnt(13)
    v_mfma_f32_16x16x32_bf16 v[16:19], v[208:211], v[80:83], v[16:19]
    ds_read_b64_tr_b16 v[224:225], v5 offset:32768
    s_waitcnt lgkmcnt(11)
    v_mfma_f32_16x16x32_bf16 v[16:19], v[212:215], v[84:87], v[16:19]
    ds_read_b64_tr_b16 v[226:227], v5 offset:36864
    s_waitcnt lgkmcnt(11)
    v_mfma_f32_16x16x32_bf16 v[32:35], v[212:215], v[92:95], v[32:35]
    ds_read_b64_tr_b16 v[228:229], v5 offset:40960
    s_waitcnt lgkmcnt(11)
    v_mfma_f32_16x16x32_bf16 v[32:35], v[208:211], v[88:91], v[32:35]
    ds_read_b64_tr_b16 v[230:231], v5 offset:45056
    s_waitcnt lgkmcnt(11)
    v_mfma_f32_16x16x32_bf16 v[48:51], v[208:211], v[96:99], v[48:51]
    ds_read_b64_tr_b16 v[232:233], v6 offset:32768
    s_waitcnt lgkmcnt(11)
    v_mfma_f32_16x16x32_bf16 v[48:51], v[212:215], v[100:103], v[48:51]
    ds_read_b64_tr_b16 v[234:235], v6 offset:36864
    s_waitcnt lgkmcnt(11)
    v_mfma_f32_16x16x32_bf16 v[64:67], v[212:215], v[108:111], v[64:67]
    ds_read_b64_tr_b16 v[236:237], v6 offset:40960
    s_waitcnt lgkmcnt(11)
    v_mfma_f32_16x16x32_bf16 v[64:67], v[208:211], v[104:107], v[64:67]
    ds_read_b64_tr_b16 v[238:239], v6 offset:45056
    s_waitcnt lgkmcnt(10)
    v_mfma_f32_16x16x32_bf16 v[68:71], v[216:219], v[104:107], v[68:71]
    s_waitcnt lgkmcnt(8)
    v_mfma_f32_16x16x32_bf16 v[68:71], v[220:223], v[108:111], v[68:71]
    v_mfma_f32_16x16x32_bf16 v[52:55], v[220:223], v[100:103], v[52:55]
    v_mfma_f32_16x16x32_bf16 v[52:55], v[216:219], v[96:99], v[52:55]
    v_mfma_f32_16x16x32_bf16 v[36:39], v[216:219], v[88:91], v[36:39]
    v_mfma_f32_16x16x32_bf16 v[36:39], v[220:223], v[92:95], v[36:39]
    v_mfma_f32_16x16x32_bf16 v[20:23], v[220:223], v[84:87], v[20:23]
    v_mfma_f32_16x16x32_bf16 v[20:23], v[216:219], v[80:83], v[20:23]
    s_waitcnt lgkmcnt(6)
    v_mfma_f32_16x16x32_bf16 v[24:27], v[224:227], v[80:83], v[24:27]
    s_waitcnt lgkmcnt(0)
    s_barrier
    v_mfma_f32_16x16x32_bf16 v[24:27], v[228:231], v[84:87], v[24:27]
    ds_read_b64_tr_b16 v[208:209], v3 offset:49152
    ds_read_b64_tr_b16 v[210:211], v3 offset:53248
    v_mfma_f32_16x16x32_bf16 v[40:43], v[228:231], v[92:95], v[40:43]
    ds_read_b128 v[112:115], v1 offset:49152
    v_mfma_f32_16x16x32_bf16 v[40:43], v[224:227], v[88:91], v[40:43]
    ds_read_b64_tr_b16 v[212:213], v3 offset:57344
    v_mfma_f32_16x16x32_bf16 v[56:59], v[224:227], v[96:99], v[56:59]
    ds_read_b64_tr_b16 v[214:215], v3 offset:61440
    v_mfma_f32_16x16x32_bf16 v[56:59], v[228:231], v[100:103], v[56:59]
    ds_read_b128 v[116:119], v2 offset:49152
    v_mfma_f32_16x16x32_bf16 v[72:75], v[228:231], v[108:111], v[72:75]
    ds_read_b128 v[124:127], v2 offset:51200
    v_mfma_f32_16x16x32_bf16 v[72:75], v[224:227], v[104:107], v[72:75]
    ds_read_b128 v[120:123], v1 offset:51200
    v_mfma_f32_16x16x32_bf16 v[76:79], v[232:235], v[104:107], v[76:79]
    ds_read_b128 v[128:131], v1 offset:53248
    v_mfma_f32_16x16x32_bf16 v[76:79], v[236:239], v[108:111], v[76:79]
    ds_read_b128 v[132:135], v2 offset:53248
    v_mfma_f32_16x16x32_bf16 v[60:63], v[236:239], v[100:103], v[60:63]
    ds_read_b128 v[140:143], v2 offset:55296
    v_mfma_f32_16x16x32_bf16 v[60:63], v[232:235], v[96:99], v[60:63]
    ds_read_b128 v[136:139], v1 offset:55296
    v_mfma_f32_16x16x32_bf16 v[44:47], v[232:235], v[88:91], v[44:47]
    ds_read_b64_tr_b16 v[216:217], v4 offset:49152
    v_mfma_f32_16x16x32_bf16 v[44:47], v[236:239], v[92:95], v[44:47]
    ds_read_b64_tr_b16 v[218:219], v4 offset:53248
    v_mfma_f32_16x16x32_bf16 v[28:31], v[236:239], v[84:87], v[28:31]
    ds_read_b64_tr_b16 v[220:221], v4 offset:57344
    v_mfma_f32_16x16x32_bf16 v[28:31], v[232:235], v[80:83], v[28:31]
    ds_read_b64_tr_b16 v[222:223], v4 offset:61440
    s_waitcnt lgkmcnt(13)
    v_mfma_f32_16x16x32_bf16 v[16:19], v[208:211], v[112:115], v[16:19]
    ds_read_b64_tr_b16 v[224:225], v5 offset:49152
    s_waitcnt lgkmcnt(11)
    v_mfma_f32_16x16x32_bf16 v[16:19], v[212:215], v[116:119], v[16:19]
    ds_read_b64_tr_b16 v[226:227], v5 offset:53248
    s_waitcnt lgkmcnt(11)
    v_mfma_f32_16x16x32_bf16 v[32:35], v[212:215], v[124:127], v[32:35]
    ds_read_b64_tr_b16 v[228:229], v5 offset:57344
    s_waitcnt lgkmcnt(11)
    v_mfma_f32_16x16x32_bf16 v[32:35], v[208:211], v[120:123], v[32:35]
    ds_read_b64_tr_b16 v[230:231], v5 offset:61440
    s_waitcnt lgkmcnt(11)
    v_mfma_f32_16x16x32_bf16 v[48:51], v[208:211], v[128:131], v[48:51]
    ds_read_b64_tr_b16 v[232:233], v6 offset:49152
    s_waitcnt lgkmcnt(11)
    v_mfma_f32_16x16x32_bf16 v[48:51], v[212:215], v[132:135], v[48:51]
    ds_read_b64_tr_b16 v[234:235], v6 offset:53248
    s_waitcnt lgkmcnt(11)
    v_mfma_f32_16x16x32_bf16 v[64:67], v[212:215], v[140:143], v[64:67]
    ds_read_b64_tr_b16 v[236:237], v6 offset:57344
    s_waitcnt lgkmcnt(11)
    v_mfma_f32_16x16x32_bf16 v[64:67], v[208:211], v[136:139], v[64:67]
    ds_read_b64_tr_b16 v[238:239], v6 offset:61440
    s_waitcnt lgkmcnt(10)
    v_mfma_f32_16x16x32_bf16 v[68:71], v[216:219], v[136:139], v[68:71]
    s_waitcnt lgkmcnt(8)
    v_mfma_f32_16x16x32_bf16 v[68:71], v[220:223], v[140:143], v[68:71]
    v_mfma_f32_16x16x32_bf16 v[52:55], v[220:223], v[132:135], v[52:55]
    v_mfma_f32_16x16x32_bf16 v[52:55], v[216:219], v[128:131], v[52:55]
    v_mfma_f32_16x16x32_bf16 v[36:39], v[216:219], v[120:123], v[36:39]
    v_mfma_f32_16x16x32_bf16 v[36:39], v[220:223], v[124:127], v[36:39]
    v_mfma_f32_16x16x32_bf16 v[20:23], v[220:223], v[116:119], v[20:23]
    v_mfma_f32_16x16x32_bf16 v[20:23], v[216:219], v[112:115], v[20:23]
    s_waitcnt lgkmcnt(6)
    v_mfma_f32_16x16x32_bf16 v[24:27], v[224:227], v[112:115], v[24:27]
    s_waitcnt lgkmcnt(0)
    s_barrier
    v_mfma_f32_16x16x32_bf16 v[24:27], v[228:231], v[116:119], v[24:27]
    ds_read_b64_tr_b16 v[208:209], v3 offset:0
    ds_read_b64_tr_b16 v[210:211], v3 offset:4096
    v_mfma_f32_16x16x32_bf16 v[40:43], v[228:231], v[124:127], v[40:43]
    ds_read_b128 v[80:83], v1 offset:0
    v_mfma_f32_16x16x32_bf16 v[40:43], v[224:227], v[120:123], v[40:43]
    ds_read_b64_tr_b16 v[212:213], v3 offset:8192
    v_mfma_f32_16x16x32_bf16 v[56:59], v[224:227], v[128:131], v[56:59]
    ds_read_b64_tr_b16 v[214:215], v3 offset:12288
    v_mfma_f32_16x16x32_bf16 v[56:59], v[228:231], v[132:135], v[56:59]
    ds_read_b128 v[84:87], v2 offset:0
    v_mfma_f32_16x16x32_bf16 v[72:75], v[228:231], v[140:143], v[72:75]
    ds_read_b128 v[92:95], v2 offset:2048
    v_mfma_f32_16x16x32_bf16 v[72:75], v[224:227], v[136:139], v[72:75]
    ds_read_b128 v[88:91], v1 offset:2048
    v_mfma_f32_16x16x32_bf16 v[76:79], v[232:235], v[136:139], v[76:79]
    ds_read_b128 v[96:99], v1 offset:4096
    v_mfma_f32_16x16x32_bf16 v[76:79], v[236:239], v[140:143], v[76:79]
    ds_read_b128 v[100:103], v2 offset:4096
    v_mfma_f32_16x16x32_bf16 v[60:63], v[236:239], v[132:135], v[60:63]
    ds_read_b128 v[108:111], v2 offset:6144
    v_mfma_f32_16x16x32_bf16 v[60:63], v[232:235], v[128:131], v[60:63]
    ds_read_b128 v[104:107], v1 offset:6144
    v_mfma_f32_16x16x32_bf16 v[44:47], v[232:235], v[120:123], v[44:47]
    ds_read_b64_tr_b16 v[216:217], v4 offset:0
    v_mfma_f32_16x16x32_bf16 v[44:47], v[236:239], v[124:127], v[44:47]
    ds_read_b64_tr_b16 v[218:219], v4 offset:4096
    v_mfma_f32_16x16x32_bf16 v[28:31], v[236:239], v[116:119], v[28:31]
    ds_read_b64_tr_b16 v[220:221], v4 offset:8192
    v_mfma_f32_16x16x32_bf16 v[28:31], v[232:235], v[112:115], v[28:31]
    ds_read_b64_tr_b16 v[222:223], v4 offset:12288
    s_waitcnt lgkmcnt(13)
    v_mfma_f32_16x16x32_bf16 v[16:19], v[208:211], v[80:83], v[16:19]
    ds_read_b64_tr_b16 v[224:225], v5 offset:0
    s_waitcnt lgkmcnt(11)
    v_mfma_f32_16x16x32_bf16 v[16:19], v[212:215], v[84:87], v[16:19]
    ds_read_b64_tr_b16 v[226:227], v5 offset:4096
    s_waitcnt lgkmcnt(11)
    v_mfma_f32_16x16x32_bf16 v[32:35], v[212:215], v[92:95], v[32:35]
    ds_read_b64_tr_b16 v[228:229], v5 offset:8192
    s_waitcnt lgkmcnt(11)
    v_mfma_f32_16x16x32_bf16 v[32:35], v[208:211], v[88:91], v[32:35]
    ds_read_b64_tr_b16 v[230:231], v5 offset:12288
    s_waitcnt lgkmcnt(11)
    v_mfma_f32_16x16x32_bf16 v[48:51], v[208:211], v[96:99], v[48:51]
    ds_read_b64_tr_b16 v[232:233], v6 offset:0
    s_waitcnt lgkmcnt(11)
    v_mfma_f32_16x16x32_bf16 v[48:51], v[212:215], v[100:103], v[48:51]
    ds_read_b64_tr_b16 v[234:235], v6 offset:4096
    s_waitcnt lgkmcnt(11)
    v_mfma_f32_16x16x32_bf16 v[64:67], v[212:215], v[108:111], v[64:67]
    ds_read_b64_tr_b16 v[236:237], v6 offset:8192
    s_waitcnt lgkmcnt(11)
    v_mfma_f32_16x16x32_bf16 v[64:67], v[208:211], v[104:107], v[64:67]
    ds_read_b64_tr_b16 v[238:239], v6 offset:12288
    s_waitcnt lgkmcnt(10)
    v_mfma_f32_16x16x32_bf16 v[68:71], v[216:219], v[104:107], v[68:71]
    s_waitcnt lgkmcnt(8)
    v_mfma_f32_16x16x32_bf16 v[68:71], v[220:223], v[108:111], v[68:71]
    v_mfma_f32_16x16x32_bf16 v[52:55], v[220:223], v[100:103], v[52:55]
    v_and_b32 v240, 15, v0
    v_lshrrev_b32 v241, 4, v0
    v_bfe_u32 v242, v240, 1, 2
    v_lshrrev_b32 v243, 1, v241
    v_xor_b32 v242, v242, v243
    v_lshlrev_b32 v242, 4, v242
    v_and_b32 v243, 1, v241
    v_lshlrev_b32 v243, 3, v243
    v_add_u32 v242, v242, v243
    v_lshlrev_b32 v243, 6, v240
    v_add_u32 v242, v242, v243
    s_lshl_b32 s34, s3, 11
    v_add_u32 v7, s34, v242
    v_xor_b32 v11, 32, v7
    v_lshrrev_b32 v240, 2, v0
    v_and_b32 v241, 3, v0
    v_bfe_u32 v242, v240, 1, 2
    v_xor_b32 v242, v242, v241
    v_lshlrev_b32 v242, 4, v242
    v_lshlrev_b32 v243, 6, v240
    v_add_u32 v242, v242, v243
    v_add_u32 v9, s34, v242
    v_lshlrev_b32 v242, 11, v240
    v_lshlrev_b32 v243, 4, v241
    v_add_u32 v10, v242, v243
    s_lshl_b32 s60, s28, 18
    s_lshl_b32 s34, s30, 17
    s_add_u32 s60, s60, s34
    s_lshl_b32 s34, s29, 8
    s_add_u32 s60, s60, s34
    s_lshl_b32 s34, s31, 7
    s_add_u32 s60, s60, s34
    v_mfma_f32_16x16x32_bf16 v[52:55], v[216:219], v[96:99], v[52:55]
    v_mfma_f32_16x16x32_bf16 v[36:39], v[216:219], v[88:91], v[36:39]
    v_mfma_f32_16x16x32_bf16 v[36:39], v[220:223], v[92:95], v[36:39]
    v_mfma_f32_16x16x32_bf16 v[20:23], v[220:223], v[84:87], v[20:23]
    v_mfma_f32_16x16x32_bf16 v[20:23], v[216:219], v[80:83], v[20:23]
    s_waitcnt lgkmcnt(6)
    v_mfma_f32_16x16x32_bf16 v[24:27], v[224:227], v[80:83], v[24:27]
    s_waitcnt lgkmcnt(0)
    s_barrier
    v_mfma_f32_16x16x32_bf16 v[24:27], v[228:231], v[84:87], v[24:27]
    ds_read_b64_tr_b16 v[208:209], v3 offset:16384
    ds_read_b64_tr_b16 v[210:211], v3 offset:20480
    v_mfma_f32_16x16x32_bf16 v[40:43], v[228:231], v[92:95], v[40:43]
    ds_read_b128 v[112:115], v1 offset:16384
    v_mfma_f32_16x16x32_bf16 v[40:43], v[224:227], v[88:91], v[40:43]
    ds_read_b64_tr_b16 v[212:213], v3 offset:24576
    v_mfma_f32_16x16x32_bf16 v[56:59], v[224:227], v[96:99], v[56:59]
    ds_read_b64_tr_b16 v[214:215], v3 offset:28672
    v_mfma_f32_16x16x32_bf16 v[56:59], v[228:231], v[100:103], v[56:59]
    ds_read_b128 v[116:119], v2 offset:16384
    v_mfma_f32_16x16x32_bf16 v[72:75], v[228:231], v[108:111], v[72:75]
    ds_read_b128 v[124:127], v2 offset:18432
    v_mfma_f32_16x16x32_bf16 v[72:75], v[224:227], v[104:107], v[72:75]
    ds_read_b128 v[120:123], v1 offset:18432
    v_mfma_f32_16x16x32_bf16 v[76:79], v[232:235], v[104:107], v[76:79]
    ds_read_b128 v[128:131], v1 offset:20480
    v_mfma_f32_16x16x32_bf16 v[76:79], v[236:239], v[108:111], v[76:79]
    ds_read_b128 v[132:135], v2 offset:20480
    v_mfma_f32_16x16x32_bf16 v[60:63], v[236:239], v[100:103], v[60:63]
    ds_read_b128 v[140:143], v2 offset:22528
    v_mfma_f32_16x16x32_bf16 v[60:63], v[232:235], v[96:99], v[60:63]
    ds_read_b128 v[136:139], v1 offset:22528
    v_mfma_f32_16x16x32_bf16 v[44:47], v[232:235], v[88:91], v[44:47]
    ds_read_b64_tr_b16 v[216:217], v4 offset:16384
    v_mfma_f32_16x16x32_bf16 v[44:47], v[236:239], v[92:95], v[44:47]
    ds_read_b64_tr_b16 v[218:219], v4 offset:20480
    v_mfma_f32_16x16x32_bf16 v[28:31], v[236:239], v[84:87], v[28:31]
    ds_read_b64_tr_b16 v[220:221], v4 offset:24576
    v_mfma_f32_16x16x32_bf16 v[28:31], v[232:235], v[80:83], v[28:31]
    ds_read_b64_tr_b16 v[222:223], v4 offset:28672
    s_waitcnt lgkmcnt(13)
    v_mfma_f32_16x16x32_bf16 v[16:19], v[208:211], v[112:115], v[16:19]
    ds_read_b64_tr_b16 v[224:225], v5 offset:16384
    s_waitcnt lgkmcnt(11)
    v_mfma_f32_16x16x32_bf16 v[16:19], v[212:215], v[116:119], v[16:19]
    ds_read_b64_tr_b16 v[226:227], v5 offset:20480
    s_waitcnt lgkmcnt(11)
    v_mfma_f32_16x16x32_bf16 v[32:35], v[212:215], v[124:127], v[32:35]
    ds_read_b64_tr_b16 v[228:229], v5 offset:24576
    s_waitcnt lgkmcnt(11)
    v_mfma_f32_16x16x32_bf16 v[32:35], v[208:211], v[120:123], v[32:35]
    ds_read_b64_tr_b16 v[230:231], v5 offset:28672
    s_waitcnt lgkmcnt(11)
    v_mfma_f32_16x16x32_bf16 v[48:51], v[208:211], v[128:131], v[48:51]
    ds_read_b64_tr_b16 v[232:233], v6 offset:16384
    s_waitcnt lgkmcnt(11)
    v_mfma_f32_16x16x32_bf16 v[48:51], v[212:215], v[132:135], v[48:51]
    ds_read_b64_tr_b16 v[234:235], v6 offset:20480
    s_waitcnt lgkmcnt(11)
    v_mfma_f32_16x16x32_bf16 v[64:67], v[212:215], v[140:143], v[64:67]
    ds_read_b64_tr_b16 v[236:237], v6 offset:24576
    s_waitcnt lgkmcnt(11)
    v_mfma_f32_16x16x32_bf16 v[64:67], v[208:211], v[136:139], v[64:67]
    ds_read_b64_tr_b16 v[238:239], v6 offset:28672
    s_waitcnt lgkmcnt(10)
    v_mfma_f32_16x16x32_bf16 v[68:71], v[216:219], v[136:139], v[68:71]
    s_waitcnt lgkmcnt(8)
    v_mfma_f32_16x16x32_bf16 v[68:71], v[220:223], v[140:143], v[68:71]
    v_mfma_f32_16x16x32_bf16 v[52:55], v[220:223], v[132:135], v[52:55]
    v_mfma_f32_16x16x32_bf16 v[52:55], v[216:219], v[128:131], v[52:55]
    v_mfma_f32_16x16x32_bf16 v[36:39], v[216:219], v[120:123], v[36:39]
    v_mfma_f32_16x16x32_bf16 v[36:39], v[220:223], v[124:127], v[36:39]
    v_mfma_f32_16x16x32_bf16 v[20:23], v[220:223], v[116:119], v[20:23]
    v_mfma_f32_16x16x32_bf16 v[20:23], v[216:219], v[112:115], v[20:23]
    s_waitcnt lgkmcnt(6)
    v_mfma_f32_16x16x32_bf16 v[24:27], v[224:227], v[112:115], v[24:27]
    s_waitcnt lgkmcnt(0)
    s_barrier
    v_mfma_f32_16x16x32_bf16 v[24:27], v[228:231], v[116:119], v[24:27]
    ds_read_b64_tr_b16 v[96:97], v3 offset:32768
    v_mfma_f32_16x16x32_bf16 v[40:43], v[228:231], v[124:127], v[40:43]
    ds_read_b64_tr_b16 v[98:99], v3 offset:36864
    v_mfma_f32_16x16x32_bf16 v[40:43], v[224:227], v[120:123], v[40:43]
    ds_read_b128 v[80:83], v1 offset:32768
    v_mfma_f32_16x16x32_bf16 v[56:59], v[224:227], v[128:131], v[56:59]
    ds_read_b128 v[84:87], v1 offset:34816
    v_mfma_f32_16x16x32_bf16 v[56:59], v[228:231], v[132:135], v[56:59]
    ds_read_b128 v[88:91], v1 offset:36864
    v_mfma_f32_16x16x32_bf16 v[72:75], v[228:231], v[140:143], v[72:75]
    ds_read_b128 v[92:95], v1 offset:38912
    v_mfma_f32_16x16x32_bf16 v[72:75], v[224:227], v[136:139], v[72:75]
    ds_read_b64_tr_b16 v[100:101], v4 offset:32768
    v_mfma_f32_16x16x32_bf16 v[76:79], v[232:235], v[136:139], v[76:79]
    ds_read_b64_tr_b16 v[102:103], v4 offset:36864
    v_mfma_f32_16x16x32_bf16 v[76:79], v[236:239], v[140:143], v[76:79]
    ds_read_b64_tr_b16 v[104:105], v5 offset:32768
    v_mfma_f32_16x16x32_bf16 v[60:63], v[236:239], v[132:135], v[60:63]
    ds_read_b64_tr_b16 v[106:107], v5 offset:36864
    v_mfma_f32_16x16x32_bf16 v[60:63], v[232:235], v[128:131], v[60:63]
    ds_read_b64_tr_b16 v[108:109], v6 offset:32768
    v_mfma_f32_16x16x32_bf16 v[44:47], v[232:235], v[120:123], v[44:47]
    ds_read_b64_tr_b16 v[110:111], v6 offset:36864
    v_mfma_f32_16x16x32_bf16 v[44:47], v[236:239], v[124:127], v[44:47]
    v_mfma_f32_16x16x32_bf16 v[28:31], v[236:239], v[116:119], v[28:31]
    v_mfma_f32_16x16x32_bf16 v[28:31], v[232:235], v[112:115], v[28:31]
    s_waitcnt lgkmcnt(9)
    v_mfma_f32_16x16x32_bf16 v[16:19], v[96:99], v[80:83], v[16:19]
    ds_read_b64_tr_b16 v[112:113], v3 offset:40960
    s_waitcnt lgkmcnt(9)
    v_mfma_f32_16x16x32_bf16 v[32:35], v[96:99], v[84:87], v[32:35]
    ds_read_b64_tr_b16 v[114:115], v3 offset:45056
    s_waitcnt lgkmcnt(9)
    v_mfma_f32_16x16x32_bf16 v[48:51], v[96:99], v[88:91], v[48:51]
    ds_read_b128 v[208:211], v2 offset:32768
    s_waitcnt lgkmcnt(9)
    v_mfma_f32_16x16x32_bf16 v[64:67], v[96:99], v[92:95], v[64:67]
    ds_read_b64_tr_b16 v[124:125], v4 offset:40960
    s_waitcnt lgkmcnt(8)
    v_mfma_f32_16x16x32_bf16 v[68:71], v[100:103], v[92:95], v[68:71]
    ds_read_b64_tr_b16 v[126:127], v4 offset:45056
    s_barrier
    v_mfma_f32_16x16x32_bf16 v[52:55], v[100:103], v[88:91], v[52:55]
    ds_read_b64_tr_b16 v[116:117], v3 offset:49152
    v_mfma_f32_16x16x32_bf16 v[36:39], v[100:103], v[84:87], v[36:39]
    ds_read_b64_tr_b16 v[118:119], v3 offset:53248
    v_mfma_f32_16x16x32_bf16 v[20:23], v[100:103], v[80:83], v[20:23]
    ds_read_b128 v[212:215], v1 offset:49152
    s_waitcnt lgkmcnt(10)
    v_mfma_f32_16x16x32_bf16 v[24:27], v[104:107], v[80:83], v[24:27]
    ds_read_b64_tr_b16 v[120:121], v3 offset:57344
    v_mfma_f32_16x16x32_bf16 v[40:43], v[104:107], v[84:87], v[40:43]
    ds_read_b64_tr_b16 v[122:123], v3 offset:61440
    v_mfma_f32_16x16x32_bf16 v[56:59], v[104:107], v[88:91], v[56:59]
    ds_read_b128 v[216:219], v2 offset:49152
    v_mfma_f32_16x16x32_bf16 v[72:75], v[104:107], v[92:95], v[72:75]
    ds_read_b64_tr_b16 v[128:129], v4 offset:49152
    s_waitcnt lgkmcnt(12)
    v_mfma_f32_16x16x32_bf16 v[76:79], v[108:111], v[92:95], v[76:79]
    ds_read_b64_tr_b16 v[130:131], v4 offset:53248
    v_mfma_f32_16x16x32_bf16 v[60:63], v[108:111], v[88:91], v[60:63]
    ds_read_b64_tr_b16 v[132:133], v4 offset:57344
    v_mfma_f32_16x16x32_bf16 v[44:47], v[108:111], v[84:87], v[44:47]
    ds_read_b64_tr_b16 v[134:135], v4 offset:61440
    v_mfma_f32_16x16x32_bf16 v[28:31], v[108:111], v[80:83], v[28:31]
    s_waitcnt lgkmcnt(12)
    v_mfma_f32_16x16x32_bf16 v[16:19], v[112:115], v[208:211], v[16:19]
    ds_read_b128 v[220:223], v2 offset:34816
    s_waitcnt lgkmcnt(8)
    v_mfma_f32_16x16x32_bf16 v[16:19], v[116:119], v[212:215], v[16:19]
    ds_read_b128 v[224:227], v1 offset:51200
    s_waitcnt lgkmcnt(6)
    v_mfma_f32_16x16x32_bf16 v[16:19], v[120:123], v[216:219], v[16:19]
    ds_read_b128 v[228:231], v2 offset:51200
    v_mfma_f32_16x16x32_bf16 v[20:23], v[124:127], v[208:211], v[20:23]
    ds_read_b64_tr_b16 v[80:81], v5 offset:40960
    s_waitcnt lgkmcnt(6)
    v_mfma_f32_16x16x32_bf16 v[20:23], v[128:131], v[212:215], v[20:23]
    ds_read_b64_tr_b16 v[82:83], v5 offset:45056
    s_waitcnt lgkmcnt(5)
    v_mfma_f32_16x16x32_bf16 v[20:23], v[132:135], v[216:219], v[20:23]
    ds_read_b64_tr_b16 v[84:85], v5 offset:49152
    s_waitcnt lgkmcnt(5)
    v_mfma_f32_16x16x32_bf16 v[32:35], v[112:115], v[220:223], v[32:35]
    ds_read_b128 v[208:211], v2 offset:36864
    v_mul_f32 v232, v144, v16
    v_mul_f32 v233, v145, v17
    s_waitcnt lgkmcnt(5)
    v_mfma_f32_16x16x32_bf16 v[32:35], v[116:119], v[224:227], v[32:35]
    ds_read_b128 v[212:215], v1 offset:53248
    v_mul_f32 v234, v146, v18
    v_mul_f32 v235, v147, v19
    v_cvt_pk_bf16_f32 v240, v232, v233
    s_waitcnt lgkmcnt(5)
    v_mfma_f32_16x16x32_bf16 v[32:35], v[120:123], v[228:231], v[32:35]
    ds_read_b128 v[216:219], v2 offset:53248
    v_cvt_pk_bf16_f32 v241, v234, v235
    v_mul_f32 v236, v148, v20
    v_mfma_f32_16x16x32_bf16 v[36:39], v[124:127], v[220:223], v[36:39]
    ds_read_b64_tr_b16 v[86:87], v5 offset:53248
    v_mul_f32 v237, v149, v21
    v_mul_f32 v238, v150, v22
    v_mul_f32 v239, v151, v23
    v_mfma_f32_16x16x32_bf16 v[36:39], v[128:131], v[224:227], v[36:39]
    ds_read_b64_tr_b16 v[88:89], v5 offset:57344
    v_cvt_pk_bf16_f32 v242, v236, v237
    v_cvt_pk_bf16_f32 v243, v238, v239
    v_mfma_f32_16x16x32_bf16 v[36:39], v[132:135], v[228:231], v[36:39]
    ds_read_b64_tr_b16 v[90:91], v5 offset:61440
    ds_write_b64 v7, v[240:241] offset:0
    ds_write_b64 v11, v[242:243] offset:0
    ds_read_b128 v[136:139], v9 offset:0
    s_waitcnt lgkmcnt(8)
    v_mfma_f32_16x16x32_bf16 v[48:51], v[112:115], v[208:211], v[48:51]
    ds_read_b128 v[220:223], v2 offset:38912
    v_mul_f32 v232, v160, v32
    v_mul_f32 v233, v161, v33
    s_waitcnt lgkmcnt(8)
    v_mfma_f32_16x16x32_bf16 v[48:51], v[116:119], v[212:215], v[48:51]
    ds_read_b128 v[224:227], v1 offset:55296
    v_mul_f32 v234, v162, v34
    v_mul_f32 v235, v163, v35
    v_cvt_pk_bf16_f32 v244, v232, v233
    s_waitcnt lgkmcnt(8)
    v_mfma_f32_16x16x32_bf16 v[48:51], v[120:123], v[216:219], v[48:51]
    ds_read_b128 v[228:231], v2 offset:55296
    v_cvt_pk_bf16_f32 v245, v234, v235
    v_mul_f32 v236, v164, v36
    v_mul_f32 v237, v165, v37
    v_mfma_f32_16x16x32_bf16 v[52:55], v[124:127], v[208:211], v[52:55]
    ds_read_b64_tr_b16 v[92:93], v6 offset:40960
    v_mul_f32 v238, v166, v38
    v_mul_f32 v239, v167, v39
    v_mfma_f32_16x16x32_bf16 v[52:55], v[128:131], v[212:215], v[52:55]
    ds_read_b64_tr_b16 v[94:95], v6 offset:45056
    v_cvt_pk_bf16_f32 v246, v236, v237
    v_cvt_pk_bf16_f32 v247, v238, v239
    ds_write_b64 v7, v[244:245] offset:1024
    v_mfma_f32_16x16x32_bf16 v[52:55], v[132:135], v[216:219], v[52:55]
    ds_read_b64_tr_b16 v[96:97], v6 offset:49152
    ds_write_b64 v11, v[246:247] offset:1024
    ds_read_b128 v[140:143], v9 offset:1024
    s_waitcnt lgkmcnt(9)
    s_add_u32 s34, s60, 0
    buffer_store_dwordx4 v[136:139], v10, s[20:23], s34 offen nt
    s_waitcnt lgkmcnt(8)
    v_mfma_f32_16x16x32_bf16 v[64:67], v[112:115], v[220:223], v[64:67]
    ds_read_b128 v[208:211], v2 offset:32768
    v_mul_f32 v232, v176, v48
    v_mul_f32 v233, v177, v49
    s_waitcnt lgkmcnt(8)
    v_mfma_f32_16x16x32_bf16 v[64:67], v[116:119], v[224:227], v[64:67]
    ds_read_b128 v[212:215], v1 offset:49152
    v_mul_f32 v234, v178, v50
    v_mul_f32 v235, v179, v51
    v_cvt_pk_bf16_f32 v248, v232, v233
    s_waitcnt lgkmcnt(8)
    v_mfma_f32_16x16x32_bf16 v[64:67], v[120:123], v[228:231], v[64:67]
    ds_read_b128 v[216:219], v2 offset:49152
    v_cvt_pk_bf16_f32 v249, v234, v235
    v_mul_f32 v236, v180, v52
    v_mul_f32 v237, v181, v53
    v_mfma_f32_16x16x32_bf16 v[68:71], v[124:127], v[220:223], v[68:71]
    ds_read_b64_tr_b16 v[98:99], v6 offset:53248
    v_mul_f32 v238, v182, v54
    v_mul_f32 v239, v183, v55
    v_mfma_f32_16x16x32_bf16 v[68:71], v[128:131], v[224:227], v[68:71]
    ds_read_b64_tr_b16 v[100:101], v6 offset:57344
    v_cvt_pk_bf16_f32 v250, v236, v237
    v_cvt_pk_bf16_f32 v251, v238, v239
    ds_write_b64 v7, v[248:249] offset:0
    v_mfma_f32_16x16x32_bf16 v[68:71], v[132:135], v[228:231], v[68:71]
    ds_read_b64_tr_b16 v[102:103], v6 offset:61440
    ds_write_b64 v11, v[250:251] offset:0
    ds_read_b128 v[136:139], v9 offset:0
    s_waitcnt lgkmcnt(9)
    s_add_u32 s34, s60, 32768
    buffer_store_dwordx4 v[140:143], v10, s[20:23], s34 offen nt
    s_waitcnt lgkmcnt(8)
    v_mfma_f32_16x16x32_bf16 v[24:27], v[80:83], v[208:211], v[24:27]
    ds_read_b128 v[220:223], v2 offset:34816
    v_mul_f32 v232, v192, v64
    v_mul_f32 v233, v193, v65
    s_waitcnt lgkmcnt(8)
    v_mfma_f32_16x16x32_bf16 v[24:27], v[84:87], v[212:215], v[24:27]
    ds_read_b128 v[224:227], v1 offset:51200
    v_mul_f32 v234, v194, v66
    v_mul_f32 v235, v195, v67
    v_cvt_pk_bf16_f32 v252, v232, v233
    s_waitcnt lgkmcnt(8)
    v_mfma_f32_16x16x32_bf16 v[24:27], v[88:91], v[216:219], v[24:27]
    ds_read_b128 v[228:231], v2 offset:51200
    v_cvt_pk_bf16_f32 v253, v234, v235
    v_mul_f32 v236, v196, v68
    v_mul_f32 v237, v197, v69
    v_mfma_f32_16x16x32_bf16 v[28:31], v[92:95], v[208:211], v[28:31]
    v_mul_f32 v238, v198, v70
    v_mul_f32 v239, v199, v71
    s_waitcnt lgkmcnt(8)
    v_mfma_f32_16x16x32_bf16 v[28:31], v[96:99], v[212:215], v[28:31]
    v_cvt_pk_bf16_f32 v254, v236, v237
    v_cvt_pk_bf16_f32 v255, v238, v239
    ds_write_b64 v7, v[252:253] offset:1024
    s_waitcnt lgkmcnt(6)
    v_mfma_f32_16x16x32_bf16 v[28:31], v[100:103], v[216:219], v[28:31]
    ds_write_b64 v11, v[254:255] offset:1024
    ds_read_b128 v[140:143], v9 offset:1024
    s_waitcnt lgkmcnt(6)
    s_add_u32 s34, s60, 65536
    buffer_store_dwordx4 v[136:139], v10, s[20:23], s34 offen nt
    s_waitcnt lgkmcnt(5)
    v_mfma_f32_16x16x32_bf16 v[40:43], v[80:83], v[220:223], v[40:43]
    ds_read_b128 v[208:211], v2 offset:36864
    v_mul_f32 v232, v152, v24
    v_mul_f32 v233, v153, v25
    s_waitcnt lgkmcnt(5)
    v_mfma_f32_16x16x32_bf16 v[40:43], v[84:87], v[224:227], v[40:43]
    ds_read_b128 v[212:215], v1 offset:53248
    v_mul_f32 v234, v154, v26
    v_mul_f32 v235, v155, v27
    v_cvt_pk_bf16_f32 v240, v232, v233
    s_waitcnt lgkmcnt(5)
    v_mfma_f32_16x16x32_bf16 v[40:43], v[88:91], v[228:231], v[40:43]
    ds_read_b128 v[216:219], v2 offset:53248
    v_cvt_pk_bf16_f32 v241, v234, v235
    v_mul_f32 v236, v156, v28
    v_mul_f32 v237, v157, v29
    v_mfma_f32_16x16x32_bf16 v[44:47], v[92:95], v[220:223], v[44:47]
    v_mul_f32 v238, v158, v30
    v_mul_f32 v239, v159, v31
    v_mfma_f32_16x16x32_bf16 v[44:47], v[96:99], v[224:227], v[44:47]
    v_cvt_pk_bf16_f32 v242, v236, v237
    v_cvt_pk_bf16_f32 v243, v238, v239
    ds_write_b64 v7, v[240:241] offset:0
    v_mfma_f32_16x16x32_bf16 v[44:47], v[100:103], v[228:231], v[44:47]
    ds_write_b64 v11, v[242:243] offset:0
    ds_read_b128 v[136:139], v9 offset:0
    s_waitcnt lgkmcnt(6)
    s_add_u32 s34, s60, 98304
    buffer_store_dwordx4 v[140:143], v10, s[20:23], s34 offen nt
    s_waitcnt lgkmcnt(5)
    v_mfma_f32_16x16x32_bf16 v[56:59], v[80:83], v[208:211], v[56:59]
    ds_read_b128 v[220:223], v2 offset:38912
    v_mul_f32 v232, v168, v40
    v_mul_f32 v233, v169, v41
    s_waitcnt lgkmcnt(5)
    v_mfma_f32_16x16x32_bf16 v[56:59], v[84:87], v[212:215], v[56:59]
    ds_read_b128 v[224:227], v1 offset:55296
    v_mul_f32 v234, v170, v42
    v_mul_f32 v235, v171, v43
    v_cvt_pk_bf16_f32 v244, v232, v233
    s_waitcnt lgkmcnt(5)
    v_mfma_f32_16x16x32_bf16 v[56:59], v[88:91], v[216:219], v[56:59]
    ds_read_b128 v[228:231], v2 offset:55296
    v_cvt_pk_bf16_f32 v245, v234, v235
    v_mul_f32 v236, v172, v44
    v_mul_f32 v237, v173, v45
    v_mfma_f32_16x16x32_bf16 v[60:63], v[92:95], v[208:211], v[60:63]
    v_mul_f32 v238, v174, v46
    v_mul_f32 v239, v175, v47
    v_mfma_f32_16x16x32_bf16 v[60:63], v[96:99], v[212:215], v[60:63]
    v_cvt_pk_bf16_f32 v246, v236, v237
    v_cvt_pk_bf16_f32 v247, v238, v239
    ds_write_b64 v7, v[244:245] offset:1024
    v_mfma_f32_16x16x32_bf16 v[60:63], v[100:103], v[216:219], v[60:63]
    ds_write_b64 v11, v[246:247] offset:1024
    ds_read_b128 v[140:143], v9 offset:1024
    s_waitcnt lgkmcnt(6)
    s_add_u32 s34, s60, 64
    buffer_store_dwordx4 v[136:139], v10, s[20:23], s34 offen nt
    s_waitcnt lgkmcnt(5)
    v_mfma_f32_16x16x32_bf16 v[72:75], v[80:83], v[220:223], v[72:75]
    v_mul_f32 v232, v184, v56
    v_mul_f32 v233, v185, v57
    s_waitcnt lgkmcnt(4)
    v_mfma_f32_16x16x32_bf16 v[72:75], v[84:87], v[224:227], v[72:75]
    v_mul_f32 v234, v186, v58
    v_mul_f32 v235, v187, v59
    v_cvt_pk_bf16_f32 v248, v232, v233
    s_waitcnt lgkmcnt(3)
    v_mfma_f32_16x16x32_bf16 v[72:75], v[88:91], v[228:231], v[72:75]
    v_cvt_pk_bf16_f32 v249, v234, v235
    v_mul_f32 v236, v188, v60
    v_mul_f32 v237, v189, v61
    v_mfma_f32_16x16x32_bf16 v[76:79], v[92:95], v[220:223], v[76:79]
    v_mul_f32 v238, v190, v62
    v_mul_f32 v239, v191, v63
    v_mfma_f32_16x16x32_bf16 v[76:79], v[96:99], v[224:227], v[76:79]
    v_cvt_pk_bf16_f32 v250, v236, v237
    v_cvt_pk_bf16_f32 v251, v238, v239
    ds_write_b64 v7, v[248:249] offset:0
    v_mfma_f32_16x16x32_bf16 v[76:79], v[100:103], v[228:231], v[76:79]
    ds_write_b64 v11, v[250:251] offset:0
    ds_read_b128 v[136:139], v9 offset:0
    s_waitcnt lgkmcnt(3)
    s_add_u32 s34, s60, 32832
    buffer_store_dwordx4 v[140:143], v10, s[20:23], s34 offen nt
    v_mul_f32 v232, v200, v72
    v_mul_f32 v233, v201, v73
    v_mul_f32 v234, v202, v74
    v_mul_f32 v235, v203, v75
    v_cvt_pk_bf16_f32 v252, v232, v233
    v_cvt_pk_bf16_f32 v253, v234, v235
    v_mul_f32 v236, v204, v76
    v_mul_f32 v237, v205, v77
    v_mul_f32 v238, v206, v78
    v_mul_f32 v239, v207, v79
    v_cvt_pk_bf16_f32 v254, v236, v237
    v_cvt_pk_bf16_f32 v255, v238, v239
    ds_write_b64 v7, v[252:253] offset:1024
    ds_write_b64 v11, v[254:255] offset:1024
    ds_read_b128 v[140:143], v9 offset:1024
    s_waitcnt lgkmcnt(3)
    s_add_u32 s34, s60, 65600
    buffer_store_dwordx4 v[136:139], v10, s[20:23], s34 offen nt
    s_waitcnt lgkmcnt(0)
    s_add_u32 s34, s60, 98368
    buffer_store_dwordx4 v[140:143], v10, s[20:23], s34 offen nt
    s_endpgm
L_loader:
    s_sub_u32 s30, s3, 4
    v_and_b32 v0, 63, v0
    v_lshrrev_b32 v14, 3, v0
    v_and_b32 v15, 7, v0
    v_lshrrev_b32 v16, 4, v0
    v_xor_b32 v17, v15, v16
    v_lshlrev_b32 v17, 4, v17
    v_lshlrev_b32 v18, 11, v14
    v_add_u32 v1, v17, v18
    v_xor_b32 v17, 64, v1
    v_add_u32 v2, 15360, v17
    v_add_u32 v3, 30720, v1
    v_add_u32 v4, 46080, v17
    v_bfe_u32 v17, v0, 1, 3
    v_xor_b32 v17, v17, v16
    v_lshlrev_b32 v17, 5, v17
    v_and_b32 v18, 1, v0
    v_lshlrev_b32 v18, 4, v18
    v_add_u32 v17, v17, v18
    v_lshlrev_b32 v18, 11, v16
    v_add_u32 v6, v17, v18
    v_xor_b32 v17, 128, v6
    v_add_u32 v7, 15360, v17
    v_add_u32 v8, 30720, v6
    v_add_u32 v9, 46080, v17
    s_lshl_b32 s48, s28, 18
    s_lshl_b32 s34, s30, 16
    s_add_u32 s48, s48, s34
    s_lshl_b32 s53, s30, 12
    s_lshr_b32 s34, s30, 1
    s_lshl_b32 s34, s34, 5
    s_and_b32 s35, s30, 1
    s_lshl_b32 s35, s35, 2
    s_add_u32 s34, s34, s35
    s_lshl_b32 s51, s34, 11
    s_lshl_b32 s35, s29, 8
    s_add_u32 s51, s51, s35
    s_waitcnt lgkmcnt(0)
    s_mov_b32 s8, s4
    s_mov_b32 s9, s5
    s_mov_b32 s10, 8388608
    s_mov_b32 s11, 0x00020000
    s_mov_b32 s12, s6
    s_mov_b32 s13, s7
    s_mov_b32 s14, 6291456
    s_mov_b32 s15, 0x00020000
    s_lshl_b32 s54, s29, 1
    s_add_u32 s54, s54, 0
    s_and_b32 s54, s54, 15
    s_lshl_b32 s55, s54, 7
    s_add_u32 s55, s55, s48
    s_add_u32 m0, s53, 0
    s_nop 0
    buffer_load_dwordx4 v1, s[8:11], s55 offen offset:0  lds
    buffer_load_dwordx4 v2, s[8:11], s55 offen offset:1024  lds
    buffer_load_dwordx4 v3, s[8:11], s55 offen offset:2048  lds
    buffer_load_dwordx4 v4, s[8:11], s55 offen offset:3072  lds
    s_lshl_b32 s54, s29, 1
    s_add_u32 s54, s54, 0
    s_and_b32 s54, s54, 15
    s_lshl_b32 s56, s54, 17
    s_add_u32 s56, s56, s51
    s_add_u32 m0, s53, 65536
    s_nop 0
    buffer_load_dwordx4 v6, s[12:15], s56 offen offset:0  lds
    buffer_load_dwordx4 v7, s[12:15], s56 offen offset:1024  lds
    buffer_load_dwordx4 v8, s[12:15], s56 offen offset:2048  lds
    buffer_load_dwordx4 v9, s[12:15], s56 offen offset:3072  lds
    s_lshl_b32 s34, s2, 13
    s_lshl_b32 s35, s30, 11
    s_add_u32 s34, s34, s35
    v_lshlrev_b32 v5, 4, v0
    s_mov_b32 m0, 132096
    s_nop 0
    buffer_load_dwordx4 v5, s[12:15], s34 offen lds
    s_add_u32 s34, s34, 1024
    buffer_load_dwordx4 v5, s[12:15], s34 offen lds
    s_mov_b32 s16, s40
    s_mov_b32 s17, s41
    s_mov_b32 s18, 18874368
    s_mov_b32 s19, 0x00020000
    s_mov_b32 s24, s44
    s_mov_b32 s25, s45
    s_mov_b32 s26, 6144
    s_mov_b32 s27, 0x00020000
    s_mov_b32 s20, s42
    s_mov_b32 s21, s43
    s_mov_b32 s22, 8388608
    s_mov_b32 s23, 0x00020000
    s_min_u32 s34, s30, 2
    s_lshl_b32 s35, s34, 8
    s_add_u32 m0, s35, 131072
    s_lshl_b32 s35, s34, 11
    s_lshl_b32 s36, s29, 8
    s_add_u32 s35, s35, s36
    v_lshlrev_b32 v14, 2, v0
    buffer_load_dword v14, s[24:27], s35 offen lds
    s_lshl_b32 s54, s29, 1
    s_add_u32 s54, s54, 1
    s_and_b32 s54, s54, 15
    s_lshl_b32 s55, s54, 7
    s_add_u32 s55, s55, s48
    s_add_u32 m0, s53, 16384
    s_nop 0
    buffer_load_dwordx4 v1, s[8:11], s55 offen offset:0  lds
    buffer_load_dwordx4 v2, s[8:11], s55 offen offset:1024  lds
    buffer_load_dwordx4 v3, s[8:11], s55 offen offset:2048  lds
    buffer_load_dwordx4 v4, s[8:11], s55 offen offset:3072  lds
    s_lshl_b32 s54, s29, 1
    s_add_u32 s54, s54, 1
    s_and_b32 s54, s54, 15
    s_lshl_b32 s56, s54, 17
    s_add_u32 s56, s56, s51
    s_add_u32 m0, s53, 81920
    s_nop 0
    buffer_load_dwordx4 v6, s[12:15], s56 offen offset:0  lds
    buffer_load_dwordx4 v7, s[12:15], s56 offen offset:1024  lds
    buffer_load_dwordx4 v8, s[12:15], s56 offen offset:2048  lds
    buffer_load_dwordx4 v9, s[12:15], s56 offen offset:3072  lds
    v_lshlrev_b32 v5, 4, v0
    v_xor_b32 v17, 128, v6
    v_mov_b32 v10, v6
    v_add_u32 v11, 7168, v17
    v_add_u32 v12, 14336, v6
    v_add_u32 v13, 21504, v17
    s_lshl_b32 s49, s28, 18
    s_add_u32 s49, s49, s53
    s_lshl_b32 s52, s30, 15
    s_lshl_b32 s35, s29, 8
    s_add_u32 s52, s52, s35
    s_lshr_b32 s34, s28, 3
    s_lshl_b32 s34, s34, 2
    s_lshr_b32 s72, 51264, s34
    s_and_b32 s72, s72, 15
    s_lshl_b32 s34, s28, 8
    s_add_u32 s34, s34, 16777216
    v_and_b32 v15, 31, v0
    v_lshlrev_b32 v15, 2, v15
    v_add_u32 v15, s34, v15
    s_mov_b32 s98, 0
    s_mov_b32 s99, 0
    s_lshl_b32 s54, s29, 1
    s_add_u32 s54, s54, 0
    s_and_b32 s54, s54, 15
    s_lshl_b32 s54, s54, 0
    s_or_b32 s98, s98, s54
    s_lshl_b32 s54, s29, 1
    s_add_u32 s54, s54, 1
    s_and_b32 s54, s54, 15
    s_lshl_b32 s54, s54, 4
    s_or_b32 s98, s98, s54
    s_add_u32 s54, s72, 0
    s_cmp_ge_u32 s54, 14
    s_cselect_b32 s39, 14, 0
    s_sub_u32 s54, s54, s39
    s_lshl_b32 s39, s29, 1
    s_add_u32 s54, s54, s39
    s_add_u32 s54, s54, 2
    s_and_b32 s54, s54, 15
    s_lshl_b32 s54, s54, 8
    s_or_b32 s98, s98, s54
    s_add_u32 s54, s72, 1
    s_cmp_ge_u32 s54, 14
    s_cselect_b32 s39, 14, 0
    s_sub_u32 s54, s54, s39
    s_lshl_b32 s39, s29, 1
    s_add_u32 s54, s54, s39
    s_add_u32 s54, s54, 2
    s_and_b32 s54, s54, 15
    s_lshl_b32 s54, s54, 12
    s_or_b32 s98, s98, s54
    s_add_u32 s54, s72, 2
    s_cmp_ge_u32 s54, 14
    s_cselect_b32 s39, 14, 0
    s_sub_u32 s54, s54, s39
    s_lshl_b32 s39, s29, 1
    s_add_u32 s54, s54, s39
    s_add_u32 s54, s54, 2
    s_and_b32 s54, s54, 15
    s_lshl_b32 s54, s54, 16
    s_or_b32 s98, s98, s54
    s_add_u32 s54, s72, 3
    s_cmp_ge_u32 s54, 14
    s_cselect_b32 s39, 14, 0
    s_sub_u32 s54, s54, s39
    s_lshl_b32 s39, s29, 1
    s_add_u32 s54, s54, s39
    s_add_u32 s54, s54, 2
    s_and_b32 s54, s54, 15
    s_lshl_b32 s54, s54, 20
    s_or_b32 s98, s98, s54
    s_add_u32 s54, s72, 4
    s_cmp_ge_u32 s54, 14
    s_cselect_b32 s39, 14, 0
    s_sub_u32 s54, s54, s39
    s_lshl_b32 s39, s29, 1
    s_add_u32 s54, s54, s39
    s_add_u32 s54, s54, 2
    s_and_b32 s54, s54, 15
    s_lshl_b32 s54, s54, 24
    s_or_b32 s98, s98, s54
    s_add_u32 s54, s72, 5
    s_cmp_ge_u32 s54, 14
    s_cselect_b32 s39, 14, 0
    s_sub_u32 s54, s54, s39
    s_lshl_b32 s39, s29, 1
    s_add_u32 s54, s54, s39
    s_add_u32 s54, s54, 2
    s_and_b32 s54, s54, 15
    s_lshl_b32 s54, s54, 28
    s_or_b32 s98, s98, s54
    s_add_u32 s54, s72, 6
    s_cmp_ge_u32 s54, 14
    s_cselect_b32 s39, 14, 0
    s_sub_u32 s54, s54, s39
    s_lshl_b32 s39, s29, 1
    s_add_u32 s54, s54, s39
    s_add_u32 s54, s54, 2
    s_and_b32 s54, s54, 15
    s_lshl_b32 s54, s54, 0
    s_or_b32 s99, s99, s54
    s_add_u32 s54, s72, 7
    s_cmp_ge_u32 s54, 14
    s_cselect_b32 s39, 14, 0
    s_sub_u32 s54, s54, s39
    s_lshl_b32 s39, s29, 1
    s_add_u32 s54, s54, s39
    s_add_u32 s54, s54, 2
    s_and_b32 s54, s54, 15
    s_lshl_b32 s54, s54, 4
    s_or_b32 s99, s99, s54
    s_add_u32 s54, s72, 8
    s_cmp_ge_u32 s54, 14
    s_cselect_b32 s39, 14, 0
    s_sub_u32 s54, s54, s39
    s_lshl_b32 s39, s29, 1
    s_add_u32 s54, s54, s39
    s_add_u32 s54, s54, 2
    s_and_b32 s54, s54, 15
    s_lshl_b32 s54, s54, 8
    s_or_b32 s99, s99, s54
    s_add_u32 s54, s72, 9
    s_cmp_ge_u32 s54, 14
    s_cselect_b32 s39, 14, 0
    s_sub_u32 s54, s54, s39
    s_lshl_b32 s39, s29, 1
    s_add_u32 s54, s54, s39
    s_add_u32 s54, s54, 2
    s_and_b32 s54, s54, 15
    s_lshl_b32 s54, s54, 12
    s_or_b32 s99, s99, s54
    s_add_u32 s54, s72, 10
    s_cmp_ge_u32 s54, 14
    s_cselect_b32 s39, 14, 0
    s_sub_u32 s54, s54, s39
    s_lshl_b32 s39, s29, 1
    s_add_u32 s54, s54, s39
    s_add_u32 s54, s54, 2
    s_and_b32 s54, s54, 15
    s_lshl_b32 s54, s54, 16
    s_or_b32 s99, s99, s54
    s_add_u32 s54, s72, 11
    s_cmp_ge_u32 s54, 14
    s_cselect_b32 s39, 14, 0
    s_sub_u32 s54, s54, s39
    s_lshl_b32 s39, s29, 1
    s_add_u32 s54, s54, s39
    s_add_u32 s54, s54, 2
    s_and_b32 s54, s54, 15
    s_lshl_b32 s54, s54, 20
    s_or_b32 s99, s99, s54
    s_add_u32 s54, s72, 12
    s_cmp_ge_u32 s54, 14
    s_cselect_b32 s39, 14, 0
    s_sub_u32 s54, s54, s39
    s_lshl_b32 s39, s29, 1
    s_add_u32 s54, s54, s39
    s_add_u32 s54, s54, 2
    s_and_b32 s54, s54, 15
    s_lshl_b32 s54, s54, 24
    s_or_b32 s99, s99, s54
    s_add_u32 s54, s72, 13
    s_cmp_ge_u32 s54, 14
    s_cselect_b32 s39, 14, 0
    s_sub_u32 s54, s54, s39
    s_lshl_b32 s39, s29, 1
    s_add_u32 s54, s54, s39
    s_add_u32 s54, s54, 2
    s_and_b32 s54, s54, 15
    s_lshl_b32 s54, s54, 28
    s_or_b32 s99, s99, s54
    s_bfe_u32 s38, s98, 131081
    s_cmp_eq_u32 s38, 1
    s_cselect_b32 s38, 0xff, 0
    s_lshr_b32 s39, s98, 16
    s_xor_b32 s39, s39, s98
    s_lshr_b32 s39, s39, 8
    s_and_b32 s39, s39, s38
    s_lshl_b32 s38, s39, 8
    s_xor_b32 s98, s98, s38
    s_lshl_b32 s38, s39, 24
    s_xor_b32 s98, s98, s38
    s_waitcnt vmcnt(8)
    s_barrier
    s_bfe_u32 s54, s98, 262152
    s_lshl_b32 s56, s54, 17
    s_add_u32 s56, s56, s51
    s_add_u32 m0, s53, 98304
    s_nop 0
    buffer_load_dwordx4 v6, s[12:15], s56 offen offset:0  lds
    buffer_load_dwordx4 v7, s[12:15], s56 offen offset:1024  lds
    buffer_load_dwordx4 v8, s[12:15], s56 offen offset:2048  lds
    buffer_load_dwordx4 v9, s[12:15], s56 offen offset:3072  lds
    s_bfe_u32 s54, s98, 262152
    s_lshl_b32 s55, s54, 7
    s_add_u32 s55, s55, s48
    s_add_u32 m0, s53, 32768
    s_nop 0
    buffer_load_dwordx4 v1, s[8:11], s55 offen offset:0  lds
    buffer_load_dwordx4 v2, s[8:11], s55 offen offset:1024  lds
    buffer_load_dwordx4 v3, s[8:11], s55 offen offset:2048  lds
    buffer_load_dwordx4 v4, s[8:11], s55 offen offset:3072  lds
    s_bfe_u32 s54, s98, 262156
    s_lshl_b32 s56, s54, 17
    s_add_u32 s56, s56, s51
    s_lshl_b32 s55, s54, 7
    s_add_u32 s55, s55, s48
    s_waitcnt vmcnt(8)
    s_barrier
    s_add_u32 m0, s53, 114688
    s_nop 0
    buffer_load_dwordx4 v6, s[12:15], s56 offen offset:0  lds
    s_lshl_b32 s34, s28, 7
    s_add_u32 s34, s34, 16842752
    s_load_dword s32, s[40:41], s34
    s_bfe_u32 s54, s98, 262160
    s_lshl_b32 s78, s54, 17
    s_add_u32 s78, s78, s51
    s_lshl_b32 s100, s54, 7
    s_add_u32 s100, s100, s48
    buffer_load_dwordx4 v7, s[12:15], s56 offen offset:1024  lds
    buffer_load_dwordx4 v8, s[12:15], s56 offen offset:2048  lds
    buffer_load_dwordx4 v9, s[12:15], s56 offen offset:3072  lds
    s_add_u32 m0, s53, 49152
    s_nop 0
    buffer_load_dwordx4 v1, s[8:11], s55 offen offset:0  lds
    buffer_load_dwordx4 v2, s[8:11], s55 offen offset:1024  lds
    buffer_load_dwordx4 v3, s[8:11], s55 offen offset:2048  lds
    buffer_load_dwordx4 v4, s[8:11], s55 offen offset:3072  lds
    s_waitcnt vmcnt(8)
    s_barrier
    s_add_u32 m0, s53, 65536
    s_nop 0
    buffer_load_dwordx4 v6, s[12:15], s78 offen offset:0  lds
    s_bfe_u32 s54, s98, 262164
    s_lshl_b32 s56, s54, 17
    s_add_u32 s56, s56, s51
    s_lshl_b32 s55, s54, 7
    s_add_u32 s55, s55, s48
    buffer_load_dwordx4 v7, s[12:15], s78 offen offset:1024  lds
    buffer_load_dwordx4 v8, s[12:15], s78 offen offset:2048  lds
    buffer_load_dwordx4 v9, s[12:15], s78 offen offset:3072  lds
    s_add_u32 m0, s53, 0
    s_nop 0
    buffer_load_dwordx4 v1, s[8:11], s100 offen offset:0  lds
    buffer_load_dwordx4 v2, s[8:11], s100 offen offset:1024  lds
    buffer_load_dwordx4 v3, s[8:11], s100 offen offset:2048  lds
    buffer_load_dwordx4 v4, s[8:11], s100 offen offset:3072  lds
    s_waitcnt vmcnt(8)
    s_barrier
    s_add_u32 m0, s53, 81920
    s_nop 0
    buffer_load_dwordx4 v6, s[12:15], s56 offen offset:0  lds
    s_bfe_u32 s54, s98, 262168
    s_lshl_b32 s78, s54, 17
    s_add_u32 s78, s78, s51
    s_lshl_b32 s100, s54, 7
    s_add_u32 s100, s100, s48
    buffer_load_dwordx4 v7, s[12:15], s56 offen offset:1024  lds
    buffer_load_dwordx4 v8, s[12:15], s56 offen offset:2048  lds
    buffer_load_dwordx4 v9, s[12:15], s56 offen offset:3072  lds
    s_add_u32 m0, s53, 16384
    s_nop 0
    buffer_load_dwordx4 v1, s[8:11], s55 offen offset:0  lds
    buffer_load_dwordx4 v2, s[8:11], s55 offen offset:1024  lds
    buffer_load_dwordx4 v3, s[8:11], s55 offen offset:2048  lds
    buffer_load_dwordx4 v4, s[8:11], s55 offen offset:3072  lds
    s_waitcnt vmcnt(8)
    s_barrier
    s_add_u32 m0, s53, 98304
    s_nop 0
    buffer_load_dwordx4 v6, s[12:15], s78 offen offset:0  lds
    s_bfe_u32 s54, s98, 262172
    s_lshl_b32 s56, s54, 17
    s_add_u32 s56, s56, s51
    s_lshl_b32 s55, s54, 7
    s_add_u32 s55, s55, s48
    buffer_load_dwordx4 v7, s[12:15], s78 offen offset:1024  lds
    buffer_load_dwordx4 v8, s[12:15], s78 offen offset:2048  lds
    buffer_load_dwordx4 v9, s[12:15], s78 offen offset:3072  lds
    s_add_u32 m0, s53, 32768
    s_nop 0
    buffer_load_dwordx4 v1, s[8:11], s100 offen offset:0  lds
    buffer_load_dwordx4 v2, s[8:11], s100 offen offset:1024  lds
    buffer_load_dwordx4 v3, s[8:11], s100 offen offset:2048  lds
    buffer_load_dwordx4 v4, s[8:11], s100 offen offset:3072  lds
    s_waitcnt vmcnt(8)
    s_barrier
    s_add_u32 m0, s53, 114688
    s_nop 0
    buffer_load_dwordx4 v6, s[12:15], s56 offen offset:0  lds
    s_bfe_u32 s54, s99, 262144
    s_lshl_b32 s78, s54, 17
    s_add_u32 s78, s78, s51
    s_lshl_b32 s100, s54, 7
    s_add_u32 s100, s100, s48
    buffer_load_dwordx4 v7, s[12:15], s56 offen offset:1024  lds
    buffer_load_dwordx4 v8, s[12:15], s56 offen offset:2048  lds
    buffer_load_dwordx4 v9, s[12:15], s56 offen offset:3072  lds
    s_add_u32 m0, s53, 49152
    s_nop 0
    buffer_load_dwordx4 v1, s[8:11], s55 offen offset:0  lds
    buffer_load_dwordx4 v2, s[8:11], s55 offen offset:1024  lds
    buffer_load_dwordx4 v3, s[8:11], s55 offen offset:2048  lds
    buffer_load_dwordx4 v4, s[8:11], s55 offen offset:3072  lds
    s_waitcnt vmcnt(8)
    s_barrier
    s_add_u32 m0, s53, 65536
    s_nop 0
    buffer_load_dwordx4 v6, s[12:15], s78 offen offset:0  lds
    s_bfe_u32 s54, s99, 262148
    s_lshl_b32 s56, s54, 17
    s_add_u32 s56, s56, s51
    s_lshl_b32 s55, s54, 7
    s_add_u32 s55, s55, s48
    buffer_load_dwordx4 v7, s[12:15], s78 offen offset:1024  lds
    buffer_load_dwordx4 v8, s[12:15], s78 offen offset:2048  lds
    buffer_load_dwordx4 v9, s[12:15], s78 offen offset:3072  lds
    s_add_u32 m0, s53, 0
    s_nop 0
    buffer_load_dwordx4 v1, s[8:11], s100 offen offset:0  lds
    buffer_load_dwordx4 v2, s[8:11], s100 offen offset:1024  lds
    buffer_load_dwordx4 v3, s[8:11], s100 offen offset:2048  lds
    buffer_load_dwordx4 v4, s[8:11], s100 offen offset:3072  lds
    s_waitcnt vmcnt(8)
    s_barrier
    s_add_u32 m0, s53, 81920
    s_nop 0
    buffer_load_dwordx4 v6, s[12:15], s56 offen offset:0  lds
    s_bfe_u32 s54, s99, 262152
    s_lshl_b32 s78, s54, 17
    s_add_u32 s78, s78, s51
    s_lshl_b32 s100, s54, 7
    s_add_u32 s100, s100, s48
    buffer_load_dwordx4 v7, s[12:15], s56 offen offset:1024  lds
    buffer_load_dwordx4 v8, s[12:15], s56 offen offset:2048  lds
    buffer_load_dwordx4 v9, s[12:15], s56 offen offset:3072  lds
    s_add_u32 m0, s53, 16384
    s_nop 0
    buffer_load_dwordx4 v1, s[8:11], s55 offen offset:0  lds
    buffer_load_dwordx4 v2, s[8:11], s55 offen offset:1024  lds
    buffer_load_dwordx4 v3, s[8:11], s55 offen offset:2048  lds
    buffer_load_dwordx4 v4, s[8:11], s55 offen offset:3072  lds
    s_waitcnt vmcnt(8)
    s_barrier
    s_add_u32 m0, s53, 98304
    s_nop 0
    buffer_load_dwordx4 v6, s[12:15], s78 offen offset:0  lds
    s_bfe_u32 s54, s99, 262156
    s_lshl_b32 s56, s54, 17
    s_add_u32 s56, s56, s51
    s_lshl_b32 s55, s54, 7
    s_add_u32 s55, s55, s48
    buffer_load_dwordx4 v7, s[12:15], s78 offen offset:1024  lds
    buffer_load_dwordx4 v8, s[12:15], s78 offen offset:2048  lds
    buffer_load_dwordx4 v9, s[12:15], s78 offen offset:3072  lds
    s_add_u32 m0, s53, 32768
    s_nop 0
    buffer_load_dwordx4 v1, s[8:11], s100 offen offset:0  lds
    buffer_load_dwordx4 v2, s[8:11], s100 offen offset:1024  lds
    buffer_load_dwordx4 v3, s[8:11], s100 offen offset:2048  lds
    buffer_load_dwordx4 v4, s[8:11], s100 offen offset:3072  lds
    s_waitcnt vmcnt(8)
    s_barrier
    s_add_u32 m0, s53, 114688
    s_nop 0
    buffer_load_dwordx4 v6, s[12:15], s56 offen offset:0  lds
    s_bfe_u32 s54, s99, 262160
    s_lshl_b32 s78, s54, 17
    s_add_u32 s78, s78, s51
    s_lshl_b32 s100, s54, 7
    s_add_u32 s100, s100, s48
    buffer_load_dwordx4 v7, s[12:15], s56 offen offset:1024  lds
    buffer_load_dwordx4 v8, s[12:15], s56 offen offset:2048  lds
    buffer_load_dwordx4 v9, s[12:15], s56 offen offset:3072  lds
    s_add_u32 m0, s53, 49152
    s_nop 0
    buffer_load_dwordx4 v1, s[8:11], s55 offen offset:0  lds
    buffer_load_dwordx4 v2, s[8:11], s55 offen offset:1024  lds
    buffer_load_dwordx4 v3, s[8:11], s55 offen offset:2048  lds
    buffer_load_dwordx4 v4, s[8:11], s55 offen offset:3072  lds
    s_waitcnt vmcnt(8)
    s_barrier
    s_add_u32 m0, s53, 65536
    s_nop 0
    buffer_load_dwordx4 v6, s[12:15], s78 offen offset:0  lds
    s_bfe_u32 s54, s99, 262164
    s_lshl_b32 s56, s54, 17
    s_add_u32 s56, s56, s51
    s_lshl_b32 s55, s54, 7
    s_add_u32 s55, s55, s48
    buffer_load_dwordx4 v7, s[12:15], s78 offen offset:1024  lds
    buffer_load_dwordx4 v8, s[12:15], s78 offen offset:2048  lds
    buffer_load_dwordx4 v9, s[12:15], s78 offen offset:3072  lds
    s_add_u32 m0, s53, 0
    s_nop 0
    buffer_load_dwordx4 v1, s[8:11], s100 offen offset:0  lds
    buffer_load_dwordx4 v2, s[8:11], s100 offen offset:1024  lds
    buffer_load_dwordx4 v3, s[8:11], s100 offen offset:2048  lds
    buffer_load_dwordx4 v4, s[8:11], s100 offen offset:3072  lds
    s_waitcnt vmcnt(8)
    s_barrier
    s_add_u32 m0, s53, 81920
    s_nop 0
    buffer_load_dwordx4 v6, s[12:15], s56 offen offset:0  lds
    s_bfe_u32 s54, s99, 262168
    s_lshl_b32 s78, s54, 17
    s_add_u32 s78, s78, s51
    s_lshl_b32 s100, s54, 7
    s_add_u32 s100, s100, s48
    buffer_load_dwordx4 v7, s[12:15], s56 offen offset:1024  lds
    buffer_load_dwordx4 v8, s[12:15], s56 offen offset:2048  lds
    buffer_load_dwordx4 v9, s[12:15], s56 offen offset:3072  lds
    s_add_u32 m0, s53, 16384
    s_nop 0
    buffer_load_dwordx4 v1, s[8:11], s55 offen offset:0  lds
    buffer_load_dwordx4 v2, s[8:11], s55 offen offset:1024  lds
    buffer_load_dwordx4 v3, s[8:11], s55 offen offset:2048  lds
    buffer_load_dwordx4 v4, s[8:11], s55 offen offset:3072  lds
    s_waitcnt vmcnt(8)
    s_barrier
    s_add_u32 m0, s53, 98304
    s_nop 0
    buffer_load_dwordx4 v6, s[12:15], s78 offen offset:0  lds
    s_bfe_u32 s54, s99, 262172
    s_lshl_b32 s56, s54, 17
    s_add_u32 s56, s56, s51
    s_lshl_b32 s55, s54, 7
    s_add_u32 s55, s55, s48
    buffer_load_dwordx4 v7, s[12:15], s78 offen offset:1024  lds
    buffer_load_dwordx4 v8, s[12:15], s78 offen offset:2048  lds
    buffer_load_dwordx4 v9, s[12:15], s78 offen offset:3072  lds
    s_add_u32 m0, s53, 32768
    s_nop 0
    buffer_load_dwordx4 v1, s[8:11], s100 offen offset:0  lds
    buffer_load_dwordx4 v2, s[8:11], s100 offen offset:1024  lds
    buffer_load_dwordx4 v3, s[8:11], s100 offen offset:2048  lds
    buffer_load_dwordx4 v4, s[8:11], s100 offen offset:3072  lds
    s_waitcnt vmcnt(8)
    s_barrier
    s_add_u32 m0, s53, 114688
    s_nop 0
    buffer_load_dwordx4 v6, s[12:15], s56 offen offset:0  lds
    s_waitcnt lgkmcnt(0)
    s_add_u32 s32, s32, 1779033703
    s_bfe_u32 s54, s98, 262144
    s_add_u32 s79, s52, 2097152
    s_lshl_b32 s78, s54, 17
    s_add_u32 s78, s78, s79
    s_bfe_u32 s54, s98, 262148
    s_lshl_b32 s50, s54, 17
    s_add_u32 s50, s50, s79
    buffer_load_dwordx4 v7, s[12:15], s56 offen offset:1024  lds
    buffer_load_dwordx4 v8, s[12:15], s56 offen offset:2048  lds
    buffer_load_dwordx4 v9, s[12:15], s56 offen offset:3072  lds
    s_add_u32 m0, s53, 49152
    s_nop 0
    buffer_load_dwordx4 v1, s[8:11], s55 offen offset:0  lds
    buffer_load_dwordx4 v2, s[8:11], s55 offen offset:1024  lds
    buffer_load_dwordx4 v3, s[8:11], s55 offen offset:2048  lds
    buffer_load_dwordx4 v4, s[8:11], s55 offen offset:3072  lds
    s_waitcnt vmcnt(8)
    s_barrier
    s_add_u32 m0, s53, 65536
    s_nop 0
    buffer_load_dwordx4 v10, s[12:15], s78 offen offset:0  lds
    s_bfe_u32 s54, s98, 262152
    s_lshl_b32 s56, s54, 17
    s_add_u32 s56, s56, s79
    buffer_load_dwordx4 v11, s[12:15], s78 offen offset:1024  lds
    buffer_load_dwordx4 v12, s[12:15], s78 offen offset:2048  lds
    buffer_load_dwordx4 v13, s[12:15], s78 offen offset:3072  lds
    s_add_u32 m0, s53, 81920
    s_nop 0
    buffer_load_dwordx4 v10, s[12:15], s50 offen offset:0  lds
    buffer_load_dwordx4 v11, s[12:15], s50 offen offset:1024  lds
    buffer_load_dwordx4 v12, s[12:15], s50 offen offset:2048  lds
    buffer_load_dwordx4 v13, s[12:15], s50 offen offset:3072  lds
    s_waitcnt vmcnt(8)
    s_barrier
    s_add_u32 m0, s53, 98304
    s_nop 0
    buffer_load_dwordx4 v10, s[12:15], s56 offen offset:0  lds
    s_bfe_u32 s54, s98, 262156
    s_lshl_b32 s78, s54, 17
    s_add_u32 s78, s78, s79
    buffer_load_dwordx4 v11, s[12:15], s56 offen offset:1024  lds
    buffer_load_dwordx4 v12, s[12:15], s56 offen offset:2048  lds
    buffer_load_dwordx4 v13, s[12:15], s56 offen offset:3072  lds
    s_waitcnt vmcnt(8)
    s_barrier
    s_add_u32 m0, s53, 114688
    s_nop 0
    buffer_load_dwordx4 v10, s[12:15], s78 offen offset:0  lds
    buffer_load_dwordx4 v11, s[12:15], s78 offen offset:1024  lds
    buffer_load_dwordx4 v12, s[12:15], s78 offen offset:2048  lds
    buffer_load_dwordx4 v13, s[12:15], s78 offen offset:3072  lds
    s_waitcnt vmcnt(8)
    s_barrier
    s_lshl_b32 s70, s29, 2
    s_lshl_b32 s70, 15, s70
    s_add_u32 s58, s49, 0
    s_bfe_u32 s54, s98, 262156
    s_lshr_b32 s76, s54, 1
    s_lshl_b32 s76, s76, 2
    s_and_b32 s39, s54, 1
    s_add_u32 s76, s76, s39
    s_lshl_b32 s76, 5, s76
    s_bfe_u32 s54, s98, 262152
    s_lshr_b32 s71, s54, 1
    s_lshl_b32 s71, s71, 2
    s_and_b32 s39, s54, 1
    s_add_u32 s71, s71, s39
    s_lshl_b32 s71, 5, s71
    s_or_b32 s71, s71, s76
    s_and_b32 s39, s70, s71
    s_cmp_eq_u32 s39, s71
    s_cbranch_scc1 L_ok18
    s_mov_b32 s57, 0
L_poll18:
    s_cmp_ge_u32 s57, 12
    s_cselect_b32 s39, 1, 0
    s_and_b32 s39, s39, s57
    s_mul_i32 s73, s39, 32768
    buffer_load_dword v16, v15, s[16:19], s73 offen offset:0 sc1
    s_waitcnt vmcnt(0)
    v_cmp_eq_u32 vcc, s32, v16
    s_nop 1
    s_or_b32 s70, s70, vcc_lo
    s_and_b32 s39, s70, s71
    s_cmp_eq_u32 s39, s71
    s_cbranch_scc1 L_ok18
    s_add_u32 s57, s57, 1
    s_cmp_lg_u32 s57, 20000
    s_cbranch_scc1 L_poll18
L_ok18:
    s_bfe_u32 s54, s98, 262152
    s_lshl_b32 s55, s54, 14
    s_add_u32 s55, s55, s58
    s_add_u32 m0, s53, 32768
    s_nop 0
    buffer_load_dwordx4 v5, s[16:19], s55 offen offset:0 sc1 lds
    buffer_load_dwordx4 v5, s[16:19], s55 offen offset:1024 sc1 lds
    buffer_load_dwordx4 v5, s[16:19], s55 offen offset:2048 sc1 lds
    buffer_load_dwordx4 v5, s[16:19], s55 offen offset:3072 sc1 lds
    buffer_load_dword v19, v15, s[16:19], 0 offen offset:0 sc1
    s_bfe_u32 s54, s98, 262156
    s_lshl_b32 s55, s54, 14
    s_add_u32 s55, s55, s58
    s_add_u32 m0, s53, 49152
    s_nop 0
    buffer_load_dwordx4 v5, s[16:19], s55 offen offset:0 sc1 lds
    buffer_load_dwordx4 v5, s[16:19], s55 offen offset:1024 sc1 lds
    buffer_load_dwordx4 v5, s[16:19], s55 offen offset:2048 sc1 lds
    buffer_load_dwordx4 v5, s[16:19], s55 offen offset:3072 sc1 lds
    s_waitcnt vmcnt(5)
    s_waitcnt vmcnt(4)
    v_cmp_eq_u32 vcc, s32, v19
    s_nop 1
    s_or_b32 s70, s70, vcc_lo
    s_bfe_u32 s54, s98, 262160
    s_lshl_b32 s78, s54, 17
    s_add_u32 s78, s78, s79
    s_cmp_eq_u32 s70, -1
    s_cbranch_scc1 L_ok20
    s_bfe_u32 s54, s98, 262160
    s_lshr_b32 s71, s54, 1
    s_lshl_b32 s71, s71, 2
    s_and_b32 s39, s54, 1
    s_add_u32 s71, s71, s39
    s_lshl_b32 s71, 5, s71
    s_and_b32 s39, s70, s71
    s_cmp_eq_u32 s39, s71
    s_cbranch_scc1 L_ok20
    s_mov_b32 s57, 0
L_poll20:
    s_cmp_ge_u32 s57, 12
    s_cselect_b32 s39, 1, 0
    s_and_b32 s39, s39, s57
    s_mul_i32 s73, s39, 32768
    buffer_load_dword v16, v15, s[16:19], s73 offen offset:0 sc1
    s_waitcnt vmcnt(0)
    v_cmp_eq_u32 vcc, s32, v16
    s_nop 1
    s_or_b32 s70, s70, vcc_lo
    s_and_b32 s39, s70, s71
    s_cmp_eq_u32 s39, s71
    s_cbranch_scc1 L_ok20
    s_add_u32 s57, s57, 1
    s_cmp_lg_u32 s57, 20000
    s_cbranch_scc1 L_poll20
L_ok20:
    s_bfe_u32 s54, s98, 262160
    s_lshl_b32 s100, s54, 14
    s_add_u32 s100, s100, s58
    s_barrier
    buffer_load_dword v19, v15, s[16:19], 0 offen offset:0 sc1
    s_add_u32 m0, s53, 65536
    s_nop 0
    buffer_load_dwordx4 v10, s[12:15], s78 offen offset:0  lds
    buffer_load_dwordx4 v11, s[12:15], s78 offen offset:1024  lds
    buffer_load_dwordx4 v12, s[12:15], s78 offen offset:2048  lds
    buffer_load_dwordx4 v13, s[12:15], s78 offen offset:3072  lds
    s_add_u32 m0, s53, 0
    s_nop 0
    buffer_load_dwordx4 v5, s[16:19], s100 offen offset:0 sc1 lds
    buffer_load_dwordx4 v5, s[16:19], s100 offen offset:1024 sc1 lds
    buffer_load_dwordx4 v5, s[16:19], s100 offen offset:2048 sc1 lds
    buffer_load_dwordx4 v5, s[16:19], s100 offen offset:3072 sc1 lds
    s_waitcnt vmcnt(9)
    s_waitcnt vmcnt(8)
    v_cmp_eq_u32 vcc, s32, v19
    s_nop 1
    s_or_b32 s70, s70, vcc_lo
    s_bfe_u32 s54, s98, 262164
    s_lshl_b32 s56, s54, 17
    s_add_u32 s56, s56, s79
    s_cmp_eq_u32 s70, -1
    s_cbranch_scc1 L_ok21
    s_bfe_u32 s54, s98, 262164
    s_lshr_b32 s71, s54, 1
    s_lshl_b32 s71, s71, 2
    s_and_b32 s39, s54, 1
    s_add_u32 s71, s71, s39
    s_lshl_b32 s71, 5, s71
    s_and_b32 s39, s70, s71
    s_cmp_eq_u32 s39, s71
    s_cbranch_scc1 L_ok21
    s_mov_b32 s57, 0
L_poll21:
    s_cmp_ge_u32 s57, 12
    s_cselect_b32 s39, 1, 0
    s_and_b32 s39, s39, s57
    s_mul_i32 s73, s39, 32768
    buffer_load_dword v16, v15, s[16:19], s73 offen offset:0 sc1
    s_waitcnt vmcnt(0)
    v_cmp_eq_u32 vcc, s32, v16
    s_nop 1
    s_or_b32 s70, s70, vcc_lo
    s_and_b32 s39, s70, s71
    s_cmp_eq_u32 s39, s71
    s_cbranch_scc1 L_ok21
    s_add_u32 s57, s57, 1
    s_cmp_lg_u32 s57, 20000
    s_cbranch_scc1 L_poll21
L_ok21:
    s_bfe_u32 s54, s98, 262164
    s_lshl_b32 s55, s54, 14
    s_add_u32 s55, s55, s58
    s_barrier
    s_add_u32 m0, s53, 81920
    s_nop 0
    buffer_load_dwordx4 v10, s[12:15], s56 offen offset:0  lds
    s_bfe_u32 s54, s98, 262168
    s_lshl_b32 s78, s54, 17
    s_add_u32 s78, s78, s79
    s_cmp_eq_u32 s70, -1
    s_cbranch_scc1 L_ok22
    s_bfe_u32 s54, s98, 262168
    s_lshr_b32 s71, s54, 1
    s_lshl_b32 s71, s71, 2
    s_and_b32 s39, s54, 1
    s_add_u32 s71, s71, s39
    s_lshl_b32 s71, 5, s71
    s_and_b32 s39, s70, s71
    s_cmp_eq_u32 s39, s71
    s_cbranch_scc1 L_ok22
    s_mov_b32 s57, 0
L_poll22:
    s_cmp_ge_u32 s57, 12
    s_cselect_b32 s39, 1, 0
    s_and_b32 s39, s39, s57
    s_mul_i32 s73, s39, 32768
    buffer_load_dword v16, v15, s[16:19], s73 offen offset:0 sc1
    s_waitcnt vmcnt(0)
    v_cmp_eq_u32 vcc, s32, v16
    s_nop 1
    s_or_b32 s70, s70, vcc_lo
    s_and_b32 s39, s70, s71
    s_cmp_eq_u32 s39, s71
    s_cbranch_scc1 L_ok22
    s_add_u32 s57, s57, 1
    s_cmp_lg_u32 s57, 20000
    s_cbranch_scc1 L_poll22
L_ok22:
    s_bfe_u32 s54, s98, 262168
    s_lshl_b32 s100, s54, 14
    s_add_u32 s100, s100, s58
    buffer_load_dwordx4 v11, s[12:15], s56 offen offset:1024  lds
    buffer_load_dwordx4 v12, s[12:15], s56 offen offset:2048  lds
    buffer_load_dwordx4 v13, s[12:15], s56 offen offset:3072  lds
    s_add_u32 m0, s53, 16384
    s_nop 0
    buffer_load_dwordx4 v5, s[16:19], s55 offen offset:0 sc1 lds
    buffer_load_dwordx4 v5, s[16:19], s55 offen offset:1024 sc1 lds
    buffer_load_dwordx4 v5, s[16:19], s55 offen offset:2048 sc1 lds
    buffer_load_dwordx4 v5, s[16:19], s55 offen offset:3072 sc1 lds
    s_waitcnt vmcnt(8)
    s_barrier
    s_add_u32 m0, s53, 98304
    s_nop 0
    buffer_load_dwordx4 v10, s[12:15], s78 offen offset:0  lds
    s_bfe_u32 s54, s98, 262172
    s_lshl_b32 s56, s54, 17
    s_add_u32 s56, s56, s79
    s_cmp_eq_u32 s70, -1
    s_cbranch_scc1 L_ok23
    s_bfe_u32 s54, s98, 262172
    s_lshr_b32 s71, s54, 1
    s_lshl_b32 s71, s71, 2
    s_and_b32 s39, s54, 1
    s_add_u32 s71, s71, s39
    s_lshl_b32 s71, 5, s71
    s_and_b32 s39, s70, s71
    s_cmp_eq_u32 s39, s71
    s_cbranch_scc1 L_ok23
    s_mov_b32 s57, 0
L_poll23:
    s_cmp_ge_u32 s57, 12
    s_cselect_b32 s39, 1, 0
    s_and_b32 s39, s39, s57
    s_mul_i32 s73, s39, 32768
    buffer_load_dword v16, v15, s[16:19], s73 offen offset:0 sc1
    s_waitcnt vmcnt(0)
    v_cmp_eq_u32 vcc, s32, v16
    s_nop 1
    s_or_b32 s70, s70, vcc_lo
    s_and_b32 s39, s70, s71
    s_cmp_eq_u32 s39, s71
    s_cbranch_scc1 L_ok23
    s_add_u32 s57, s57, 1
    s_cmp_lg_u32 s57, 20000
    s_cbranch_scc1 L_poll23
L_ok23:
    s_bfe_u32 s54, s98, 262172
    s_lshl_b32 s55, s54, 14
    s_add_u32 s55, s55, s58
    buffer_load_dwordx4 v11, s[12:15], s78 offen offset:1024  lds
    buffer_load_dwordx4 v12, s[12:15], s78 offen offset:2048  lds
    buffer_load_dwordx4 v13, s[12:15], s78 offen offset:3072  lds
    s_add_u32 m0, s53, 32768
    s_nop 0
    buffer_load_dwordx4 v5, s[16:19], s100 offen offset:0 sc1 lds
    buffer_load_dwordx4 v5, s[16:19], s100 offen offset:1024 sc1 lds
    buffer_load_dwordx4 v5, s[16:19], s100 offen offset:2048 sc1 lds
    buffer_load_dwordx4 v5, s[16:19], s100 offen offset:3072 sc1 lds
    s_waitcnt vmcnt(8)
    s_barrier
    s_add_u32 m0, s53, 114688
    s_nop 0
    buffer_load_dwordx4 v10, s[12:15], s56 offen offset:0  lds
    s_bfe_u32 s54, s99, 262144
    s_lshl_b32 s78, s54, 17
    s_add_u32 s78, s78, s79
    s_cmp_eq_u32 s70, -1
    s_cbranch_scc1 L_ok24
    s_bfe_u32 s54, s99, 262144
    s_lshr_b32 s71, s54, 1
    s_lshl_b32 s71, s71, 2
    s_and_b32 s39, s54, 1
    s_add_u32 s71, s71, s39
    s_lshl_b32 s71, 5, s71
    s_and_b32 s39, s70, s71
    s_cmp_eq_u32 s39, s71
    s_cbranch_scc1 L_ok24
    s_mov_b32 s57, 0
L_poll24:
    s_cmp_ge_u32 s57, 12
    s_cselect_b32 s39, 1, 0
    s_and_b32 s39, s39, s57
    s_mul_i32 s73, s39, 32768
    buffer_load_dword v16, v15, s[16:19], s73 offen offset:0 sc1
    s_waitcnt vmcnt(0)
    v_cmp_eq_u32 vcc, s32, v16
    s_nop 1
    s_or_b32 s70, s70, vcc_lo
    s_and_b32 s39, s70, s71
    s_cmp_eq_u32 s39, s71
    s_cbranch_scc1 L_ok24
    s_add_u32 s57, s57, 1
    s_cmp_lg_u32 s57, 20000
    s_cbranch_scc1 L_poll24
L_ok24:
    s_bfe_u32 s54, s99, 262144
    s_lshl_b32 s100, s54, 14
    s_add_u32 s100, s100, s58
    buffer_load_dwordx4 v11, s[12:15], s56 offen offset:1024  lds
    buffer_load_dwordx4 v12, s[12:15], s56 offen offset:2048  lds
    buffer_load_dwordx4 v13, s[12:15], s56 offen offset:3072  lds
    s_add_u32 m0, s53, 49152
    s_nop 0
    buffer_load_dwordx4 v5, s[16:19], s55 offen offset:0 sc1 lds
    buffer_load_dwordx4 v5, s[16:19], s55 offen offset:1024 sc1 lds
    buffer_load_dwordx4 v5, s[16:19], s55 offen offset:2048 sc1 lds
    buffer_load_dwordx4 v5, s[16:19], s55 offen offset:3072 sc1 lds
    s_waitcnt vmcnt(8)
    s_barrier
    s_add_u32 m0, s53, 65536
    s_nop 0
    buffer_load_dwordx4 v10, s[12:15], s78 offen offset:0  lds
    s_bfe_u32 s54, s99, 262148
    s_lshl_b32 s56, s54, 17
    s_add_u32 s56, s56, s79
    s_cmp_eq_u32 s70, -1
    s_cbranch_scc1 L_ok25
    s_bfe_u32 s54, s99, 262148
    s_lshr_b32 s71, s54, 1
    s_lshl_b32 s71, s71, 2
    s_and_b32 s39, s54, 1
    s_add_u32 s71, s71, s39
    s_lshl_b32 s71, 5, s71
    s_and_b32 s39, s70, s71
    s_cmp_eq_u32 s39, s71
    s_cbranch_scc1 L_ok25
    s_mov_b32 s57, 0
L_poll25:
    s_cmp_ge_u32 s57, 12
    s_cselect_b32 s39, 1, 0
    s_and_b32 s39, s39, s57
    s_mul_i32 s73, s39, 32768
    buffer_load_dword v16, v15, s[16:19], s73 offen offset:0 sc1
    s_waitcnt vmcnt(0)
    v_cmp_eq_u32 vcc, s32, v16
    s_nop 1
    s_or_b32 s70, s70, vcc_lo
    s_and_b32 s39, s70, s71
    s_cmp_eq_u32 s39, s71
    s_cbranch_scc1 L_ok25
    s_add_u32 s57, s57, 1
    s_cmp_lg_u32 s57, 20000
    s_cbranch_scc1 L_poll25
L_ok25:
    s_bfe_u32 s54, s99, 262148
    s_lshl_b32 s55, s54, 14
    s_add_u32 s55, s55, s58
    buffer_load_dwordx4 v11, s[12:15], s78 offen offset:1024  lds
    buffer_load_dwordx4 v12, s[12:15], s78 offen offset:2048  lds
    buffer_load_dwordx4 v13, s[12:15], s78 offen offset:3072  lds
    s_add_u32 m0, s53, 0
    s_nop 0
    buffer_load_dwordx4 v5, s[16:19], s100 offen offset:0 sc1 lds
    buffer_load_dwordx4 v5, s[16:19], s100 offen offset:1024 sc1 lds
    buffer_load_dwordx4 v5, s[16:19], s100 offen offset:2048 sc1 lds
    buffer_load_dwordx4 v5, s[16:19], s100 offen offset:3072 sc1 lds
    s_waitcnt vmcnt(8)
    s_barrier
    s_add_u32 m0, s53, 81920
    s_nop 0
    buffer_load_dwordx4 v10, s[12:15], s56 offen offset:0  lds
    s_bfe_u32 s54, s99, 262152
    s_lshl_b32 s78, s54, 17
    s_add_u32 s78, s78, s79
    s_cmp_eq_u32 s70, -1
    s_cbranch_scc1 L_ok26
    s_bfe_u32 s54, s99, 262152
    s_lshr_b32 s71, s54, 1
    s_lshl_b32 s71, s71, 2
    s_and_b32 s39, s54, 1
    s_add_u32 s71, s71, s39
    s_lshl_b32 s71, 5, s71
    s_and_b32 s39, s70, s71
    s_cmp_eq_u32 s39, s71
    s_cbranch_scc1 L_ok26
    s_mov_b32 s57, 0
L_poll26:
    s_cmp_ge_u32 s57, 12
    s_cselect_b32 s39, 1, 0
    s_and_b32 s39, s39, s57
    s_mul_i32 s73, s39, 32768
    buffer_load_dword v16, v15, s[16:19], s73 offen offset:0 sc1
    s_waitcnt vmcnt(0)
    v_cmp_eq_u32 vcc, s32, v16
    s_nop 1
    s_or_b32 s70, s70, vcc_lo
    s_and_b32 s39, s70, s71
    s_cmp_eq_u32 s39, s71
    s_cbranch_scc1 L_ok26
    s_add_u32 s57, s57, 1
    s_cmp_lg_u32 s57, 20000
    s_cbranch_scc1 L_poll26
L_ok26:
    s_bfe_u32 s54, s99, 262152
    s_lshl_b32 s100, s54, 14
    s_add_u32 s100, s100, s58
    buffer_load_dwordx4 v11, s[12:15], s56 offen offset:1024  lds
    buffer_load_dwordx4 v12, s[12:15], s56 offen offset:2048  lds
    buffer_load_dwordx4 v13, s[12:15], s56 offen offset:3072  lds
    s_add_u32 m0, s53, 16384
    s_nop 0
    buffer_load_dwordx4 v5, s[16:19], s55 offen offset:0 sc1 lds
    buffer_load_dwordx4 v5, s[16:19], s55 offen offset:1024 sc1 lds
    buffer_load_dwordx4 v5, s[16:19], s55 offen offset:2048 sc1 lds
    buffer_load_dwordx4 v5, s[16:19], s55 offen offset:3072 sc1 lds
    s_waitcnt vmcnt(8)
    s_barrier
    s_add_u32 m0, s53, 98304
    s_nop 0
    buffer_load_dwordx4 v10, s[12:15], s78 offen offset:0  lds
    s_bfe_u32 s54, s99, 262156
    s_lshl_b32 s56, s54, 17
    s_add_u32 s56, s56, s79
    s_cmp_eq_u32 s70, -1
    s_cbranch_scc1 L_ok27
    s_bfe_u32 s54, s99, 262156
    s_lshr_b32 s71, s54, 1
    s_lshl_b32 s71, s71, 2
    s_and_b32 s39, s54, 1
    s_add_u32 s71, s71, s39
    s_lshl_b32 s71, 5, s71
    s_and_b32 s39, s70, s71
    s_cmp_eq_u32 s39, s71
    s_cbranch_scc1 L_ok27
    s_mov_b32 s57, 0
L_poll27:
    s_cmp_ge_u32 s57, 12
    s_cselect_b32 s39, 1, 0
    s_and_b32 s39, s39, s57
    s_mul_i32 s73, s39, 32768
    buffer_load_dword v16, v15, s[16:19], s73 offen offset:0 sc1
    s_waitcnt vmcnt(0)
    v_cmp_eq_u32 vcc, s32, v16
    s_nop 1
    s_or_b32 s70, s70, vcc_lo
    s_and_b32 s39, s70, s71
    s_cmp_eq_u32 s39, s71
    s_cbranch_scc1 L_ok27
    s_add_u32 s57, s57, 1
    s_cmp_lg_u32 s57, 20000
    s_cbranch_scc1 L_poll27
L_ok27:
    s_bfe_u32 s54, s99, 262156
    s_lshl_b32 s55, s54, 14
    s_add_u32 s55, s55, s58
    buffer_load_dwordx4 v11, s[12:15], s78 offen offset:1024  lds
    buffer_load_dwordx4 v12, s[12:15], s78 offen offset:2048  lds
    buffer_load_dwordx4 v13, s[12:15], s78 offen offset:3072  lds
    s_add_u32 m0, s53, 32768
    s_nop 0
    buffer_load_dwordx4 v5, s[16:19], s100 offen offset:0 sc1 nt lds
    buffer_load_dwordx4 v5, s[16:19], s100 offen offset:1024 sc1 nt lds
    buffer_load_dwordx4 v5, s[16:19], s100 offen offset:2048 sc1 nt lds
    buffer_load_dwordx4 v5, s[16:19], s100 offen offset:3072 sc1 nt lds
    s_waitcnt vmcnt(8)
    s_barrier
    s_add_u32 m0, s53, 114688
    s_nop 0
    buffer_load_dwordx4 v10, s[12:15], s56 offen offset:0  lds
    s_bfe_u32 s54, s99, 262160
    s_lshl_b32 s78, s54, 17
    s_add_u32 s78, s78, s79
    s_cmp_eq_u32 s70, -1
    s_cbranch_scc1 L_ok28
    s_bfe_u32 s54, s99, 262160
    s_lshr_b32 s71, s54, 1
    s_lshl_b32 s71, s71, 2
    s_and_b32 s39, s54, 1
    s_add_u32 s71, s71, s39
    s_lshl_b32 s71, 5, s71
    s_and_b32 s39, s70, s71
    s_cmp_eq_u32 s39, s71
    s_cbranch_scc1 L_ok28
    s_mov_b32 s57, 0
L_poll28:
    s_cmp_ge_u32 s57, 12
    s_cselect_b32 s39, 1, 0
    s_and_b32 s39, s39, s57
    s_mul_i32 s73, s39, 32768
    buffer_load_dword v16, v15, s[16:19], s73 offen offset:0 sc1
    s_waitcnt vmcnt(0)
    v_cmp_eq_u32 vcc, s32, v16
    s_nop 1
    s_or_b32 s70, s70, vcc_lo
    s_and_b32 s39, s70, s71
    s_cmp_eq_u32 s39, s71
    s_cbranch_scc1 L_ok28
    s_add_u32 s57, s57, 1
    s_cmp_lg_u32 s57, 20000
    s_cbranch_scc1 L_poll28
L_ok28:
    s_bfe_u32 s54, s99, 262160
    s_lshl_b32 s100, s54, 14
    s_add_u32 s100, s100, s58
    buffer_load_dwordx4 v11, s[12:15], s56 offen offset:1024  lds
    buffer_load_dwordx4 v12, s[12:15], s56 offen offset:2048  lds
    buffer_load_dwordx4 v13, s[12:15], s56 offen offset:3072  lds
    s_add_u32 m0, s53, 49152
    s_nop 0
    buffer_load_dwordx4 v5, s[16:19], s55 offen offset:0 sc1 nt lds
    buffer_load_dwordx4 v5, s[16:19], s55 offen offset:1024 sc1 nt lds
    buffer_load_dwordx4 v5, s[16:19], s55 offen offset:2048 sc1 nt lds
    buffer_load_dwordx4 v5, s[16:19], s55 offen offset:3072 sc1 nt lds
    s_waitcnt vmcnt(8)
    s_barrier
    s_add_u32 m0, s53, 65536
    s_nop 0
    buffer_load_dwordx4 v10, s[12:15], s78 offen offset:0  lds
    s_bfe_u32 s54, s99, 262164
    s_lshl_b32 s56, s54, 17
    s_add_u32 s56, s56, s79
    s_cmp_eq_u32 s70, -1
    s_cbranch_scc1 L_ok29
    s_bfe_u32 s54, s99, 262164
    s_lshr_b32 s71, s54, 1
    s_lshl_b32 s71, s71, 2
    s_and_b32 s39, s54, 1
    s_add_u32 s71, s71, s39
    s_lshl_b32 s71, 5, s71
    s_and_b32 s39, s70, s71
    s_cmp_eq_u32 s39, s71
    s_cbranch_scc1 L_ok29
    s_mov_b32 s57, 0
L_poll29:
    s_cmp_ge_u32 s57, 12
    s_cselect_b32 s39, 1, 0
    s_and_b32 s39, s39, s57
    s_mul_i32 s73, s39, 32768
    buffer_load_dword v16, v15, s[16:19], s73 offen offset:0 sc1
    s_waitcnt vmcnt(0)
    v_cmp_eq_u32 vcc, s32, v16
    s_nop 1
    s_or_b32 s70, s70, vcc_lo
    s_and_b32 s39, s70, s71
    s_cmp_eq_u32 s39, s71
    s_cbranch_scc1 L_ok29
    s_add_u32 s57, s57, 1
    s_cmp_lg_u32 s57, 20000
    s_cbranch_scc1 L_poll29
L_ok29:
    s_bfe_u32 s54, s99, 262164
    s_lshl_b32 s55, s54, 14
    s_add_u32 s55, s55, s58
    buffer_load_dwordx4 v11, s[12:15], s78 offen offset:1024  lds
    buffer_load_dwordx4 v12, s[12:15], s78 offen offset:2048  lds
    buffer_load_dwordx4 v13, s[12:15], s78 offen offset:3072  lds
    s_add_u32 m0, s53, 0
    s_nop 0
    buffer_load_dwordx4 v5, s[16:19], s100 offen offset:0 sc1 nt lds
    buffer_load_dwordx4 v5, s[16:19], s100 offen offset:1024 sc1 nt lds
    buffer_load_dwordx4 v5, s[16:19], s100 offen offset:2048 sc1 nt lds
    buffer_load_dwordx4 v5, s[16:19], s100 offen offset:3072 sc1 nt lds
    s_waitcnt vmcnt(8)
    s_barrier
    s_add_u32 m0, s53, 81920
    s_nop 0
    buffer_load_dwordx4 v10, s[12:15], s56 offen offset:0  lds
    s_bfe_u32 s54, s99, 262168
    s_lshl_b32 s78, s54, 17
    s_add_u32 s78, s78, s79
    s_cmp_eq_u32 s70, -1
    s_cbranch_scc1 L_ok30
    s_bfe_u32 s54, s99, 262168
    s_lshr_b32 s71, s54, 1
    s_lshl_b32 s71, s71, 2
    s_and_b32 s39, s54, 1
    s_add_u32 s71, s71, s39
    s_lshl_b32 s71, 5, s71
    s_and_b32 s39, s70, s71
    s_cmp_eq_u32 s39, s71
    s_cbranch_scc1 L_ok30
    s_mov_b32 s57, 0
L_poll30:
    s_cmp_ge_u32 s57, 12
    s_cselect_b32 s39, 1, 0
    s_and_b32 s39, s39, s57
    s_mul_i32 s73, s39, 32768
    buffer_load_dword v16, v15, s[16:19], s73 offen offset:0 sc1
    s_waitcnt vmcnt(0)
    v_cmp_eq_u32 vcc, s32, v16
    s_nop 1
    s_or_b32 s70, s70, vcc_lo
    s_and_b32 s39, s70, s71
    s_cmp_eq_u32 s39, s71
    s_cbranch_scc1 L_ok30
    s_add_u32 s57, s57, 1
    s_cmp_lg_u32 s57, 20000
    s_cbranch_scc1 L_poll30
L_ok30:
    s_bfe_u32 s54, s99, 262168
    s_lshl_b32 s100, s54, 14
    s_add_u32 s100, s100, s58
    buffer_load_dwordx4 v11, s[12:15], s56 offen offset:1024  lds
    buffer_load_dwordx4 v12, s[12:15], s56 offen offset:2048  lds
    buffer_load_dwordx4 v13, s[12:15], s56 offen offset:3072  lds
    s_add_u32 m0, s53, 16384
    s_nop 0
    buffer_load_dwordx4 v5, s[16:19], s55 offen offset:0 sc1 nt lds
    buffer_load_dwordx4 v5, s[16:19], s55 offen offset:1024 sc1 nt lds
    buffer_load_dwordx4 v5, s[16:19], s55 offen offset:2048 sc1 nt lds
    buffer_load_dwordx4 v5, s[16:19], s55 offen offset:3072 sc1 nt lds
    s_waitcnt vmcnt(8)
    s_barrier
    s_add_u32 m0, s53, 98304
    s_nop 0
    buffer_load_dwordx4 v10, s[12:15], s78 offen offset:0  lds
    s_bfe_u32 s54, s99, 262172
    s_lshl_b32 s56, s54, 17
    s_add_u32 s56, s56, s79
    s_cmp_eq_u32 s70, -1
    s_cbranch_scc1 L_ok31
    s_bfe_u32 s54, s99, 262172
    s_lshr_b32 s71, s54, 1
    s_lshl_b32 s71, s71, 2
    s_and_b32 s39, s54, 1
    s_add_u32 s71, s71, s39
    s_lshl_b32 s71, 5, s71
    s_and_b32 s39, s70, s71
    s_cmp_eq_u32 s39, s71
    s_cbranch_scc1 L_ok31
    s_mov_b32 s57, 0
L_poll31:
    s_cmp_ge_u32 s57, 12
    s_cselect_b32 s39, 1, 0
    s_and_b32 s39, s39, s57
    s_mul_i32 s73, s39, 32768
    buffer_load_dword v16, v15, s[16:19], s73 offen offset:0 sc1
    s_waitcnt vmcnt(0)
    v_cmp_eq_u32 vcc, s32, v16
    s_nop 1
    s_or_b32 s70, s70, vcc_lo
    s_and_b32 s39, s70, s71
    s_cmp_eq_u32 s39, s71
    s_cbranch_scc1 L_ok31
    s_add_u32 s57, s57, 1
    s_cmp_lg_u32 s57, 20000
    s_cbranch_scc1 L_poll31
L_ok31:
    s_bfe_u32 s54, s99, 262172
    s_lshl_b32 s55, s54, 14
    s_add_u32 s55, s55, s58
    buffer_load_dwordx4 v11, s[12:15], s78 offen offset:1024  lds
    buffer_load_dwordx4 v12, s[12:15], s78 offen offset:2048  lds
    buffer_load_dwordx4 v13, s[12:15], s78 offen offset:3072  lds
    s_add_u32 m0, s53, 32768
    s_nop 0
    buffer_load_dwordx4 v5, s[16:19], s100 offen offset:0 sc1 nt lds
    buffer_load_dwordx4 v5, s[16:19], s100 offen offset:1024 sc1 nt lds
    buffer_load_dwordx4 v5, s[16:19], s100 offen offset:2048 sc1 nt lds
    buffer_load_dwordx4 v5, s[16:19], s100 offen offset:3072 sc1 nt lds
    s_waitcnt vmcnt(8)
    s_barrier
    s_add_u32 m0, s53, 114688
    s_nop 0
    buffer_load_dwordx4 v10, s[12:15], s56 offen offset:0  lds
    s_bfe_u32 s54, s98, 262144
    s_add_u32 s79, s52, 4194304
    s_lshl_b32 s78, s54, 17
    s_add_u32 s78, s78, s79
    s_bfe_u32 s54, s98, 262148
    s_lshl_b32 s50, s54, 17
    s_add_u32 s50, s50, s79
    buffer_load_dwordx4 v11, s[12:15], s56 offen offset:1024  lds
    buffer_load_dwordx4 v12, s[12:15], s56 offen offset:2048  lds
    buffer_load_dwordx4 v13, s[12:15], s56 offen offset:3072  lds
    s_add_u32 m0, s53, 49152
    s_nop 0
    buffer_load_dwordx4 v5, s[16:19], s55 offen offset:0 sc1 nt lds
    buffer_load_dwordx4 v5, s[16:19], s55 offen offset:1024 sc1 nt lds
    buffer_load_dwordx4 v5, s[16:19], s55 offen offset:2048 sc1 nt lds
    buffer_load_dwordx4 v5, s[16:19], s55 offen offset:3072 sc1 nt lds
    s_waitcnt vmcnt(8)
    s_barrier
    s_add_u32 m0, s53, 65536
    s_nop 0
    buffer_load_dwordx4 v10, s[12:15], s78 offen offset:0  lds
    s_bfe_u32 s54, s98, 262152
    s_lshl_b32 s56, s54, 17
    s_add_u32 s56, s56, s79
    buffer_load_dwordx4 v11, s[12:15], s78 offen offset:1024  lds
    buffer_load_dwordx4 v12, s[12:15], s78 offen offset:2048  lds
    buffer_load_dwordx4 v13, s[12:15], s78 offen offset:3072  lds
    s_add_u32 m0, s53, 81920
    s_nop 0
    buffer_load_dwordx4 v10, s[12:15], s50 offen offset:0  lds
    buffer_load_dwordx4 v11, s[12:15], s50 offen offset:1024  lds
    buffer_load_dwordx4 v12, s[12:15], s50 offen offset:2048  lds
    buffer_load_dwordx4 v13, s[12:15], s50 offen offset:3072  lds
    s_waitcnt vmcnt(8)
    s_barrier
    s_add_u32 m0, s53, 98304
    s_nop 0
    buffer_load_dwordx4 v10, s[12:15], s56 offen offset:0  lds
    s_bfe_u32 s54, s98, 262156
    s_lshl_b32 s78, s54, 17
    s_add_u32 s78, s78, s79
    buffer_load_dwordx4 v11, s[12:15], s56 offen offset:1024  lds
    buffer_load_dwordx4 v12, s[12:15], s56 offen offset:2048  lds
    buffer_load_dwordx4 v13, s[12:15], s56 offen offset:3072  lds
    s_waitcnt vmcnt(8)
    s_barrier
    s_add_u32 m0, s53, 114688
    s_nop 0
    buffer_load_dwordx4 v10, s[12:15], s78 offen offset:0  lds
    buffer_load_dwordx4 v11, s[12:15], s78 offen offset:1024  lds
    buffer_load_dwordx4 v12, s[12:15], s78 offen offset:2048  lds
    buffer_load_dwordx4 v13, s[12:15], s78 offen offset:3072  lds
    s_waitcnt vmcnt(8)
    s_barrier
    s_lshl_b32 s70, s29, 2
    s_lshl_b32 s70, 15, s70
    s_add_u32 s58, s49, 8388608
    s_bfe_u32 s54, s98, 262156
    s_lshr_b32 s76, s54, 1
    s_lshl_b32 s76, s76, 2
    s_and_b32 s39, s54, 1
    s_add_u32 s76, s76, s39
    s_lshl_b32 s76, 5, s76
    s_bfe_u32 s54, s98, 262152
    s_lshr_b32 s71, s54, 1
    s_lshl_b32 s71, s71, 2
    s_and_b32 s39, s54, 1
    s_add_u32 s71, s71, s39
    s_lshl_b32 s71, 5, s71
    s_or_b32 s71, s71, s76
    s_and_b32 s39, s70, s71
    s_cmp_eq_u32 s39, s71
    s_cbranch_scc1 L_ok34
    s_mov_b32 s57, 0
L_poll34:
    s_cmp_ge_u32 s57, 12
    s_cselect_b32 s39, 1, 0
    s_and_b32 s39, s39, s57
    s_mul_i32 s73, s39, 32768
    buffer_load_dword v16, v15, s[16:19], s73 offen offset:128 sc1
    s_waitcnt vmcnt(0)
    v_cmp_eq_u32 vcc, s32, v16
    s_nop 1
    s_or_b32 s70, s70, vcc_lo
    s_and_b32 s39, s70, s71
    s_cmp_eq_u32 s39, s71
    s_cbranch_scc1 L_ok34
    s_add_u32 s57, s57, 1
    s_cmp_lg_u32 s57, 20000
    s_cbranch_scc1 L_poll34
L_ok34:
    s_bfe_u32 s54, s98, 262152
    s_lshl_b32 s55, s54, 14
    s_add_u32 s55, s55, s58
    s_add_u32 m0, s53, 32768
    s_nop 0
    buffer_load_dwordx4 v5, s[16:19], s55 offen offset:0 sc1 lds
    buffer_load_dwordx4 v5, s[16:19], s55 offen offset:1024 sc1 lds
    buffer_load_dwordx4 v5, s[16:19], s55 offen offset:2048 sc1 lds
    buffer_load_dwordx4 v5, s[16:19], s55 offen offset:3072 sc1 lds
    buffer_load_dword v19, v15, s[16:19], 0 offen offset:128 sc1
    s_bfe_u32 s54, s98, 262156
    s_lshl_b32 s55, s54, 14
    s_add_u32 s55, s55, s58
    s_add_u32 m0, s53, 49152
    s_nop 0
    buffer_load_dwordx4 v5, s[16:19], s55 offen offset:0 sc1 lds
    buffer_load_dwordx4 v5, s[16:19], s55 offen offset:1024 sc1 lds
    buffer_load_dwordx4 v5, s[16:19], s55 offen offset:2048 sc1 lds
    buffer_load_dwordx4 v5, s[16:19], s55 offen offset:3072 sc1 lds
    s_waitcnt vmcnt(5)
    s_waitcnt vmcnt(4)
    v_cmp_eq_u32 vcc, s32, v19
    s_nop 1
    s_or_b32 s70, s70, vcc_lo
    s_bfe_u32 s54, s98, 262160
    s_lshl_b32 s78, s54, 17
    s_add_u32 s78, s78, s79
    s_cmp_eq_u32 s70, -1
    s_cbranch_scc1 L_ok36
    s_bfe_u32 s54, s98, 262160
    s_lshr_b32 s71, s54, 1
    s_lshl_b32 s71, s71, 2
    s_and_b32 s39, s54, 1
    s_add_u32 s71, s71, s39
    s_lshl_b32 s71, 5, s71
    s_and_b32 s39, s70, s71
    s_cmp_eq_u32 s39, s71
    s_cbranch_scc1 L_ok36
    s_mov_b32 s57, 0
L_poll36:
    s_cmp_ge_u32 s57, 12
    s_cselect_b32 s39, 1, 0
    s_and_b32 s39, s39, s57
    s_mul_i32 s73, s39, 32768
    buffer_load_dword v16, v15, s[16:19], s73 offen offset:128 sc1
    s_waitcnt vmcnt(0)
    v_cmp_eq_u32 vcc, s32, v16
    s_nop 1
    s_or_b32 s70, s70, vcc_lo
    s_and_b32 s39, s70, s71
    s_cmp_eq_u32 s39, s71
    s_cbranch_scc1 L_ok36
    s_add_u32 s57, s57, 1
    s_cmp_lg_u32 s57, 20000
    s_cbranch_scc1 L_poll36
L_ok36:
    s_bfe_u32 s54, s98, 262160
    s_lshl_b32 s100, s54, 14
    s_add_u32 s100, s100, s58
    s_barrier
    buffer_load_dword v19, v15, s[16:19], 0 offen offset:128 sc1
    s_add_u32 m0, s53, 65536
    s_nop 0
    buffer_load_dwordx4 v10, s[12:15], s78 offen offset:0  lds
    buffer_load_dwordx4 v11, s[12:15], s78 offen offset:1024  lds
    buffer_load_dwordx4 v12, s[12:15], s78 offen offset:2048  lds
    buffer_load_dwordx4 v13, s[12:15], s78 offen offset:3072  lds
    s_add_u32 m0, s53, 0
    s_nop 0
    buffer_load_dwordx4 v5, s[16:19], s100 offen offset:0 sc1 lds
    buffer_load_dwordx4 v5, s[16:19], s100 offen offset:1024 sc1 lds
    buffer_load_dwordx4 v5, s[16:19], s100 offen offset:2048 sc1 lds
    buffer_load_dwordx4 v5, s[16:19], s100 offen offset:3072 sc1 lds
    s_waitcnt vmcnt(9)
    s_waitcnt vmcnt(8)
    v_cmp_eq_u32 vcc, s32, v19
    s_nop 1
    s_or_b32 s70, s70, vcc_lo
    s_bfe_u32 s54, s98, 262164
    s_lshl_b32 s56, s54, 17
    s_add_u32 s56, s56, s79
    s_cmp_eq_u32 s70, -1
    s_cbranch_scc1 L_ok37
    s_bfe_u32 s54, s98, 262164
    s_lshr_b32 s71, s54, 1
    s_lshl_b32 s71, s71, 2
    s_and_b32 s39, s54, 1
    s_add_u32 s71, s71, s39
    s_lshl_b32 s71, 5, s71
    s_and_b32 s39, s70, s71
    s_cmp_eq_u32 s39, s71
    s_cbranch_scc1 L_ok37
    s_mov_b32 s57, 0
L_poll37:
    s_cmp_ge_u32 s57, 12
    s_cselect_b32 s39, 1, 0
    s_and_b32 s39, s39, s57
    s_mul_i32 s73, s39, 32768
    buffer_load_dword v16, v15, s[16:19], s73 offen offset:128 sc1
    s_waitcnt vmcnt(0)
    v_cmp_eq_u32 vcc, s32, v16
    s_nop 1
    s_or_b32 s70, s70, vcc_lo
    s_and_b32 s39, s70, s71
    s_cmp_eq_u32 s39, s71
    s_cbranch_scc1 L_ok37
    s_add_u32 s57, s57, 1
    s_cmp_lg_u32 s57, 20000
    s_cbranch_scc1 L_poll37
L_ok37:
    s_bfe_u32 s54, s98, 262164
    s_lshl_b32 s55, s54, 14
    s_add_u32 s55, s55, s58
    s_barrier
    s_add_u32 m0, s53, 81920
    s_nop 0
    buffer_load_dwordx4 v10, s[12:15], s56 offen offset:0  lds
    s_bfe_u32 s54, s98, 262168
    s_lshl_b32 s78, s54, 17
    s_add_u32 s78, s78, s79
    s_cmp_eq_u32 s70, -1
    s_cbranch_scc1 L_ok38
    s_bfe_u32 s54, s98, 262168
    s_lshr_b32 s71, s54, 1
    s_lshl_b32 s71, s71, 2
    s_and_b32 s39, s54, 1
    s_add_u32 s71, s71, s39
    s_lshl_b32 s71, 5, s71
    s_and_b32 s39, s70, s71
    s_cmp_eq_u32 s39, s71
    s_cbranch_scc1 L_ok38
    s_mov_b32 s57, 0
L_poll38:
    s_cmp_ge_u32 s57, 12
    s_cselect_b32 s39, 1, 0
    s_and_b32 s39, s39, s57
    s_mul_i32 s73, s39, 32768
    buffer_load_dword v16, v15, s[16:19], s73 offen offset:128 sc1
    s_waitcnt vmcnt(0)
    v_cmp_eq_u32 vcc, s32, v16
    s_nop 1
    s_or_b32 s70, s70, vcc_lo
    s_and_b32 s39, s70, s71
    s_cmp_eq_u32 s39, s71
    s_cbranch_scc1 L_ok38
    s_add_u32 s57, s57, 1
    s_cmp_lg_u32 s57, 20000
    s_cbranch_scc1 L_poll38
L_ok38:
    s_bfe_u32 s54, s98, 262168
    s_lshl_b32 s100, s54, 14
    s_add_u32 s100, s100, s58
    buffer_load_dwordx4 v11, s[12:15], s56 offen offset:1024  lds
    buffer_load_dwordx4 v12, s[12:15], s56 offen offset:2048  lds
    buffer_load_dwordx4 v13, s[12:15], s56 offen offset:3072  lds
    s_add_u32 m0, s53, 16384
    s_nop 0
    buffer_load_dwordx4 v5, s[16:19], s55 offen offset:0 sc1 lds
    buffer_load_dwordx4 v5, s[16:19], s55 offen offset:1024 sc1 lds
    buffer_load_dwordx4 v5, s[16:19], s55 offen offset:2048 sc1 lds
    buffer_load_dwordx4 v5, s[16:19], s55 offen offset:3072 sc1 lds
    s_waitcnt vmcnt(8)
    s_barrier
    s_add_u32 m0, s53, 98304
    s_nop 0
    buffer_load_dwordx4 v10, s[12:15], s78 offen offset:0  lds
    s_bfe_u32 s54, s98, 262172
    s_lshl_b32 s56, s54, 17
    s_add_u32 s56, s56, s79
    s_cmp_eq_u32 s70, -1
    s_cbranch_scc1 L_ok39
    s_bfe_u32 s54, s98, 262172
    s_lshr_b32 s71, s54, 1
    s_lshl_b32 s71, s71, 2
    s_and_b32 s39, s54, 1
    s_add_u32 s71, s71, s39
    s_lshl_b32 s71, 5, s71
    s_and_b32 s39, s70, s71
    s_cmp_eq_u32 s39, s71
    s_cbranch_scc1 L_ok39
    s_mov_b32 s57, 0
L_poll39:
    s_cmp_ge_u32 s57, 12
    s_cselect_b32 s39, 1, 0
    s_and_b32 s39, s39, s57
    s_mul_i32 s73, s39, 32768
    buffer_load_dword v16, v15, s[16:19], s73 offen offset:128 sc1
    s_waitcnt vmcnt(0)
    v_cmp_eq_u32 vcc, s32, v16
    s_nop 1
    s_or_b32 s70, s70, vcc_lo
    s_and_b32 s39, s70, s71
    s_cmp_eq_u32 s39, s71
    s_cbranch_scc1 L_ok39
    s_add_u32 s57, s57, 1
    s_cmp_lg_u32 s57, 20000
    s_cbranch_scc1 L_poll39
L_ok39:
    s_bfe_u32 s54, s98, 262172
    s_lshl_b32 s55, s54, 14
    s_add_u32 s55, s55, s58
    buffer_load_dwordx4 v11, s[12:15], s78 offen offset:1024  lds
    buffer_load_dwordx4 v12, s[12:15], s78 offen offset:2048  lds
    buffer_load_dwordx4 v13, s[12:15], s78 offen offset:3072  lds
    s_add_u32 m0, s53, 32768
    s_nop 0
    buffer_load_dwordx4 v5, s[16:19], s100 offen offset:0 sc1 lds
    buffer_load_dwordx4 v5, s[16:19], s100 offen offset:1024 sc1 lds
    buffer_load_dwordx4 v5, s[16:19], s100 offen offset:2048 sc1 lds
    buffer_load_dwordx4 v5, s[16:19], s100 offen offset:3072 sc1 lds
    s_waitcnt vmcnt(8)
    s_barrier
    s_add_u32 m0, s53, 114688
    s_nop 0
    buffer_load_dwordx4 v10, s[12:15], s56 offen offset:0  lds
    s_bfe_u32 s54, s99, 262144
    s_lshl_b32 s78, s54, 17
    s_add_u32 s78, s78, s79
    s_cmp_eq_u32 s70, -1
    s_cbranch_scc1 L_ok40
    s_bfe_u32 s54, s99, 262144
    s_lshr_b32 s71, s54, 1
    s_lshl_b32 s71, s71, 2
    s_and_b32 s39, s54, 1
    s_add_u32 s71, s71, s39
    s_lshl_b32 s71, 5, s71
    s_and_b32 s39, s70, s71
    s_cmp_eq_u32 s39, s71
    s_cbranch_scc1 L_ok40
    s_mov_b32 s57, 0
L_poll40:
    s_cmp_ge_u32 s57, 12
    s_cselect_b32 s39, 1, 0
    s_and_b32 s39, s39, s57
    s_mul_i32 s73, s39, 32768
    buffer_load_dword v16, v15, s[16:19], s73 offen offset:128 sc1
    s_waitcnt vmcnt(0)
    v_cmp_eq_u32 vcc, s32, v16
    s_nop 1
    s_or_b32 s70, s70, vcc_lo
    s_and_b32 s39, s70, s71
    s_cmp_eq_u32 s39, s71
    s_cbranch_scc1 L_ok40
    s_add_u32 s57, s57, 1
    s_cmp_lg_u32 s57, 20000
    s_cbranch_scc1 L_poll40
L_ok40:
    s_bfe_u32 s54, s99, 262144
    s_lshl_b32 s100, s54, 14
    s_add_u32 s100, s100, s58
    buffer_load_dwordx4 v11, s[12:15], s56 offen offset:1024  lds
    buffer_load_dwordx4 v12, s[12:15], s56 offen offset:2048  lds
    buffer_load_dwordx4 v13, s[12:15], s56 offen offset:3072  lds
    s_add_u32 m0, s53, 49152
    s_nop 0
    buffer_load_dwordx4 v5, s[16:19], s55 offen offset:0 sc1 lds
    buffer_load_dwordx4 v5, s[16:19], s55 offen offset:1024 sc1 lds
    buffer_load_dwordx4 v5, s[16:19], s55 offen offset:2048 sc1 lds
    buffer_load_dwordx4 v5, s[16:19], s55 offen offset:3072 sc1 lds
    s_waitcnt vmcnt(8)
    s_barrier
    s_add_u32 m0, s53, 65536
    s_nop 0
    buffer_load_dwordx4 v10, s[12:15], s78 offen offset:0  lds
    s_bfe_u32 s54, s99, 262148
    s_lshl_b32 s56, s54, 17
    s_add_u32 s56, s56, s79
    s_cmp_eq_u32 s70, -1
    s_cbranch_scc1 L_ok41
    s_bfe_u32 s54, s99, 262148
    s_lshr_b32 s71, s54, 1
    s_lshl_b32 s71, s71, 2
    s_and_b32 s39, s54, 1
    s_add_u32 s71, s71, s39
    s_lshl_b32 s71, 5, s71
    s_and_b32 s39, s70, s71
    s_cmp_eq_u32 s39, s71
    s_cbranch_scc1 L_ok41
    s_mov_b32 s57, 0
L_poll41:
    s_cmp_ge_u32 s57, 12
    s_cselect_b32 s39, 1, 0
    s_and_b32 s39, s39, s57
    s_mul_i32 s73, s39, 32768
    buffer_load_dword v16, v15, s[16:19], s73 offen offset:128 sc1
    s_waitcnt vmcnt(0)
    v_cmp_eq_u32 vcc, s32, v16
    s_nop 1
    s_or_b32 s70, s70, vcc_lo
    s_and_b32 s39, s70, s71
    s_cmp_eq_u32 s39, s71
    s_cbranch_scc1 L_ok41
    s_add_u32 s57, s57, 1
    s_cmp_lg_u32 s57, 20000
    s_cbranch_scc1 L_poll41
L_ok41:
    s_bfe_u32 s54, s99, 262148
    s_lshl_b32 s55, s54, 14
    s_add_u32 s55, s55, s58
    buffer_load_dwordx4 v11, s[12:15], s78 offen offset:1024  lds
    buffer_load_dwordx4 v12, s[12:15], s78 offen offset:2048  lds
    buffer_load_dwordx4 v13, s[12:15], s78 offen offset:3072  lds
    s_add_u32 m0, s53, 0
    s_nop 0
    buffer_load_dwordx4 v5, s[16:19], s100 offen offset:0 sc1 lds
    buffer_load_dwordx4 v5, s[16:19], s100 offen offset:1024 sc1 lds
    buffer_load_dwordx4 v5, s[16:19], s100 offen offset:2048 sc1 lds
    buffer_load_dwordx4 v5, s[16:19], s100 offen offset:3072 sc1 lds
    s_waitcnt vmcnt(8)
    s_barrier
    s_add_u32 m0, s53, 81920
    s_nop 0
    buffer_load_dwordx4 v10, s[12:15], s56 offen offset:0  lds
    s_bfe_u32 s54, s99, 262152
    s_lshl_b32 s78, s54, 17
    s_add_u32 s78, s78, s79
    s_cmp_eq_u32 s70, -1
    s_cbranch_scc1 L_ok42
    s_bfe_u32 s54, s99, 262152
    s_lshr_b32 s71, s54, 1
    s_lshl_b32 s71, s71, 2
    s_and_b32 s39, s54, 1
    s_add_u32 s71, s71, s39
    s_lshl_b32 s71, 5, s71
    s_and_b32 s39, s70, s71
    s_cmp_eq_u32 s39, s71
    s_cbranch_scc1 L_ok42
    s_mov_b32 s57, 0
L_poll42:
    s_cmp_ge_u32 s57, 12
    s_cselect_b32 s39, 1, 0
    s_and_b32 s39, s39, s57
    s_mul_i32 s73, s39, 32768
    buffer_load_dword v16, v15, s[16:19], s73 offen offset:128 sc1
    s_waitcnt vmcnt(0)
    v_cmp_eq_u32 vcc, s32, v16
    s_nop 1
    s_or_b32 s70, s70, vcc_lo
    s_and_b32 s39, s70, s71
    s_cmp_eq_u32 s39, s71
    s_cbranch_scc1 L_ok42
    s_add_u32 s57, s57, 1
    s_cmp_lg_u32 s57, 20000
    s_cbranch_scc1 L_poll42
L_ok42:
    s_bfe_u32 s54, s99, 262152
    s_lshl_b32 s100, s54, 14
    s_add_u32 s100, s100, s58
    buffer_load_dwordx4 v11, s[12:15], s56 offen offset:1024  lds
    buffer_load_dwordx4 v12, s[12:15], s56 offen offset:2048  lds
    buffer_load_dwordx4 v13, s[12:15], s56 offen offset:3072  lds
    s_add_u32 m0, s53, 16384
    s_nop 0
    buffer_load_dwordx4 v5, s[16:19], s55 offen offset:0 sc1 lds
    buffer_load_dwordx4 v5, s[16:19], s55 offen offset:1024 sc1 lds
    buffer_load_dwordx4 v5, s[16:19], s55 offen offset:2048 sc1 lds
    buffer_load_dwordx4 v5, s[16:19], s55 offen offset:3072 sc1 lds
    s_waitcnt vmcnt(8)
    s_barrier
    s_add_u32 m0, s53, 98304
    s_nop 0
    buffer_load_dwordx4 v10, s[12:15], s78 offen offset:0  lds
    s_bfe_u32 s54, s99, 262156
    s_lshl_b32 s56, s54, 17
    s_add_u32 s56, s56, s79
    s_cmp_eq_u32 s70, -1
    s_cbranch_scc1 L_ok43
    s_bfe_u32 s54, s99, 262156
    s_lshr_b32 s71, s54, 1
    s_lshl_b32 s71, s71, 2
    s_and_b32 s39, s54, 1
    s_add_u32 s71, s71, s39
    s_lshl_b32 s71, 5, s71
    s_and_b32 s39, s70, s71
    s_cmp_eq_u32 s39, s71
    s_cbranch_scc1 L_ok43
    s_mov_b32 s57, 0
L_poll43:
    s_cmp_ge_u32 s57, 12
    s_cselect_b32 s39, 1, 0
    s_and_b32 s39, s39, s57
    s_mul_i32 s73, s39, 32768
    buffer_load_dword v16, v15, s[16:19], s73 offen offset:128 sc1
    s_waitcnt vmcnt(0)
    v_cmp_eq_u32 vcc, s32, v16
    s_nop 1
    s_or_b32 s70, s70, vcc_lo
    s_and_b32 s39, s70, s71
    s_cmp_eq_u32 s39, s71
    s_cbranch_scc1 L_ok43
    s_add_u32 s57, s57, 1
    s_cmp_lg_u32 s57, 20000
    s_cbranch_scc1 L_poll43
L_ok43:
    s_bfe_u32 s54, s99, 262156
    s_lshl_b32 s55, s54, 14
    s_add_u32 s55, s55, s58
    buffer_load_dwordx4 v11, s[12:15], s78 offen offset:1024  lds
    buffer_load_dwordx4 v12, s[12:15], s78 offen offset:2048  lds
    buffer_load_dwordx4 v13, s[12:15], s78 offen offset:3072  lds
    s_add_u32 m0, s53, 32768
    s_nop 0
    buffer_load_dwordx4 v5, s[16:19], s100 offen offset:0 sc1 nt lds
    buffer_load_dwordx4 v5, s[16:19], s100 offen offset:1024 sc1 nt lds
    buffer_load_dwordx4 v5, s[16:19], s100 offen offset:2048 sc1 nt lds
    buffer_load_dwordx4 v5, s[16:19], s100 offen offset:3072 sc1 nt lds
    s_waitcnt vmcnt(8)
    s_barrier
    s_add_u32 m0, s53, 114688
    s_nop 0
    buffer_load_dwordx4 v10, s[12:15], s56 offen offset:0  lds
    s_bfe_u32 s54, s99, 262160
    s_lshl_b32 s78, s54, 17
    s_add_u32 s78, s78, s79
    s_cmp_eq_u32 s70, -1
    s_cbranch_scc1 L_ok44
    s_bfe_u32 s54, s99, 262160
    s_lshr_b32 s71, s54, 1
    s_lshl_b32 s71, s71, 2
    s_and_b32 s39, s54, 1
    s_add_u32 s71, s71, s39
    s_lshl_b32 s71, 5, s71
    s_and_b32 s39, s70, s71
    s_cmp_eq_u32 s39, s71
    s_cbranch_scc1 L_ok44
    s_mov_b32 s57, 0
L_poll44:
    s_cmp_ge_u32 s57, 12
    s_cselect_b32 s39, 1, 0
    s_and_b32 s39, s39, s57
    s_mul_i32 s73, s39, 32768
    buffer_load_dword v16, v15, s[16:19], s73 offen offset:128 sc1
    s_waitcnt vmcnt(0)
    v_cmp_eq_u32 vcc, s32, v16
    s_nop 1
    s_or_b32 s70, s70, vcc_lo
    s_and_b32 s39, s70, s71
    s_cmp_eq_u32 s39, s71
    s_cbranch_scc1 L_ok44
    s_add_u32 s57, s57, 1
    s_cmp_lg_u32 s57, 20000
    s_cbranch_scc1 L_poll44
L_ok44:
    s_bfe_u32 s54, s99, 262160
    s_lshl_b32 s100, s54, 14
    s_add_u32 s100, s100, s58
    buffer_load_dwordx4 v11, s[12:15], s56 offen offset:1024  lds
    buffer_load_dwordx4 v12, s[12:15], s56 offen offset:2048  lds
    buffer_load_dwordx4 v13, s[12:15], s56 offen offset:3072  lds
    s_add_u32 m0, s53, 49152
    s_nop 0
    buffer_load_dwordx4 v5, s[16:19], s55 offen offset:0 sc1 nt lds
    buffer_load_dwordx4 v5, s[16:19], s55 offen offset:1024 sc1 nt lds
    buffer_load_dwordx4 v5, s[16:19], s55 offen offset:2048 sc1 nt lds
    buffer_load_dwordx4 v5, s[16:19], s55 offen offset:3072 sc1 nt lds
    s_waitcnt vmcnt(8)
    s_barrier
    s_add_u32 m0, s53, 65536
    s_nop 0
    buffer_load_dwordx4 v10, s[12:15], s78 offen offset:0  lds
    s_bfe_u32 s54, s99, 262164
    s_lshl_b32 s56, s54, 17
    s_add_u32 s56, s56, s79
    s_cmp_eq_u32 s70, -1
    s_cbranch_scc1 L_ok45
    s_bfe_u32 s54, s99, 262164
    s_lshr_b32 s71, s54, 1
    s_lshl_b32 s71, s71, 2
    s_and_b32 s39, s54, 1
    s_add_u32 s71, s71, s39
    s_lshl_b32 s71, 5, s71
    s_and_b32 s39, s70, s71
    s_cmp_eq_u32 s39, s71
    s_cbranch_scc1 L_ok45
    s_mov_b32 s57, 0
L_poll45:
    s_cmp_ge_u32 s57, 12
    s_cselect_b32 s39, 1, 0
    s_and_b32 s39, s39, s57
    s_mul_i32 s73, s39, 32768
    buffer_load_dword v16, v15, s[16:19], s73 offen offset:128 sc1
    s_waitcnt vmcnt(0)
    v_cmp_eq_u32 vcc, s32, v16
    s_nop 1
    s_or_b32 s70, s70, vcc_lo
    s_and_b32 s39, s70, s71
    s_cmp_eq_u32 s39, s71
    s_cbranch_scc1 L_ok45
    s_add_u32 s57, s57, 1
    s_cmp_lg_u32 s57, 20000
    s_cbranch_scc1 L_poll45
L_ok45:
    s_bfe_u32 s54, s99, 262164
    s_lshl_b32 s55, s54, 14
    s_add_u32 s55, s55, s58
    buffer_load_dwordx4 v11, s[12:15], s78 offen offset:1024  lds
    buffer_load_dwordx4 v12, s[12:15], s78 offen offset:2048  lds
    buffer_load_dwordx4 v13, s[12:15], s78 offen offset:3072  lds
    s_add_u32 m0, s53, 0
    s_nop 0
    buffer_load_dwordx4 v5, s[16:19], s100 offen offset:0 sc1 nt lds
    buffer_load_dwordx4 v5, s[16:19], s100 offen offset:1024 sc1 nt lds
    buffer_load_dwordx4 v5, s[16:19], s100 offen offset:2048 sc1 nt lds
    buffer_load_dwordx4 v5, s[16:19], s100 offen offset:3072 sc1 nt lds
    s_waitcnt vmcnt(8)
    s_barrier
    s_add_u32 m0, s53, 81920
    s_nop 0
    buffer_load_dwordx4 v10, s[12:15], s56 offen offset:0  lds
    s_bfe_u32 s54, s99, 262168
    s_lshl_b32 s78, s54, 17
    s_add_u32 s78, s78, s79
    s_cmp_eq_u32 s70, -1
    s_cbranch_scc1 L_ok46
    s_bfe_u32 s54, s99, 262168
    s_lshr_b32 s71, s54, 1
    s_lshl_b32 s71, s71, 2
    s_and_b32 s39, s54, 1
    s_add_u32 s71, s71, s39
    s_lshl_b32 s71, 5, s71
    s_and_b32 s39, s70, s71
    s_cmp_eq_u32 s39, s71
    s_cbranch_scc1 L_ok46
    s_mov_b32 s57, 0
L_poll46:
    s_cmp_ge_u32 s57, 12
    s_cselect_b32 s39, 1, 0
    s_and_b32 s39, s39, s57
    s_mul_i32 s73, s39, 32768
    buffer_load_dword v16, v15, s[16:19], s73 offen offset:128 sc1
    s_waitcnt vmcnt(0)
    v_cmp_eq_u32 vcc, s32, v16
    s_nop 1
    s_or_b32 s70, s70, vcc_lo
    s_and_b32 s39, s70, s71
    s_cmp_eq_u32 s39, s71
    s_cbranch_scc1 L_ok46
    s_add_u32 s57, s57, 1
    s_cmp_lg_u32 s57, 20000
    s_cbranch_scc1 L_poll46
L_ok46:
    s_bfe_u32 s54, s99, 262168
    s_lshl_b32 s100, s54, 14
    s_add_u32 s100, s100, s58
    buffer_load_dwordx4 v11, s[12:15], s56 offen offset:1024  lds
    buffer_load_dwordx4 v12, s[12:15], s56 offen offset:2048  lds
    buffer_load_dwordx4 v13, s[12:15], s56 offen offset:3072  lds
    s_add_u32 m0, s53, 16384
    s_nop 0
    buffer_load_dwordx4 v5, s[16:19], s55 offen offset:0 sc1 nt lds
    buffer_load_dwordx4 v5, s[16:19], s55 offen offset:1024 sc1 nt lds
    buffer_load_dwordx4 v5, s[16:19], s55 offen offset:2048 sc1 nt lds
    buffer_load_dwordx4 v5, s[16:19], s55 offen offset:3072 sc1 nt lds
    s_waitcnt vmcnt(8)
    s_barrier
    s_add_u32 m0, s53, 98304
    s_nop 0
    buffer_load_dwordx4 v10, s[12:15], s78 offen offset:0  lds
    s_bfe_u32 s54, s99, 262172
    s_lshl_b32 s56, s54, 17
    s_add_u32 s56, s56, s79
    s_cmp_eq_u32 s70, -1
    s_cbranch_scc1 L_ok47
    s_bfe_u32 s54, s99, 262172
    s_lshr_b32 s71, s54, 1
    s_lshl_b32 s71, s71, 2
    s_and_b32 s39, s54, 1
    s_add_u32 s71, s71, s39
    s_lshl_b32 s71, 5, s71
    s_and_b32 s39, s70, s71
    s_cmp_eq_u32 s39, s71
    s_cbranch_scc1 L_ok47
    s_mov_b32 s57, 0
L_poll47:
    s_cmp_ge_u32 s57, 12
    s_cselect_b32 s39, 1, 0
    s_and_b32 s39, s39, s57
    s_mul_i32 s73, s39, 32768
    buffer_load_dword v16, v15, s[16:19], s73 offen offset:128 sc1
    s_waitcnt vmcnt(0)
    v_cmp_eq_u32 vcc, s32, v16
    s_nop 1
    s_or_b32 s70, s70, vcc_lo
    s_and_b32 s39, s70, s71
    s_cmp_eq_u32 s39, s71
    s_cbranch_scc1 L_ok47
    s_add_u32 s57, s57, 1
    s_cmp_lg_u32 s57, 20000
    s_cbranch_scc1 L_poll47
L_ok47:
    s_bfe_u32 s54, s99, 262172
    s_lshl_b32 s55, s54, 14
    s_add_u32 s55, s55, s58
    buffer_load_dwordx4 v11, s[12:15], s78 offen offset:1024  lds
    buffer_load_dwordx4 v12, s[12:15], s78 offen offset:2048  lds
    buffer_load_dwordx4 v13, s[12:15], s78 offen offset:3072  lds
    s_add_u32 m0, s53, 32768
    s_nop 0
    buffer_load_dwordx4 v5, s[16:19], s100 offen offset:0 sc1 nt lds
    buffer_load_dwordx4 v5, s[16:19], s100 offen offset:1024 sc1 nt lds
    buffer_load_dwordx4 v5, s[16:19], s100 offen offset:2048 sc1 nt lds
    buffer_load_dwordx4 v5, s[16:19], s100 offen offset:3072 sc1 nt lds
    s_waitcnt vmcnt(8)
    s_barrier
    s_add_u32 m0, s53, 114688
    s_nop 0
    buffer_load_dwordx4 v10, s[12:15], s56 offen offset:0  lds
    buffer_load_dwordx4 v11, s[12:15], s56 offen offset:1024  lds
    buffer_load_dwordx4 v12, s[12:15], s56 offen offset:2048  lds
    buffer_load_dwordx4 v13, s[12:15], s56 offen offset:3072  lds
    s_add_u32 m0, s53, 49152
    s_nop 0
    buffer_load_dwordx4 v5, s[16:19], s55 offen offset:0 sc1 nt lds
    buffer_load_dwordx4 v5, s[16:19], s55 offen offset:1024 sc1 nt lds
    buffer_load_dwordx4 v5, s[16:19], s55 offen offset:2048 sc1 nt lds
    buffer_load_dwordx4 v5, s[16:19], s55 offen offset:3072 sc1 nt lds
    s_waitcnt vmcnt(8)
    s_barrier
    s_waitcnt vmcnt(0)
    s_barrier
    s_cmp_eq_u32 s29, 0
    s_cbranch_scc0 L_nov
    s_cmp_eq_u32 s30, 0
    s_cbranch_scc0 L_nov
    v_mov_b32 v17, s32
    s_lshl_b32 s34, s28, 7
    s_add_u32 s34, s34, 16842752
    v_mov_b32 v18, s34
    buffer_store_dword v17, v18, s[16:19], 0 offen sc1
L_nov:
L_end:
    s_endpgm
.section .rodata,"a"
.p2align 6
.amdhsa_kernel standalone__cross_network_dcn__recsys_kernel
  .amdhsa_next_free_vgpr 256
  .amdhsa_next_free_sgpr 102
  .amdhsa_accum_offset 256
  .amdhsa_group_segment_fixed_size 0
  .amdhsa_kernarg_size 48
  .amdhsa_user_sgpr_count 2
  .amdhsa_user_sgpr_kernarg_segment_ptr 1
  .amdhsa_system_sgpr_workgroup_id_x 1
.end_amdhsa_kernel
```
